```python
import torch

def _softmax(x, axis=-1):
    return torch.softmax(x, dim=axis)

def _gelu(x):
    return torch.nn.functional.gelu(x, approximate='tanh')

def _silu(x):
    return torch.nn.functional.silu(x)

def _sigmoid(x):
    return torch.sigmoid(x)

def _layernorm(x, axis=-1, eps=1e-05):
    m = x.mean(dim=axis, keepdim=True)
    v = x.var(dim=axis, keepdim=True, unbiased=False)
    return (x - m) / torch.sqrt(v + eps)

def _scatter_add(tgt, idx, src, axis=0):
    return tgt.clone().index_add_(axis, idx, src)

def _segment_sum(src, seg, n):
    out = torch.zeros((n,) + src.shape[1:], dtype=src.dtype)
    return out.index_add_(0, seg, src)

def _pad(x, pw):
    flat = tuple((v for pair in reversed(pw) for v in pair))
    return torch.nn.functional.pad(x, flat)
kernel_name = 'adaLN_cond__sliding_block__mixer_gmlp__prompt'

def setup_inputs():

    _w = lambda a: (lambda t: t.to(torch.bfloat16) if t.is_floating_point() else t)(torch.as_tensor(a))

    def _A_setup():
        B, S, D = (1, 2048, 640)
        return {'x': _w((lambda *s: torch.randn(*s, dtype=torch.bfloat16) * 0.05)(B, S, D)), 'wqkv': _w((lambda *s: torch.randn(*s, dtype=torch.bfloat16) * 0.05)(D, 3 * D)), 'wo': _w((lambda *s: torch.randn(*s, dtype=torch.bfloat16) * 0.05)(D, D))}
    _A_in = _A_setup()

    def _B_setup():
        B, S, D, F = (1, 2048, 640, 1728)
        Fh = F // 2
        return {'x': _w((lambda *s: torch.randn(*s, dtype=torch.bfloat16) * 0.05)(B, S, D)), 'w_in': _w((lambda *s: torch.randn(*s, dtype=torch.bfloat16) * 0.4)(D, 2 * Fh)), 'w_sp': _w(0.01 * (lambda *s: torch.randn(*s, dtype=torch.bfloat16) * 0.4)(S, S)), 'b_sp': _w(1.0 + 0.01 * (lambda *s: torch.randn(*s, dtype=torch.bfloat16) * 0.05)(S)), 'w_out': _w((lambda *s: torch.randn(*s, dtype=torch.bfloat16) * 0.05)(Fh, D))}
    _B_in = _B_setup()
    return {'A_x': _A_in['x'], 'A_wqkv': _A_in['wqkv'], 'A_wo': _A_in['wo'], 'B_x': _B_in['x'], 'B_w_in': _B_in['w_in'], 'B_w_sp': _B_in['w_sp'], 'B_b_sp': _B_in['b_sp'], 'B_w_out': _B_in['w_out'], 'c': _w((lambda *s: torch.randn(*s, dtype=torch.bfloat16) * 0.1)(1, 640) * 8.0), 'w_mod': _w((lambda *s: torch.randn(*s, dtype=torch.bfloat16) * 0.1)(640, 6 * 640) * 640 ** (-0.5) * 8.0)}

def reference(A_x, A_wqkv, A_wo, B_x, B_w_in, B_w_sp, B_b_sp, B_w_out, c, w_mod):

    def _A_ref(x, wqkv, wo):
        B, S, D = x.shape
        H = 32
        Dh = D // H
        W = 256
        qkv = (lambda x, *d: x.permute(*d))((x @ wqkv).reshape(B, S, 3, H, Dh), 2, 0, 3, 1, 4)
        q, k, v = (qkv[0], qkv[1], qkv[2])
        scores = torch.einsum('bhqd,bhkd->bhqk', q, k) * Dh ** (-0.5)
        idx = torch.arange(S)
        mask = (idx[:, None] - idx[None, :] >= 0) & (idx[:, None] - idx[None, :] < W)
        scores = torch.where(mask[None, None], scores, -1000000000.0)
        p = _softmax(scores, axis=-1)
        o = torch.einsum('bhqk,bhkd->bhqd', p, v)
        return (lambda x, *d: x.permute(*d))(o, 0, 2, 1, 3).reshape(B, S, D) @ wo

    def _B_ref(x, w_in, w_sp, b_sp, w_out):
        B, S, D = x.shape
        F = w_in.shape[-1]
        Fh = F // 2
        z = _gelu(torch.einsum('bsd,df->bsf', x, w_in))
        z1 = z[..., :Fh].clone()
        z2 = _layernorm(z[..., Fh:], axis=-1)
        g = torch.einsum('ts,bsf->btf', w_sp, z2) + b_sp[None, :, None]
        return torch.einsum('bsf,fd->bsd', z1 * g, w_out)
    x = A_x
    mod = (_silu(c) @ w_mod).reshape(c.shape[0], 6, 1, -1)
    sa, ca, ga, sb, cb, gb = (mod[:, 0].clone(), mod[:, 1].clone(), mod[:, 2].clone(), mod[:, 3].clone(), mod[:, 4].clone(), mod[:, 5].clone())
    h = _layernorm(x, axis=-1) * (1 + ca) + sa
    x = x + ga * _A_ref(h, A_wqkv, A_wo)
    h = _layernorm(x, axis=-1) * (1 + cb) + sb
    x = x + gb * _B_ref(h, B_w_in, B_w_sp, B_b_sp, B_w_out)
    return x
```

```asm
; @launch grid=(256,1,1) block=(512,1,1) lds=163840
.amdgcn_target "amdgcn-amd-amdhsa--gfx950"
.text
.globl adaLN_cond__sliding_block__mixer_gmlp__prompt_kernel
.p2align 8
.type adaLN_cond__sliding_block__mixer_gmlp__prompt_kernel,@function
adaLN_cond__sliding_block__mixer_gmlp__prompt_kernel:
  s_cmp_ge_u32 s2, 256
  s_cbranch_scc1 L_end
  s_load_dwordx16 s[4:19], s[0:1], 0
  s_load_dwordx4 s[20:23], s[0:1], 64
  s_load_dwordx4 s[24:27], s[0:1], 80
  s_load_dwordx2 s[28:29], s[0:1], 96
  v_lshrrev_b32 v3, 6, v0
  v_and_b32 v1, 63, v0
  v_readfirstlane_b32 s46, v3
  v_lshlrev_b32 v2, 4, v1
  s_and_b32 s50, s2, 7
  s_lshr_b32 s51, s2, 3
  s_and_b32 s45, s50, 1
  s_lshl_b32 s45, s45, 2
  s_and_b32 s52, s51, 3
  s_add_u32 s45, s45, s52
  s_lshr_b32 s50, s50, 1
  s_lshr_b32 s51, s51, 2
  s_lshl_b32 s44, s50, 3
  s_add_u32 s44, s44, s51
  s_lshl_b32 s48, s51, 2
  s_add_u32 s48, s48, s50
  s_and_b32 s96, s46, 3
  s_lshr_b32 s97, s46, 2
  v_mov_b32 v4, 0
  v_mov_b32 v5, 0
  v_mov_b32 v8, 89600
  ds_write_b64 v8, v[4:5]
  ds_write_b32 v8, v4 offset:8
  s_waitcnt lgkmcnt(0)
  s_mov_b32 s32, s28
  s_mov_b32 s33, s29
  s_mov_b32 s34, 33554432
  s_mov_b32 s35, 0x20000
  buffer_load_dword v6, off, s[32:35], 0 sc1
  s_cmp_ge_u32 s48, 22
  s_cbranch_scc1 L_rmod_1
  s_cmp_ge_u32 s48, 20
  s_cbranch_scc1 L_rplain_2
  s_cmp_ge_u32 s46, 5
  s_cbranch_scc1 L_rplain_2
  s_mov_b32 s36, s6
  s_mov_b32 s37, s7
  s_mov_b32 s38, 2457600
  s_mov_b32 s39, 0x20000
  s_mov_b32 s40, s8
  s_mov_b32 s41, s9
  s_mov_b32 s42, 819200
  s_mov_b32 s43, 0x20000
  s_lshl_b32 s51, s46, 6
  v_add_u32 v8, s51, v1
  v_mul_u32_u24 v9, 6554, v8
  v_lshrrev_b32 v9, 16, v9
  v_mul_u32_u24 v10, 10, v9
  v_sub_u32 v10, v8, v10
  v_lshlrev_b32 v10, 4, v10
  v_mul_u32_u24 v11, 1280, v9
  v_add_u32 v11, v11, v10
  v_mul_u32_u24 v9, 3840, v9
  v_add_u32 v10, v9, v10
  s_mul_i32 s50, s48, 122880
  s_mul_i32 s51, s45, 160
  s_add_u32 s50, s50, s51
  s_lshl_b32 s55, s46, 10
  s_add_u32 s52, s50, 1280
  s_add_u32 m0, s55, 122880
  s_nop 0
  buffer_load_dwordx4 v10, s[36:39], s52 offen nt lds
  s_add_u32 s52, s50, 2560
  s_add_u32 m0, s55, 128000
  s_nop 0
  buffer_load_dwordx4 v10, s[36:39], s52 offen nt lds
  s_add_u32 s52, s50, 0
  s_add_u32 m0, s55, 133120
  s_nop 0
  buffer_load_dwordx4 v10, s[36:39], s52 offen nt lds
  s_mul_i32 s52, s48, 40960
  s_add_u32 s52, s52, s51
  s_add_u32 m0, s55, 138240
  s_nop 0
  buffer_load_dwordx4 v11, s[40:43], s52 offen nt lds
  s_barrier
  s_lshl_b32 s55, s46, 5
  s_add_u32 s55, s55, 122880
  s_mul_i32 s57, s45, 20
  s_add_u32 s57, s57, s48
  s_mul_i32 s57, s57, 5120
  s_lshl_b32 s52, s46, 10
  s_add_u32 s57, s57, s52
  s_add_u32 s57, s57, 3670016
  v_lshrrev_b32 v9, 4, v1
  v_bfe_u32 v10, v1, 2, 2
  v_lshl_add_u32 v9, v9, 3, v10
  v_mul_u32_u24 v9, 160, v9
  v_and_b32 v10, 3, v1
  v_lshl_add_u32 v8, v10, 3, v9
  v_add_u32 v8, s55, v8
  s_mul_i32 s51, s45, 307200
  s_mul_i32 s52, s48, 15360
  s_add_u32 s51, s51, s52
  s_lshl_b32 s52, s46, 10
  s_add_u32 s51, s51, s52
  s_add_u32 s51, s51, 1048576
  s_lshl_b32 s54, s48, 5
  s_add_u32 s54, s54, s46
  s_lshl_b32 s54, s54, 2
  s_lshl_b32 s52, s45, 12
  s_add_u32 s54, s54, s52
  s_add_u32 s54, s54, 786432
  s_waitcnt vmcnt(0)
  v_readfirstlane_b32 s49, v6
  s_nop 1
  s_mul_i32 s47, s49, 0x9E3779B1
  s_add_u32 s47, s47, 0x7F4A7C15
  v_writelane_b32 v3, s47, 0
  v_mov_b32 v10, 89604
  v_mov_b32 v11, 1
  s_mov_b64 exec, 1
  ds_add_u32 v10, v11
  s_mov_b64 exec, -1
  s_mov_b32 s61, 0
L_lj_4:
  ds_read_b32 v11, v10
  s_waitcnt lgkmcnt(0)
  v_readfirstlane_b32 s60, v11
  s_nop 1
  s_cmp_ge_u32 s60, 5
  s_cbranch_scc1 L_ljd_5
  s_add_u32 s61, s61, 1
  s_cmp_lt_u32 s61, 320000
  s_cbranch_scc1 L_lj_4
L_ljd_5:
  ds_read_b64_tr_b16 v[12:13], v8 offset:0
  ds_read_b64_tr_b16 v[14:15], v8 offset:640
  ds_read_b64_tr_b16 v[16:17], v8 offset:5120
  ds_read_b64_tr_b16 v[18:19], v8 offset:5760
  ds_read_b64_tr_b16 v[20:21], v8 offset:10240
  ds_read_b64_tr_b16 v[22:23], v8 offset:10880
  ds_read_b64_tr_b16 v[24:25], v8 offset:15360
  ds_read_b64_tr_b16 v[26:27], v8 offset:16000
  s_waitcnt lgkmcnt(6)
  buffer_store_dwordx4 v[12:15], v2, s[32:35], s51 offen sc1
  s_add_u32 s51, s51, 5120
  s_waitcnt lgkmcnt(4)
  buffer_store_dwordx4 v[16:19], v2, s[32:35], s51 offen sc1
  s_add_u32 s51, s51, 5120
  s_waitcnt lgkmcnt(2)
  buffer_store_dwordx4 v[20:23], v2, s[32:35], s51 offen sc1
  s_waitcnt lgkmcnt(0)
  buffer_store_dwordx4 v[24:27], v2, s[32:35], s57 offen sc1
  s_waitcnt vmcnt(0)
  s_mov_b64 exec, 1
  buffer_store_dword v3, off, s[32:35], s54 sc1
  s_mov_b64 exec, -1
  s_branch L_rx_3
L_rmod_1:
  s_cmp_ge_u32 s46, 4
  s_cbranch_scc1 L_rplain_2
  s_mov_b32 s36, s22
  s_mov_b32 s37, s23
  s_mov_b32 s38, 4915200
  s_mov_b32 s39, 0x20000
  s_mov_b32 s40, s20
  s_mov_b32 s41, s21
  s_mov_b32 s42, 1280
  s_mov_b32 s43, 0x20000
  s_sub_u32 s50, s48, 22
  s_lshl_b32 s50, s50, 3
  s_add_u32 s50, s50, s45
  s_mul_i32 s51, s50, 205
  s_lshr_b32 s51, s51, 12
  s_mul_i32 s52, s51, 20
  s_sub_u32 s52, s50, s52
  v_lshlrev_b32 v8, 2, v0
  buffer_load_dword v12, v8, s[40:43], 0 offen
  v_lshlrev_b32 v9, 2, v1
  buffer_load_dword v13, v9, s[40:43], 0 offen offset:1024
  v_lshrrev_b32 v10, 3, v1
  v_mul_u32_u24 v10, 7680, v10
  v_and_b32 v11, 7, v1
  v_lshl_add_u32 v10, v11, 4, v10
  s_mul_i32 s53, s51, 1228800
  s_lshl_b32 s54, s52, 7
  s_add_u32 s53, s53, s54
  s_mul_i32 s54, s46, 307200
  s_add_u32 s53, s53, s54
  s_mul_i32 s54, s46, 5120
  s_add_u32 s54, s54, 122880
  s_lshl_b32 s55, s46, 5
  s_add_u32 s55, s55, 122880
  s_mov_b32 m0, s54
  s_nop 0
  buffer_load_dwordx4 v10, s[36:39], s53 offen nt lds
  s_add_u32 s53, s53, 61440
  s_add_u32 s54, s54, 1024
  s_mov_b32 m0, s54
  s_nop 0
  buffer_load_dwordx4 v10, s[36:39], s53 offen nt lds
  s_add_u32 s53, s53, 61440
  s_add_u32 s54, s54, 1024
  s_mov_b32 m0, s54
  s_nop 0
  buffer_load_dwordx4 v10, s[36:39], s53 offen nt lds
  s_add_u32 s53, s53, 61440
  s_add_u32 s54, s54, 1024
  s_mov_b32 m0, s54
  s_nop 0
  buffer_load_dwordx4 v10, s[36:39], s53 offen nt lds
  s_add_u32 s53, s53, 61440
  s_add_u32 s54, s54, 1024
  s_mov_b32 m0, s54
  s_nop 0
  buffer_load_dwordx4 v10, s[36:39], s53 offen nt lds
  s_add_u32 s53, s53, 61440
  s_add_u32 s54, s54, 1024
  s_barrier
  v_add_u32 v14, 87040, v8
  v_add_u32 v15, 88064, v9
  v_lshrrev_b32 v11, 4, v1
  v_lshlrev_b32 v10, 4, v11
  s_mul_i32 s54, s51, 320
  s_add_u32 s54, s54, 87040
  v_add_u32 v10, s54, v10
  s_mul_i32 s57, s51, 5120
  s_lshl_b32 s52, s52, 8
  s_add_u32 s57, s57, s52
  s_lshl_b32 s52, s46, 6
  s_add_u32 s57, s57, s52
  s_add_u32 s57, s57, 45056
  v_lshrrev_b32 v16, 4, v1
  v_bfe_u32 v17, v1, 2, 2
  v_lshl_add_u32 v16, v16, 3, v17
  v_mul_u32_u24 v16, 128, v16
  v_and_b32 v17, 3, v1
  v_lshl_add_u32 v8, v17, 3, v16
  v_add_u32 v8, s55, v8
  s_waitcnt vmcnt(5)
  v_lshlrev_b32 v16, 16, v12
  v_and_b32 v17, 0xffff0000, v12
  v_mul_f32 v18, 0xbfb8aa3b, v16
  v_mul_f32 v19, 0xbfb8aa3b, v17
  v_exp_f32 v18, v18
  v_exp_f32 v19, v19
  v_add_f32 v18, 1.0, v18
  v_add_f32 v19, 1.0, v19
  v_rcp_f32 v18, v18
  v_rcp_f32 v19, v19
  v_mul_f32 v16, v16, v18
  v_mul_f32 v17, v17, v19
  v_cvt_pk_bf16_f32 v16, v16, v17
  ds_write_b32 v14, v16 offset:0
  v_lshlrev_b32 v16, 16, v13
  v_and_b32 v17, 0xffff0000, v13
  v_mul_f32 v18, 0xbfb8aa3b, v16
  v_mul_f32 v19, 0xbfb8aa3b, v17
  v_exp_f32 v18, v18
  v_exp_f32 v19, v19
  v_add_f32 v18, 1.0, v18
  v_add_f32 v19, 1.0, v19
  v_rcp_f32 v18, v18
  v_rcp_f32 v19, v19
  v_mul_f32 v16, v16, v18
  v_mul_f32 v17, v17, v19
  v_cvt_pk_bf16_f32 v16, v16, v17
  ds_write_b32 v15, v16 offset:0
  v_readfirstlane_b32 s49, v6
  s_nop 1
  s_mul_i32 s47, s49, 0x9E3779B1
  s_add_u32 s47, s47, 0x7F4A7C15
  v_writelane_b32 v3, s47, 0
  s_waitcnt vmcnt(0) lgkmcnt(0)
  v_mov_b32 v16, 89604
  v_mov_b32 v17, 1
  s_mov_b64 exec, 1
  ds_add_u32 v16, v17
  s_mov_b64 exec, -1
  s_mov_b32 s61, 0
L_lj_6:
  ds_read_b32 v17, v16
  s_waitcnt lgkmcnt(0)
  v_readfirstlane_b32 s60, v17
  s_nop 1
  s_cmp_ge_u32 s60, 4
  s_cbranch_scc1 L_ljd_7
  s_add_u32 s61, s61, 1
  s_cmp_lt_u32 s61, 320000
  s_cbranch_scc1 L_lj_6
L_ljd_7:
  ds_read_b64_tr_b16 v[16:17], v8 offset:0
  ds_read_b64_tr_b16 v[18:19], v8 offset:512
  ds_read_b128 v[20:23], v10 offset:0
  ds_read_b64_tr_b16 v[24:25], v8 offset:4096
  ds_read_b64_tr_b16 v[26:27], v8 offset:4608
  ds_read_b128 v[28:31], v10 offset:64
  ds_read_b64_tr_b16 v[32:33], v8 offset:8192
  ds_read_b64_tr_b16 v[34:35], v8 offset:8704
  ds_read_b128 v[36:39], v10 offset:128
  ds_read_b64_tr_b16 v[40:41], v8 offset:12288
  ds_read_b64_tr_b16 v[42:43], v8 offset:12800
  ds_read_b128 v[44:47], v10 offset:192
  ds_read_b64_tr_b16 v[48:49], v8 offset:16384
  ds_read_b64_tr_b16 v[50:51], v8 offset:16896
  ds_read_b128 v[52:55], v10 offset:256
  s_waitcnt lgkmcnt(12)
  v_mfma_f32_16x16x32_bf16 v[12:15], v[16:19], v[20:23], 0
  s_waitcnt lgkmcnt(9)
  v_mfma_f32_16x16x32_bf16 v[12:15], v[24:27], v[28:31], v[12:15]
  s_waitcnt lgkmcnt(6)
  v_mfma_f32_16x16x32_bf16 v[12:15], v[32:35], v[36:39], v[12:15]
  s_waitcnt lgkmcnt(3)
  v_mfma_f32_16x16x32_bf16 v[12:15], v[40:43], v[44:47], v[12:15]
  s_waitcnt lgkmcnt(0)
  v_mfma_f32_16x16x32_bf16 v[12:15], v[48:51], v[52:55], v[12:15]
  v_and_b32 v16, 15, v1
  v_cmp_eq_u32 s[58:59], 0, v16
  v_lshlrev_b32 v17, 4, v11
  v_mov_b32 v16, 0x40000000
  v_cndmask_b32 v17, v16, v17, s[58:59]
  v_mov_b32 v18, 0xff
  s_lshr_b32 s60, s47, 0
  v_mov_b32 v19, s60
  v_bfi_b32 v12, v18, v19, v12
  s_lshr_b32 s60, s47, 8
  v_mov_b32 v19, s60
  v_bfi_b32 v13, v18, v19, v13
  s_lshr_b32 s60, s47, 16
  v_mov_b32 v19, s60
  v_bfi_b32 v14, v18, v19, v14
  s_lshr_b32 s60, s47, 24
  v_mov_b32 v19, s60
  v_bfi_b32 v15, v18, v19, v15
  buffer_store_dwordx4 v[12:15], v17, s[32:35], s57 offen sc1
  s_branch L_rx_3
L_rplain_2:
  s_cmp_eq_u32 s46, 7
  s_cbranch_scc0 L_w_9
  s_getpc_b64 s[52:53]
L_pc_8:
  s_sub_u32 s52, s52, L_pc_8-adaLN_cond__sliding_block__mixer_gmlp__prompt_kernel
  s_subb_u32 s53, s53, 0
  s_lshr_b32 s50, s2, 3
  s_mul_i32 s50, s50, 1792
  v_min_u32 v4, 13, v1
  v_lshlrev_b32 v4, 7, v4
  v_add_u32 v4, s50, v4
  v_min_u32 v4, 52668, v4
  global_load_dword v7, v4, s[52:53]
L_w_9:
  s_barrier
  s_cmp_ge_u32 s46, 5
  s_cbranch_scc0 L_w_10
  s_mov_b32 s40, s4
  s_mov_b32 s41, s5
  s_mov_b32 s42, 2621440
  s_mov_b32 s43, 0x20000
  s_and_b32 s53, s45, 3
  s_mul_i32 s53, s53, 20
  s_add_u32 s53, s53, s46
  s_sub_u32 s53, s53, 5
  s_lshl_b32 s53, s53, 10
  s_mul_i32 s52, s44, 81920
  s_add_u32 s54, s52, s53
  s_mov_b32 m0, s53
  s_add_u32 s53, s53, 3072
  buffer_load_dwordx4 v2, s[40:43], s54 offen nt lds
  s_cmp_ge_u32 s53, 81920
  s_cselect_b32 s55, 81920, 0
  s_sub_u32 s53, s53, s55
  s_add_u32 s54, s52, s53
  s_mov_b32 m0, s53
  s_add_u32 s53, s53, 3072
  buffer_load_dwordx4 v2, s[40:43], s54 offen nt lds
  s_cmp_ge_u32 s53, 81920
  s_cselect_b32 s55, 81920, 0
  s_sub_u32 s53, s53, s55
  s_add_u32 s54, s52, s53
  s_mov_b32 m0, s53
  s_add_u32 s53, s53, 3072
  buffer_load_dwordx4 v2, s[40:43], s54 offen nt lds
  s_cmp_ge_u32 s53, 81920
  s_cselect_b32 s55, 81920, 0
  s_sub_u32 s53, s53, s55
  s_add_u32 s54, s52, s53
  s_mov_b32 m0, s53
  s_add_u32 s53, s53, 3072
  buffer_load_dwordx4 v2, s[40:43], s54 offen nt lds
  s_cmp_ge_u32 s53, 81920
  s_cselect_b32 s55, 81920, 0
  s_sub_u32 s53, s53, s55
  s_add_u32 s54, s52, s53
  s_mov_b32 m0, s53
  s_add_u32 s53, s53, 3072
  buffer_load_dwordx4 v2, s[40:43], s54 offen nt lds
  s_cmp_ge_u32 s53, 81920
  s_cselect_b32 s55, 81920, 0
  s_sub_u32 s53, s53, s55
  s_add_u32 s54, s52, s53
  s_mov_b32 m0, s53
  s_add_u32 s53, s53, 3072
  buffer_load_dwordx4 v2, s[40:43], s54 offen nt lds
  s_cmp_ge_u32 s53, 81920
  s_cselect_b32 s55, 81920, 0
  s_sub_u32 s53, s53, s55
  s_add_u32 s54, s52, s53
  s_mov_b32 m0, s53
  s_add_u32 s53, s53, 3072
  buffer_load_dwordx4 v2, s[40:43], s54 offen nt lds
  s_cmp_ge_u32 s53, 81920
  s_cselect_b32 s55, 81920, 0
  s_sub_u32 s53, s53, s55
  s_add_u32 s54, s52, s53
  s_mov_b32 m0, s53
  s_add_u32 s53, s53, 3072
  buffer_load_dwordx4 v2, s[40:43], s54 offen nt lds
  s_cmp_ge_u32 s53, 81920
  s_cselect_b32 s55, 81920, 0
  s_sub_u32 s53, s53, s55
  s_add_u32 s54, s52, s53
  s_mov_b32 m0, s53
  s_add_u32 s53, s53, 3072
  buffer_load_dwordx4 v2, s[40:43], s54 offen nt lds
  s_cmp_ge_u32 s53, 81920
  s_cselect_b32 s55, 81920, 0
  s_sub_u32 s53, s53, s55
  s_add_u32 s54, s52, s53
  s_mov_b32 m0, s53
  s_add_u32 s53, s53, 3072
  buffer_load_dwordx4 v2, s[40:43], s54 offen nt lds
  s_cmp_ge_u32 s53, 81920
  s_cselect_b32 s55, 81920, 0
  s_sub_u32 s53, s53, s55
  s_add_u32 s54, s52, s53
  s_mov_b32 m0, s53
  s_add_u32 s53, s53, 3072
  buffer_load_dwordx4 v2, s[40:43], s54 offen nt lds
  s_cmp_ge_u32 s53, 81920
  s_cselect_b32 s55, 81920, 0
  s_sub_u32 s53, s53, s55
  s_add_u32 s54, s52, s53
  s_mov_b32 m0, s53
  s_add_u32 s53, s53, 3072
  buffer_load_dwordx4 v2, s[40:43], s54 offen nt lds
  s_cmp_ge_u32 s53, 81920
  s_cselect_b32 s55, 81920, 0
  s_sub_u32 s53, s53, s55
  s_add_u32 s54, s52, s53
  s_mov_b32 m0, s53
  s_add_u32 s53, s53, 3072
  buffer_load_dwordx4 v2, s[40:43], s54 offen nt lds
  s_cmp_ge_u32 s53, 81920
  s_cselect_b32 s55, 81920, 0
  s_sub_u32 s53, s53, s55
  s_add_u32 s54, s52, s53
  s_mov_b32 m0, s53
  s_add_u32 s53, s53, 3072
  buffer_load_dwordx4 v2, s[40:43], s54 offen nt lds
  s_cmp_ge_u32 s53, 81920
  s_cselect_b32 s55, 81920, 0
  s_sub_u32 s53, s53, s55
  s_add_u32 s54, s52, s53
  s_mov_b32 m0, s53
  s_add_u32 s53, s53, 3072
  buffer_load_dwordx4 v2, s[40:43], s54 offen nt lds
  s_cmp_ge_u32 s53, 81920
  s_cselect_b32 s55, 81920, 0
  s_sub_u32 s53, s53, s55
  s_add_u32 s54, s52, s53
  s_mov_b32 m0, s53
  s_add_u32 s53, s53, 3072
  buffer_load_dwordx4 v2, s[40:43], s54 offen nt lds
  s_cmp_ge_u32 s53, 81920
  s_cselect_b32 s55, 81920, 0
  s_sub_u32 s53, s53, s55
  s_add_u32 s54, s52, s53
  s_mov_b32 m0, s53
  s_add_u32 s53, s53, 3072
  buffer_load_dwordx4 v2, s[40:43], s54 offen nt lds
  s_cmp_ge_u32 s53, 81920
  s_cselect_b32 s55, 81920, 0
  s_sub_u32 s53, s53, s55
  s_add_u32 s54, s52, s53
  s_mov_b32 m0, s53
  s_add_u32 s53, s53, 3072
  buffer_load_dwordx4 v2, s[40:43], s54 offen nt lds
  s_cmp_ge_u32 s53, 81920
  s_cselect_b32 s55, 81920, 0
  s_sub_u32 s53, s53, s55
  s_add_u32 s54, s52, s53
  s_mov_b32 m0, s53
  s_add_u32 s53, s53, 3072
  buffer_load_dwordx4 v2, s[40:43], s54 offen nt lds
  s_cmp_ge_u32 s53, 81920
  s_cselect_b32 s55, 81920, 0
  s_sub_u32 s53, s53, s55
  s_add_u32 s54, s52, s53
  s_mov_b32 m0, s53
  s_add_u32 s53, s53, 3072
  buffer_load_dwordx4 v2, s[40:43], s54 offen nt lds
  s_cmp_ge_u32 s53, 81920
  s_cselect_b32 s55, 81920, 0
  s_sub_u32 s53, s53, s55
  s_add_u32 s54, s52, s53
  s_mov_b32 m0, s53
  s_add_u32 s53, s53, 3072
  buffer_load_dwordx4 v2, s[40:43], s54 offen nt lds
  s_cmp_ge_u32 s53, 81920
  s_cselect_b32 s55, 81920, 0
  s_sub_u32 s53, s53, s55
  s_add_u32 s54, s52, s53
  s_mov_b32 m0, s53
  s_add_u32 s53, s53, 3072
  buffer_load_dwordx4 v2, s[40:43], s54 offen nt lds
  s_cmp_ge_u32 s53, 81920
  s_cselect_b32 s55, 81920, 0
  s_sub_u32 s53, s53, s55
  s_add_u32 s54, s52, s53
  s_mov_b32 m0, s53
  s_add_u32 s53, s53, 3072
  buffer_load_dwordx4 v2, s[40:43], s54 offen nt lds
  s_cmp_ge_u32 s53, 81920
  s_cselect_b32 s55, 81920, 0
  s_sub_u32 s53, s53, s55
  s_add_u32 s54, s52, s53
  s_mov_b32 m0, s53
  s_add_u32 s53, s53, 3072
  buffer_load_dwordx4 v2, s[40:43], s54 offen nt lds
  s_cmp_ge_u32 s53, 81920
  s_cselect_b32 s55, 81920, 0
  s_sub_u32 s53, s53, s55
  s_add_u32 s54, s52, s53
  s_mov_b32 m0, s53
  s_add_u32 s53, s53, 3072
  buffer_load_dwordx4 v2, s[40:43], s54 offen nt lds
  s_cmp_ge_u32 s53, 81920
  s_cselect_b32 s55, 81920, 0
  s_sub_u32 s53, s53, s55
  s_add_u32 s54, s52, s53
  s_mov_b32 m0, s53
  s_add_u32 s53, s53, 3072
  buffer_load_dwordx4 v2, s[40:43], s54 offen nt lds
  s_cmp_ge_u32 s53, 81920
  s_cselect_b32 s55, 81920, 0
  s_sub_u32 s53, s53, s55
  s_add_u32 s54, s52, s53
  s_mov_b32 m0, s53
  s_add_u32 s53, s53, 3072
  buffer_load_dwordx4 v2, s[40:43], s54 offen nt lds
  s_cmp_ge_u32 s53, 81920
  s_cselect_b32 s55, 81920, 0
  s_sub_u32 s53, s53, s55
L_w_10:
  s_waitcnt vmcnt(0)
  v_readfirstlane_b32 s49, v6
  s_nop 1
  s_mul_i32 s47, s49, 0x9E3779B1
  s_add_u32 s47, s47, 0x7F4A7C15
  v_writelane_b32 v3, s47, 0
L_rx_3:
  s_cmp_ge_u32 s46, 4
  s_cbranch_scc0 L_w_11
  v_bfe_u32 v8, v0, 7, 1
  v_mul_u32_u24 v8, 11264, v8
  v_bfe_u32 v9, v0, 5, 2
  v_mul_u32_u24 v9, 2816, v9
  v_and_b32 v10, 31, v0
  v_mul_u32_u24 v10, 48, v10
  v_add3_u32 v8, v8, v9, v10
  v_add_u32 v8, 91432, v8
  v_mov_b32 v10, 0x3f80
  v_mov_b32 v11, 0
  ds_write_b64 v8, v[10:11]
L_w_11:
  v_and_b32 v136, 31, v0
  v_lshrrev_b32 v137, 1, v136
  v_and_b32 v138, 1, v136
  v_lshlrev_b32 v138, 3, v138
  v_lshl_add_u32 v138, v137, 10, v138
  v_and_b32 v137, 7, v137
  v_lshrrev_b32 v136, 5, v0
  v_lshlrev_b32 v136, 2, v136
  v_add_u32 v139, 0, v136
  v_xor_b32 v139, v139, v137
  v_lshl_add_u32 v152, v139, 4, v138
  v_add_u32 v139, 1, v136
  v_xor_b32 v139, v139, v137
  v_lshl_add_u32 v153, v139, 4, v138
  v_add_u32 v139, 2, v136
  v_xor_b32 v139, v139, v137
  v_lshl_add_u32 v154, v139, 4, v138
  v_add_u32 v139, 3, v136
  v_xor_b32 v139, v139, v137
  v_lshl_add_u32 v155, v139, 4, v138
  v_and_b32 v156, 31, v0
  v_lshlrev_b32 v156, 4, v156
  v_add_u32 v156, 81920, v156
  v_and_b32 v11, 15, v1
  s_lshl_b32 s51, s96, 4
  v_add_u32 v11, s51, v11
  v_mul_u32_u24 v11, 1280, v11
  v_lshrrev_b32 v10, 4, v1
  v_lshl_add_u32 v11, v10, 3, v11
  s_mul_i32 s51, s97, 96
  s_mul_i32 s52, s45, 160
  s_add_u32 s51, s51, s52
  v_add_u32 v11, s51, v11
  v_lshrrev_b32 v8, 5, v0
  v_mul_u32_u24 v8, 5120, v8
  v_and_b32 v9, 31, v0
  v_lshl_add_u32 v8, v9, 3, v8
  s_barrier
  ds_read_b64 v[96:97], v8 offset:0
  ds_read_b64 v[98:99], v8 offset:256
  ds_read_b64 v[100:101], v8 offset:512
  ds_read_b64 v[102:103], v8 offset:768
  ds_read_b64 v[104:105], v8 offset:1024
  ds_read_b64 v[106:107], v8 offset:1280
  ds_read_b64 v[108:109], v8 offset:1536
  ds_read_b64 v[110:111], v8 offset:1792
  ds_read_b64 v[112:113], v8 offset:2048
  ds_read_b64 v[114:115], v8 offset:2304
  ds_read_b64 v[116:117], v8 offset:2560
  ds_read_b64 v[118:119], v8 offset:2816
  ds_read_b64 v[120:121], v8 offset:3072
  ds_read_b64 v[122:123], v8 offset:3328
  ds_read_b64 v[124:125], v8 offset:3584
  s_waitcnt lgkmcnt(10)
  v_lshlrev_b32 v16, 16, v96
  v_and_b32 v17, 0xffff0000, v96
  v_lshlrev_b32 v18, 16, v97
  v_and_b32 v19, 0xffff0000, v97
  v_lshlrev_b32 v20, 16, v98
  v_and_b32 v21, 0xffff0000, v98
  v_lshlrev_b32 v22, 16, v99
  v_and_b32 v23, 0xffff0000, v99
  v_lshlrev_b32 v24, 16, v100
  v_and_b32 v25, 0xffff0000, v100
  v_lshlrev_b32 v26, 16, v101
  v_and_b32 v27, 0xffff0000, v101
  v_lshlrev_b32 v28, 16, v102
  v_and_b32 v29, 0xffff0000, v102
  v_lshlrev_b32 v30, 16, v103
  v_and_b32 v31, 0xffff0000, v103
  v_lshlrev_b32 v32, 16, v104
  v_and_b32 v33, 0xffff0000, v104
  v_lshlrev_b32 v34, 16, v105
  v_and_b32 v35, 0xffff0000, v105
  v_add_f32 v136, v16, v17
  v_mul_f32 v140, v16, v16
  v_add_f32 v144, v18, v19
  v_mul_f32 v145, v17, v17
  v_fmac_f32 v140, v18, v18
  v_fmac_f32 v145, v19, v19
  v_add_f32 v136, v136, v20
  v_fmac_f32 v140, v20, v20
  v_add_f32 v144, v144, v21
  v_fmac_f32 v145, v21, v21
  v_add_f32 v136, v136, v22
  v_fmac_f32 v140, v22, v22
  v_add_f32 v144, v144, v23
  v_fmac_f32 v145, v23, v23
  v_add_f32 v136, v136, v24
  v_fmac_f32 v140, v24, v24
  v_add_f32 v144, v144, v25
  v_fmac_f32 v145, v25, v25
  v_add_f32 v136, v136, v26
  v_fmac_f32 v140, v26, v26
  v_add_f32 v144, v144, v27
  v_fmac_f32 v145, v27, v27
  v_add_f32 v136, v136, v28
  v_fmac_f32 v140, v28, v28
  v_add_f32 v144, v144, v29
  v_fmac_f32 v145, v29, v29
  v_add_f32 v136, v136, v30
  v_fmac_f32 v140, v30, v30
  v_add_f32 v144, v144, v31
  v_fmac_f32 v145, v31, v31
  v_add_f32 v136, v136, v32
  v_fmac_f32 v140, v32, v32
  v_add_f32 v144, v144, v33
  v_fmac_f32 v145, v33, v33
  v_add_f32 v136, v136, v34
  v_fmac_f32 v140, v34, v34
  v_add_f32 v144, v144, v35
  v_fmac_f32 v145, v35, v35
  v_add_f32 v136, v136, v144
  v_add_f32 v140, v140, v145
  ds_read_b64 v[126:127], v8 offset:3840
  ds_read_b64 v[128:129], v8 offset:4096
  ds_read_b64 v[130:131], v8 offset:4352
  ds_read_b64 v[132:133], v8 offset:4608
  ds_read_b64 v[134:135], v8 offset:4864
  s_waitcnt lgkmcnt(10)
  v_lshlrev_b32 v36, 16, v106
  v_and_b32 v37, 0xffff0000, v106
  v_lshlrev_b32 v38, 16, v107
  v_and_b32 v39, 0xffff0000, v107
  v_lshlrev_b32 v40, 16, v108
  v_and_b32 v41, 0xffff0000, v108
  v_lshlrev_b32 v42, 16, v109
  v_and_b32 v43, 0xffff0000, v109
  v_lshlrev_b32 v44, 16, v110
  v_and_b32 v45, 0xffff0000, v110
  v_lshlrev_b32 v46, 16, v111
  v_and_b32 v47, 0xffff0000, v111
  v_lshlrev_b32 v48, 16, v112
  v_and_b32 v49, 0xffff0000, v112
  v_lshlrev_b32 v50, 16, v113
  v_and_b32 v51, 0xffff0000, v113
  v_lshlrev_b32 v52, 16, v114
  v_and_b32 v53, 0xffff0000, v114
  v_lshlrev_b32 v54, 16, v115
  v_and_b32 v55, 0xffff0000, v115
  v_add_f32 v137, v36, v37
  v_mul_f32 v141, v36, v36
  v_add_f32 v144, v38, v39
  v_mul_f32 v145, v37, v37
  v_fmac_f32 v141, v38, v38
  v_fmac_f32 v145, v39, v39
  v_add_f32 v137, v137, v40
  v_fmac_f32 v141, v40, v40
  v_add_f32 v144, v144, v41
  v_fmac_f32 v145, v41, v41
  v_add_f32 v137, v137, v42
  v_fmac_f32 v141, v42, v42
  v_add_f32 v144, v144, v43
  v_fmac_f32 v145, v43, v43
  v_add_f32 v137, v137, v44
  v_fmac_f32 v141, v44, v44
  v_add_f32 v144, v144, v45
  v_fmac_f32 v145, v45, v45
  v_add_f32 v137, v137, v46
  v_fmac_f32 v141, v46, v46
  v_add_f32 v144, v144, v47
  v_fmac_f32 v145, v47, v47
  v_add_f32 v137, v137, v48
  v_fmac_f32 v141, v48, v48
  v_add_f32 v144, v144, v49
  v_fmac_f32 v145, v49, v49
  v_add_f32 v137, v137, v50
  v_fmac_f32 v141, v50, v50
  v_add_f32 v144, v144, v51
  v_fmac_f32 v145, v51, v51
  v_add_f32 v137, v137, v52
  v_fmac_f32 v141, v52, v52
  v_add_f32 v144, v144, v53
  v_fmac_f32 v145, v53, v53
  v_add_f32 v137, v137, v54
  v_fmac_f32 v141, v54, v54
  v_add_f32 v144, v144, v55
  v_fmac_f32 v145, v55, v55
  v_add_f32 v137, v137, v144
  v_add_f32 v141, v141, v145
  s_waitcnt lgkmcnt(5)
  v_lshlrev_b32 v56, 16, v116
  v_and_b32 v57, 0xffff0000, v116
  v_lshlrev_b32 v58, 16, v117
  v_and_b32 v59, 0xffff0000, v117
  v_lshlrev_b32 v60, 16, v118
  v_and_b32 v61, 0xffff0000, v118
  v_lshlrev_b32 v62, 16, v119
  v_and_b32 v63, 0xffff0000, v119
  v_lshlrev_b32 v64, 16, v120
  v_and_b32 v65, 0xffff0000, v120
  v_lshlrev_b32 v66, 16, v121
  v_and_b32 v67, 0xffff0000, v121
  v_lshlrev_b32 v68, 16, v122
  v_and_b32 v69, 0xffff0000, v122
  v_lshlrev_b32 v70, 16, v123
  v_and_b32 v71, 0xffff0000, v123
  v_lshlrev_b32 v72, 16, v124
  v_and_b32 v73, 0xffff0000, v124
  v_lshlrev_b32 v74, 16, v125
  v_and_b32 v75, 0xffff0000, v125
  v_add_f32 v138, v56, v57
  v_mul_f32 v142, v56, v56
  v_add_f32 v144, v58, v59
  v_mul_f32 v145, v57, v57
  v_fmac_f32 v142, v58, v58
  v_fmac_f32 v145, v59, v59
  v_add_f32 v138, v138, v60
  v_fmac_f32 v142, v60, v60
  v_add_f32 v144, v144, v61
  v_fmac_f32 v145, v61, v61
  v_add_f32 v138, v138, v62
  v_fmac_f32 v142, v62, v62
  v_add_f32 v144, v144, v63
  v_fmac_f32 v145, v63, v63
  v_add_f32 v138, v138, v64
  v_fmac_f32 v142, v64, v64
  v_add_f32 v144, v144, v65
  v_fmac_f32 v145, v65, v65
  v_add_f32 v138, v138, v66
  v_fmac_f32 v142, v66, v66
  v_add_f32 v144, v144, v67
  v_fmac_f32 v145, v67, v67
  v_add_f32 v138, v138, v68
  v_fmac_f32 v142, v68, v68
  v_add_f32 v144, v144, v69
  v_fmac_f32 v145, v69, v69
  v_add_f32 v138, v138, v70
  v_fmac_f32 v142, v70, v70
  v_add_f32 v144, v144, v71
  v_fmac_f32 v145, v71, v71
  v_add_f32 v138, v138, v72
  v_fmac_f32 v142, v72, v72
  v_add_f32 v144, v144, v73
  v_fmac_f32 v145, v73, v73
  v_add_f32 v138, v138, v74
  v_fmac_f32 v142, v74, v74
  v_add_f32 v144, v144, v75
  v_fmac_f32 v145, v75, v75
  v_add_f32 v138, v138, v144
  v_add_f32 v142, v142, v145
  s_waitcnt lgkmcnt(0)
  ds_read_b64 v[146:147], v11 offset:0
  ds_read_b64 v[148:149], v11 offset:32
  ds_read_b64 v[150:151], v11 offset:64
  v_lshlrev_b32 v76, 16, v126
  v_and_b32 v77, 0xffff0000, v126
  v_lshlrev_b32 v78, 16, v127
  v_and_b32 v79, 0xffff0000, v127
  v_lshlrev_b32 v80, 16, v128
  v_and_b32 v81, 0xffff0000, v128
  v_lshlrev_b32 v82, 16, v129
  v_and_b32 v83, 0xffff0000, v129
  v_lshlrev_b32 v84, 16, v130
  v_and_b32 v85, 0xffff0000, v130
  v_lshlrev_b32 v86, 16, v131
  v_and_b32 v87, 0xffff0000, v131
  v_lshlrev_b32 v88, 16, v132
  v_and_b32 v89, 0xffff0000, v132
  v_lshlrev_b32 v90, 16, v133
  v_and_b32 v91, 0xffff0000, v133
  v_lshlrev_b32 v92, 16, v134
  v_and_b32 v93, 0xffff0000, v134
  v_lshlrev_b32 v94, 16, v135
  v_and_b32 v95, 0xffff0000, v135
  v_add_f32 v139, v76, v77
  v_mul_f32 v143, v76, v76
  v_add_f32 v144, v78, v79
  v_mul_f32 v145, v77, v77
  v_fmac_f32 v143, v78, v78
  v_fmac_f32 v145, v79, v79
  v_add_f32 v139, v139, v80
  v_fmac_f32 v143, v80, v80
  v_add_f32 v144, v144, v81
  v_fmac_f32 v145, v81, v81
  v_add_f32 v139, v139, v82
  v_fmac_f32 v143, v82, v82
  v_add_f32 v144, v144, v83
  v_fmac_f32 v145, v83, v83
  v_add_f32 v139, v139, v84
  v_fmac_f32 v143, v84, v84
  v_add_f32 v144, v144, v85
  v_fmac_f32 v145, v85, v85
  v_add_f32 v139, v139, v86
  v_fmac_f32 v143, v86, v86
  v_add_f32 v144, v144, v87
  v_fmac_f32 v145, v87, v87
  v_add_f32 v139, v139, v88
  v_fmac_f32 v143, v88, v88
  v_add_f32 v144, v144, v89
  v_fmac_f32 v145, v89, v89
  v_add_f32 v139, v139, v90
  v_fmac_f32 v143, v90, v90
  v_add_f32 v144, v144, v91
  v_fmac_f32 v145, v91, v91
  v_add_f32 v139, v139, v92
  v_fmac_f32 v143, v92, v92
  v_add_f32 v144, v144, v93
  v_fmac_f32 v145, v93, v93
  v_add_f32 v139, v139, v94
  v_fmac_f32 v143, v94, v94
  v_add_f32 v144, v144, v95
  v_fmac_f32 v145, v95, v95
  v_add_f32 v139, v139, v144
  v_add_f32 v143, v143, v145
  v_permlane16_swap_b32 v136, v140
  v_permlane16_swap_b32 v137, v141
  v_permlane16_swap_b32 v138, v142
  v_permlane16_swap_b32 v139, v143
  v_add_f32 v136, v136, v140
  v_add_f32 v137, v137, v141
  v_add_f32 v138, v138, v142
  v_add_f32 v139, v139, v143
  v_add_f32_dpp v136, v136, v136 quad_perm:[1,0,3,2] row_mask:0xf bank_mask:0xf
  v_add_f32_dpp v137, v137, v137 quad_perm:[1,0,3,2] row_mask:0xf bank_mask:0xf
  v_add_f32_dpp v138, v138, v138 quad_perm:[1,0,3,2] row_mask:0xf bank_mask:0xf
  v_add_f32_dpp v139, v139, v139 quad_perm:[1,0,3,2] row_mask:0xf bank_mask:0xf
  v_add_f32_dpp v136, v136, v136 quad_perm:[2,3,0,1] row_mask:0xf bank_mask:0xf
  v_add_f32_dpp v137, v137, v137 quad_perm:[2,3,0,1] row_mask:0xf bank_mask:0xf
  v_add_f32_dpp v138, v138, v138 quad_perm:[2,3,0,1] row_mask:0xf bank_mask:0xf
  v_add_f32_dpp v139, v139, v139 quad_perm:[2,3,0,1] row_mask:0xf bank_mask:0xf
  v_add_f32_dpp v136, v136, v136 row_half_mirror row_mask:0xf bank_mask:0xf
  v_add_f32_dpp v137, v137, v137 row_half_mirror row_mask:0xf bank_mask:0xf
  v_add_f32_dpp v138, v138, v138 row_half_mirror row_mask:0xf bank_mask:0xf
  v_add_f32_dpp v139, v139, v139 row_half_mirror row_mask:0xf bank_mask:0xf
  v_add_f32_dpp v136, v136, v136 row_mirror row_mask:0xf bank_mask:0xf
  v_add_f32_dpp v137, v137, v137 row_mirror row_mask:0xf bank_mask:0xf
  v_add_f32_dpp v138, v138, v138 row_mirror row_mask:0xf bank_mask:0xf
  v_add_f32_dpp v139, v139, v139 row_mirror row_mask:0xf bank_mask:0xf
  v_mov_b32 v140, v136
  v_mov_b32 v141, v137
  v_mov_b32 v142, v138
  v_mov_b32 v143, v139
  v_permlane16_swap_b32 v136, v140
  v_permlane16_swap_b32 v137, v141
  v_permlane16_swap_b32 v138, v142
  v_permlane16_swap_b32 v139, v143
  v_mul_f32 v136, 0x3acccccd, v136
  v_mul_f32 v137, 0x3acccccd, v137
  v_mul_f32 v138, 0x3acccccd, v138
  v_mul_f32 v139, 0x3acccccd, v139
  v_mul_f32 v140, 0x3acccccd, v140
  v_mul_f32 v141, 0x3acccccd, v141
  v_mul_f32 v142, 0x3acccccd, v142
  v_mul_f32 v143, 0x3acccccd, v143
  v_fma_f32 v140, -v136, v136, v140
  v_fma_f32 v141, -v137, v137, v141
  v_fma_f32 v142, -v138, v138, v142
  v_fma_f32 v143, -v139, v139, v143
  v_max_f32 v140, 0, v140
  v_max_f32 v141, 0, v141
  v_max_f32 v142, 0, v142
  v_max_f32 v143, 0, v143
  v_add_f32 v140, 0x3727c5ac, v140
  v_add_f32 v141, 0x3727c5ac, v141
  v_add_f32 v142, 0x3727c5ac, v142
  v_add_f32 v143, 0x3727c5ac, v143
  v_rsq_f32 v140, v140
  v_rsq_f32 v141, v141
  v_rsq_f32 v142, v142
  v_rsq_f32 v143, v143
  v_mul_f32 v136, v136, v140
  v_mul_f32 v137, v137, v141
  v_mul_f32 v138, v138, v142
  v_mul_f32 v139, v139, v143
  v_fma_f32 v16, v16, v140, -v136
  v_fma_f32 v36, v36, v141, -v137
  v_fma_f32 v56, v56, v142, -v138
  v_fma_f32 v76, v76, v143, -v139
  v_fma_f32 v17, v17, v140, -v136
  v_fma_f32 v37, v37, v141, -v137
  v_fma_f32 v57, v57, v142, -v138
  v_fma_f32 v77, v77, v143, -v139
  v_fma_f32 v18, v18, v140, -v136
  v_fma_f32 v38, v38, v141, -v137
  v_fma_f32 v58, v58, v142, -v138
  v_fma_f32 v78, v78, v143, -v139
  v_fma_f32 v19, v19, v140, -v136
  v_fma_f32 v39, v39, v141, -v137
  v_fma_f32 v59, v59, v142, -v138
  v_fma_f32 v79, v79, v143, -v139
  v_fma_f32 v20, v20, v140, -v136
  v_fma_f32 v40, v40, v141, -v137
  v_fma_f32 v60, v60, v142, -v138
  v_fma_f32 v80, v80, v143, -v139
  v_fma_f32 v21, v21, v140, -v136
  v_fma_f32 v41, v41, v141, -v137
  v_fma_f32 v61, v61, v142, -v138
  v_fma_f32 v81, v81, v143, -v139
  v_fma_f32 v22, v22, v140, -v136
  v_fma_f32 v42, v42, v141, -v137
  v_fma_f32 v62, v62, v142, -v138
  v_fma_f32 v82, v82, v143, -v139
  v_fma_f32 v23, v23, v140, -v136
  v_fma_f32 v43, v43, v141, -v137
  v_fma_f32 v63, v63, v142, -v138
  v_fma_f32 v83, v83, v143, -v139
  v_fma_f32 v24, v24, v140, -v136
  v_fma_f32 v44, v44, v141, -v137
  v_fma_f32 v64, v64, v142, -v138
  v_fma_f32 v84, v84, v143, -v139
  v_fma_f32 v25, v25, v140, -v136
  v_fma_f32 v45, v45, v141, -v137
  v_fma_f32 v65, v65, v142, -v138
  v_fma_f32 v85, v85, v143, -v139
  v_fma_f32 v26, v26, v140, -v136
  v_fma_f32 v46, v46, v141, -v137
  v_fma_f32 v66, v66, v142, -v138
  v_fma_f32 v86, v86, v143, -v139
  v_fma_f32 v27, v27, v140, -v136
  v_fma_f32 v47, v47, v141, -v137
  v_fma_f32 v67, v67, v142, -v138
  v_fma_f32 v87, v87, v143, -v139
  v_fma_f32 v28, v28, v140, -v136
  v_fma_f32 v48, v48, v141, -v137
  v_fma_f32 v68, v68, v142, -v138
  v_fma_f32 v88, v88, v143, -v139
  v_fma_f32 v29, v29, v140, -v136
  v_fma_f32 v49, v49, v141, -v137
  v_fma_f32 v69, v69, v142, -v138
  v_fma_f32 v89, v89, v143, -v139
  v_fma_f32 v30, v30, v140, -v136
  v_fma_f32 v50, v50, v141, -v137
  v_fma_f32 v70, v70, v142, -v138
  v_fma_f32 v90, v90, v143, -v139
  v_fma_f32 v31, v31, v140, -v136
  v_fma_f32 v51, v51, v141, -v137
  v_fma_f32 v71, v71, v142, -v138
  v_fma_f32 v91, v91, v143, -v139
  v_fma_f32 v32, v32, v140, -v136
  v_fma_f32 v52, v52, v141, -v137
  v_fma_f32 v72, v72, v142, -v138
  v_fma_f32 v92, v92, v143, -v139
  v_fma_f32 v33, v33, v140, -v136
  v_fma_f32 v53, v53, v141, -v137
  v_fma_f32 v73, v73, v142, -v138
  v_fma_f32 v93, v93, v143, -v139
  v_fma_f32 v34, v34, v140, -v136
  v_fma_f32 v54, v54, v141, -v137
  v_fma_f32 v74, v74, v142, -v138
  v_fma_f32 v94, v94, v143, -v139
  v_fma_f32 v35, v35, v140, -v136
  v_fma_f32 v55, v55, v141, -v137
  v_fma_f32 v75, v75, v142, -v138
  v_fma_f32 v95, v95, v143, -v139
  v_and_b32 v136, 15, v1
  v_lshrrev_b32 v137, 4, v1
  v_add_u32 v138, 0, v137
  v_xor_b32 v139, v136, v138
  v_lshlrev_b32 v139, 4, v139
  v_lshl_add_u32 v4, v138, 10, v139
  v_add_u32 v6, 0x10000, v4
  v_add_u32 v138, 4, v137
  v_xor_b32 v139, v136, v138
  v_lshlrev_b32 v139, 4, v139
  v_lshl_add_u32 v5, v138, 10, v139
  v_add_u32 v7, 0x10000, v5
  s_lshl_b32 s78, s46, 1
  s_cmp_ge_u32 s46, 4
  s_cselect_b32 s50, 2, 0
  s_add_u32 s78, s78, s50
  s_add_u32 s79, s78, 1
  s_add_u32 s50, s46, 2
  s_cmp_ge_u32 s46, 6
  s_cselect_b32 s78, s50, s78
  s_cselect_b32 s79, 14, s79
  s_lshl_b32 s50, s78, 10
  v_add_u32 v8, s50, v2
  s_lshl_b32 s50, s79, 10
  s_cmp_eq_u32 s46, 7
  s_cselect_b32 s50, 0x40000000, s50
  v_add_u32 v9, s50, v2
  s_mul_i32 s51, s45, 307200
  s_add_u32 s51, s51, 1048576
  s_mov_b32 s31, s51
  s_mov_b32 s30, 15360
  s_mov_b32 s40, s28
  s_mov_b32 s41, s29
  s_mov_b32 s42, 33554432
  s_mov_b32 s43, 0x20000
  s_cmp_lt_u32 s46, 5
  s_cbranch_scc0 L_w_12
  v_lshlrev_b32 v10, 4, v0
  s_mov_b32 s61, 0
  s_mov_b32 s60, 0x0c0c0400
L_tl_13:
  s_mov_b32 s52, 45056
  buffer_load_dwordx4 v[96:99], v10, s[32:35], s52 offen sc1
  s_mov_b32 s52, 50176
  buffer_load_dwordx4 v[100:103], v10, s[32:35], s52 offen sc1
  s_mov_b32 s52, 55296
  buffer_load_dwordx4 v[104:107], v10, s[32:35], s52 offen sc1
  s_mov_b32 s52, 60416
  buffer_load_dwordx4 v[108:111], v10, s[32:35], s52 offen sc1
  s_waitcnt vmcnt(0)
L_tc_15:
  v_perm_b32 v12, v97, v96, s60
  v_perm_b32 v13, v99, v98, s60
  v_lshl_or_b32 v12, v13, 16, v12
  v_cmp_ne_u32 vcc, s47, v12
  v_perm_b32 v12, v101, v100, s60
  v_perm_b32 v13, v103, v102, s60
  v_lshl_or_b32 v12, v13, 16, v12
  v_cmp_ne_u32 s[58:59], s47, v12
  s_nop 1
  s_or_b64 vcc, vcc, s[58:59]
  v_perm_b32 v12, v105, v104, s60
  v_perm_b32 v13, v107, v106, s60
  v_lshl_or_b32 v12, v13, 16, v12
  v_cmp_ne_u32 s[58:59], s47, v12
  s_nop 1
  s_or_b64 vcc, vcc, s[58:59]
  v_perm_b32 v12, v109, v108, s60
  v_perm_b32 v13, v111, v110, s60
  v_lshl_or_b32 v12, v13, 16, v12
  v_cmp_ne_u32 s[58:59], s47, v12
  s_nop 1
  s_or_b64 vcc, vcc, s[58:59]
  s_cmp_eq_u64 vcc, 0
  s_cbranch_scc1 L_td_14
  s_add_u32 s61, s61, 1
  s_cmp_lt_u32 s61, 40000
  s_cbranch_scc1 L_tl_13
L_td_14:
  v_and_b32 v96, 0xffffff00, v96
  v_and_b32 v97, 0xffffff00, v97
  v_and_b32 v98, 0xffffff00, v98
  v_and_b32 v99, 0xffffff00, v99
  v_and_b32 v100, 0xffffff00, v100
  v_and_b32 v101, 0xffffff00, v101
  v_and_b32 v102, 0xffffff00, v102
  v_and_b32 v103, 0xffffff00, v103
  v_and_b32 v104, 0xffffff00, v104
  v_and_b32 v105, 0xffffff00, v105
  v_and_b32 v106, 0xffffff00, v106
  v_and_b32 v107, 0xffffff00, v107
  v_and_b32 v108, 0xffffff00, v108
  v_and_b32 v109, 0xffffff00, v109
  v_and_b32 v110, 0xffffff00, v110
  v_and_b32 v111, 0xffffff00, v111
  v_add_f32 v96, v96, v100
  v_add_f32 v97, v97, v101
  v_add_f32 v98, v98, v102
  v_add_f32 v99, v99, v103
  v_add_f32 v96, v96, v104
  v_add_f32 v97, v97, v105
  v_add_f32 v98, v98, v106
  v_add_f32 v99, v99, v107
  v_add_f32 v96, v96, v108
  v_add_f32 v97, v97, v109
  v_add_f32 v98, v98, v110
  v_add_f32 v99, v99, v111
  s_movk_i32 s60, 160
  v_cmp_le_u32 s[58:59], s60, v0
  v_mov_b32 v136, 0
  v_mov_b32 v137, 1.0
  v_cndmask_b32 v136, v136, v137, s[58:59]
  v_lshlrev_b32 v137, 4, v0
  v_add_u32 v138, 84480, v137
  v_add_u32 v137, 79360, v137
  v_cndmask_b32 v137, v138, v137, s[58:59]
  v_cvt_pk_bf16_f32 v138, v96, v97
  v_cvt_pk_bf16_f32 v139, v98, v99
  v_lshlrev_b32 v96, 16, v138
  v_and_b32 v97, 0xffff0000, v138
  v_lshlrev_b32 v98, 16, v139
  v_and_b32 v99, 0xffff0000, v139
  v_add_f32 v96, v96, v136
  v_add_f32 v97, v97, v136
  v_add_f32 v98, v98, v136
  v_add_f32 v99, v99, v136
  v_cvt_pk_bf16_f32 v138, v96, v97
  v_cvt_pk_bf16_f32 v139, v98, v99
  v_lshlrev_b32 v96, 16, v138
  v_and_b32 v97, 0xffff0000, v138
  v_lshlrev_b32 v98, 16, v139
  v_and_b32 v99, 0xffff0000, v139
  ds_write_b128 v137, v[96:99]
L_w_12:
  s_cmp_eq_u32 s46, 7
  s_cbranch_scc0 L_w_16
  s_lshl_b32 s50, s45, 12
  s_add_u32 s50, s50, 786432
  v_min_u32 v11, 49, v1
  v_mul_u32_u24 v10, 52, v11
  v_lshrrev_b32 v10, 8, v10
  v_mul_u32_u24 v10, 108, v10
  v_lshl_add_u32 v10, v11, 2, v10
  v_add_u32 v10, s50, v10
  v_add_u32 v11, 1280, v10
  s_mov_b32 s61, 0
L_poll_17:
  buffer_load_dword v12, v10, s[32:35], 0 offen sc1
  buffer_load_dword v13, v11, s[32:35], 0 offen sc1
L_pchk_19:
  s_waitcnt vmcnt(0)
  v_cmp_ne_u32 vcc, s47, v12
  v_cmp_ne_u32 s[58:59], s47, v13
  s_nop 1
  s_or_b64 vcc, vcc, s[58:59]
  s_cmp_eq_u64 vcc, 0
  s_cbranch_scc1 L_pdone_18
  s_add_u32 s61, s61, 1
  s_cmp_lt_u32 s61, 40000
  s_cbranch_scc1 L_poll_17
L_pdone_18:
L_w_16:
  s_waitcnt lgkmcnt(0)
  s_barrier
  ds_read_b128 v[96:99], v156 offset:0
  ds_read_b128 v[100:103], v156 offset:2560
  ds_read_b128 v[104:107], v156 offset:512
  ds_read_b128 v[108:111], v156 offset:3072
  ds_read_b128 v[112:115], v156 offset:1024
  ds_read_b128 v[116:119], v156 offset:3584
  ds_read_b128 v[120:123], v156 offset:1536
  ds_read_b128 v[124:127], v156 offset:4096
  ds_read_b128 v[128:131], v156 offset:2048
  ds_read_b128 v[132:135], v156 offset:4608
  buffer_load_dwordx4 v[160:163], v8, s[32:35], s51 offen sc1
  buffer_load_dwordx4 v[164:167], v9, s[40:43], s31 offen sc1
  s_add_u32 s51, s51, 15360
  s_add_u32 s31, s31, s30
  buffer_load_dwordx4 v[168:171], v8, s[32:35], s51 offen sc1
  buffer_load_dwordx4 v[172:175], v9, s[40:43], s31 offen sc1
  s_add_u32 s51, s51, 15360
  s_add_u32 s31, s31, s30
  s_waitcnt lgkmcnt(8)
  v_fma_f32 v16, v16, v96, v100
  v_fma_f32 v17, v17, v97, v101
  v_fma_f32 v18, v18, v98, v102
  v_fma_f32 v19, v19, v99, v103
  v_fma_f32 v36, v36, v96, v100
  v_fma_f32 v37, v37, v97, v101
  v_fma_f32 v38, v38, v98, v102
  v_fma_f32 v39, v39, v99, v103
  v_fma_f32 v56, v56, v96, v100
  v_fma_f32 v57, v57, v97, v101
  v_fma_f32 v58, v58, v98, v102
  v_fma_f32 v59, v59, v99, v103
  v_fma_f32 v76, v76, v96, v100
  v_fma_f32 v77, v77, v97, v101
  v_fma_f32 v78, v78, v98, v102
  v_fma_f32 v79, v79, v99, v103
  v_cvt_pk_bf16_f32 v136, v16, v17
  v_cvt_pk_bf16_f32 v137, v18, v19
  ds_write_b64 v152, v[136:137] offset:0
  v_cvt_pk_bf16_f32 v138, v36, v37
  v_cvt_pk_bf16_f32 v139, v38, v39
  ds_write_b64 v153, v[138:139] offset:0
  v_cvt_pk_bf16_f32 v140, v56, v57
  v_cvt_pk_bf16_f32 v141, v58, v59
  ds_write_b64 v154, v[140:141] offset:0
  v_cvt_pk_bf16_f32 v142, v76, v77
  v_cvt_pk_bf16_f32 v143, v78, v79
  ds_write_b64 v155, v[142:143] offset:0
  buffer_load_dwordx4 v[176:179], v8, s[32:35], s51 offen sc1
  buffer_load_dwordx4 v[180:183], v9, s[40:43], s31 offen sc1
  s_add_u32 s51, s51, 15360
  s_add_u32 s31, s31, s30
  s_waitcnt lgkmcnt(10)
  v_fma_f32 v20, v20, v104, v108
  v_fma_f32 v21, v21, v105, v109
  v_fma_f32 v22, v22, v106, v110
  v_fma_f32 v23, v23, v107, v111
  v_fma_f32 v40, v40, v104, v108
  v_fma_f32 v41, v41, v105, v109
  v_fma_f32 v42, v42, v106, v110
  v_fma_f32 v43, v43, v107, v111
  v_fma_f32 v60, v60, v104, v108
  v_fma_f32 v61, v61, v105, v109
  v_fma_f32 v62, v62, v106, v110
  v_fma_f32 v63, v63, v107, v111
  v_fma_f32 v80, v80, v104, v108
  v_fma_f32 v81, v81, v105, v109
  v_fma_f32 v82, v82, v106, v110
  v_fma_f32 v83, v83, v107, v111
  v_cvt_pk_bf16_f32 v136, v20, v21
  v_cvt_pk_bf16_f32 v137, v22, v23
  ds_write_b64 v152, v[136:137] offset:16384
  v_cvt_pk_bf16_f32 v138, v40, v41
  v_cvt_pk_bf16_f32 v139, v42, v43
  ds_write_b64 v153, v[138:139] offset:16384
  v_cvt_pk_bf16_f32 v140, v60, v61
  v_cvt_pk_bf16_f32 v141, v62, v63
  ds_write_b64 v154, v[140:141] offset:16384
  v_cvt_pk_bf16_f32 v142, v80, v81
  v_cvt_pk_bf16_f32 v143, v82, v83
  ds_write_b64 v155, v[142:143] offset:16384
  buffer_load_dwordx4 v[184:187], v8, s[32:35], s51 offen sc1
  buffer_load_dwordx4 v[188:191], v9, s[40:43], s31 offen sc1
  s_add_u32 s51, s51, 15360
  s_add_u32 s31, s31, s30
  s_waitcnt lgkmcnt(12)
  v_fma_f32 v24, v24, v112, v116
  v_fma_f32 v25, v25, v113, v117
  v_fma_f32 v26, v26, v114, v118
  v_fma_f32 v27, v27, v115, v119
  v_fma_f32 v44, v44, v112, v116
  v_fma_f32 v45, v45, v113, v117
  v_fma_f32 v46, v46, v114, v118
  v_fma_f32 v47, v47, v115, v119
  v_fma_f32 v64, v64, v112, v116
  v_fma_f32 v65, v65, v113, v117
  v_fma_f32 v66, v66, v114, v118
  v_fma_f32 v67, v67, v115, v119
  v_fma_f32 v84, v84, v112, v116
  v_fma_f32 v85, v85, v113, v117
  v_fma_f32 v86, v86, v114, v118
  v_fma_f32 v87, v87, v115, v119
  v_cvt_pk_bf16_f32 v136, v24, v25
  v_cvt_pk_bf16_f32 v137, v26, v27
  ds_write_b64 v152, v[136:137] offset:32768
  v_cvt_pk_bf16_f32 v138, v44, v45
  v_cvt_pk_bf16_f32 v139, v46, v47
  ds_write_b64 v153, v[138:139] offset:32768
  v_cvt_pk_bf16_f32 v140, v64, v65
  v_cvt_pk_bf16_f32 v141, v66, v67
  ds_write_b64 v154, v[140:141] offset:32768
  v_cvt_pk_bf16_f32 v142, v84, v85
  v_cvt_pk_bf16_f32 v143, v86, v87
  ds_write_b64 v155, v[142:143] offset:32768
  buffer_load_dwordx4 v[192:195], v8, s[32:35], s51 offen sc1
  buffer_load_dwordx4 v[196:199], v9, s[40:43], s31 offen sc1
  s_add_u32 s51, s51, 15360
  s_add_u32 s31, s31, s30
  s_waitcnt lgkmcnt(14)
  v_fma_f32 v28, v28, v120, v124
  v_fma_f32 v29, v29, v121, v125
  v_fma_f32 v30, v30, v122, v126
  v_fma_f32 v31, v31, v123, v127
  v_fma_f32 v48, v48, v120, v124
  v_fma_f32 v49, v49, v121, v125
  v_fma_f32 v50, v50, v122, v126
  v_fma_f32 v51, v51, v123, v127
  v_fma_f32 v68, v68, v120, v124
  v_fma_f32 v69, v69, v121, v125
  v_fma_f32 v70, v70, v122, v126
  v_fma_f32 v71, v71, v123, v127
  v_fma_f32 v88, v88, v120, v124
  v_fma_f32 v89, v89, v121, v125
  v_fma_f32 v90, v90, v122, v126
  v_fma_f32 v91, v91, v123, v127
  v_cvt_pk_bf16_f32 v136, v28, v29
  v_cvt_pk_bf16_f32 v137, v30, v31
  ds_write_b64 v152, v[136:137] offset:49152
  v_cvt_pk_bf16_f32 v138, v48, v49
  v_cvt_pk_bf16_f32 v139, v50, v51
  ds_write_b64 v153, v[138:139] offset:49152
  v_cvt_pk_bf16_f32 v140, v68, v69
  v_cvt_pk_bf16_f32 v141, v70, v71
  ds_write_b64 v154, v[140:141] offset:49152
  v_cvt_pk_bf16_f32 v142, v88, v89
  v_cvt_pk_bf16_f32 v143, v90, v91
  ds_write_b64 v155, v[142:143] offset:49152
  buffer_load_dwordx4 v[200:203], v8, s[32:35], s51 offen sc1
  buffer_load_dwordx4 v[204:207], v9, s[40:43], s31 offen sc1
  s_add_u32 s51, s51, 15360
  s_add_u32 s31, s31, s30
  s_waitcnt lgkmcnt(15)
  v_add_u32 v152, 0x10000, v152
  v_add_u32 v153, 0x10000, v153
  v_add_u32 v154, 0x10000, v154
  v_add_u32 v155, 0x10000, v155
  v_fma_f32 v32, v32, v128, v132
  v_fma_f32 v33, v33, v129, v133
  v_fma_f32 v34, v34, v130, v134
  v_fma_f32 v35, v35, v131, v135
  v_fma_f32 v52, v52, v128, v132
  v_fma_f32 v53, v53, v129, v133
  v_fma_f32 v54, v54, v130, v134
  v_fma_f32 v55, v55, v131, v135
  v_fma_f32 v72, v72, v128, v132
  v_fma_f32 v73, v73, v129, v133
  v_fma_f32 v74, v74, v130, v134
  v_fma_f32 v75, v75, v131, v135
  v_fma_f32 v92, v92, v128, v132
  v_fma_f32 v93, v93, v129, v133
  v_fma_f32 v94, v94, v130, v134
  v_fma_f32 v95, v95, v131, v135
  v_cvt_pk_bf16_f32 v136, v32, v33
  v_cvt_pk_bf16_f32 v137, v34, v35
  ds_write_b64 v152, v[136:137] offset:0
  v_cvt_pk_bf16_f32 v138, v52, v53
  v_cvt_pk_bf16_f32 v139, v54, v55
  ds_write_b64 v153, v[138:139] offset:0
  v_cvt_pk_bf16_f32 v140, v72, v73
  v_cvt_pk_bf16_f32 v141, v74, v75
  ds_write_b64 v154, v[140:141] offset:0
  v_cvt_pk_bf16_f32 v142, v92, v93
  v_cvt_pk_bf16_f32 v143, v94, v95
  ds_write_b64 v155, v[142:143] offset:0
  v_mov_b32 v10, v146
  v_mov_b32 v11, v147
  v_mov_b32 v12, v148
  v_mov_b32 v13, v149
  v_mov_b32 v14, v150
  v_mov_b32 v15, v151
  s_waitcnt lgkmcnt(0)
  s_barrier
  ds_read_b128 v[48:51], v4 offset:0
  ds_read_b128 v[52:55], v4 offset:256
  ds_read_b128 v[56:59], v4 offset:512
  ds_read_b128 v[60:63], v4 offset:768
  s_cmp_ge_u32 s46, 6
  s_cbranch_scc1 L_g6_20
  s_waitcnt vmcnt(10) lgkmcnt(3)
  v_mfma_f32_16x16x32_bf16 v[16:19], v[160:163], v[48:51], 0
  ds_read_b128 v[64:67], v5 offset:0
  v_mfma_f32_16x16x32_bf16 v[32:35], v[164:167], v[48:51], 0
  buffer_load_dwordx4 v[208:211], v8, s[32:35], s51 offen sc1
  s_waitcnt lgkmcnt(3)
  v_mfma_f32_16x16x32_bf16 v[20:23], v[160:163], v[52:55], 0
  ds_read_b128 v[68:71], v5 offset:256
  v_mfma_f32_16x16x32_bf16 v[36:39], v[164:167], v[52:55], 0
  buffer_load_dwordx4 v[212:215], v9, s[40:43], s31 offen sc1
  s_add_u32 s51, s51, 15360
  s_add_u32 s31, s31, s30
  s_waitcnt lgkmcnt(3)
  v_mfma_f32_16x16x32_bf16 v[24:27], v[160:163], v[56:59], 0
  ds_read_b128 v[72:75], v5 offset:512
  v_mfma_f32_16x16x32_bf16 v[40:43], v[164:167], v[56:59], 0
  s_waitcnt lgkmcnt(3)
  v_mfma_f32_16x16x32_bf16 v[28:31], v[160:163], v[60:63], 0
  ds_read_b128 v[76:79], v5 offset:768
  v_mfma_f32_16x16x32_bf16 v[44:47], v[164:167], v[60:63], 0
  s_waitcnt vmcnt(10) lgkmcnt(3)
  v_mfma_f32_16x16x32_bf16 v[16:19], v[168:171], v[64:67], v[16:19]
  ds_read_b128 v[48:51], v4 offset:8192
  v_mfma_f32_16x16x32_bf16 v[32:35], v[172:175], v[64:67], v[32:35]
  buffer_load_dwordx4 v[216:219], v8, s[32:35], s51 offen sc1
  s_waitcnt lgkmcnt(3)
  v_mfma_f32_16x16x32_bf16 v[20:23], v[168:171], v[68:71], v[20:23]
  ds_read_b128 v[52:55], v4 offset:8448
  v_mfma_f32_16x16x32_bf16 v[36:39], v[172:175], v[68:71], v[36:39]
  buffer_load_dwordx4 v[220:223], v9, s[40:43], s31 offen sc1
  s_add_u32 s51, s51, 15360
  s_add_u32 s31, s31, s30
  s_waitcnt lgkmcnt(3)
  v_mfma_f32_16x16x32_bf16 v[24:27], v[168:171], v[72:75], v[24:27]
  ds_read_b128 v[56:59], v4 offset:8704
  v_mfma_f32_16x16x32_bf16 v[40:43], v[172:175], v[72:75], v[40:43]
  s_waitcnt lgkmcnt(3)
  v_mfma_f32_16x16x32_bf16 v[28:31], v[168:171], v[76:79], v[28:31]
  ds_read_b128 v[60:63], v4 offset:8960
  v_mfma_f32_16x16x32_bf16 v[44:47], v[172:175], v[76:79], v[44:47]
  s_waitcnt vmcnt(10) lgkmcnt(3)
  v_mfma_f32_16x16x32_bf16 v[16:19], v[176:179], v[48:51], v[16:19]
  ds_read_b128 v[64:67], v5 offset:8192
  v_mfma_f32_16x16x32_bf16 v[32:35], v[180:183], v[48:51], v[32:35]
  buffer_load_dwordx4 v[224:227], v8, s[32:35], s51 offen sc1
  s_waitcnt lgkmcnt(3)
  v_mfma_f32_16x16x32_bf16 v[20:23], v[176:179], v[52:55], v[20:23]
  ds_read_b128 v[68:71], v5 offset:8448
  v_mfma_f32_16x16x32_bf16 v[36:39], v[180:183], v[52:55], v[36:39]
  buffer_load_dwordx4 v[228:231], v9, s[40:43], s31 offen sc1
  s_add_u32 s51, s51, 15360
  s_add_u32 s31, s31, s30
  s_waitcnt lgkmcnt(3)
  v_mfma_f32_16x16x32_bf16 v[24:27], v[176:179], v[56:59], v[24:27]
  ds_read_b128 v[72:75], v5 offset:8704
  v_mfma_f32_16x16x32_bf16 v[40:43], v[180:183], v[56:59], v[40:43]
  v_and_b32 v88, 15, v1
  v_lshrrev_b32 v89, 4, v1
  s_waitcnt lgkmcnt(3)
  v_mfma_f32_16x16x32_bf16 v[28:31], v[176:179], v[60:63], v[28:31]
  ds_read_b128 v[76:79], v5 offset:8960
  v_mfma_f32_16x16x32_bf16 v[44:47], v[180:183], v[60:63], v[44:47]
  s_mov_b32 s64, s78
  s_mul_i32 s65, s64, 52
  s_lshr_b32 s65, s65, 8
  s_mul_i32 s66, s65, 5
  s_sub_u32 s66, s64, s66
  s_lshl_b32 s66, s66, 2
  s_cmp_ge_u32 s65, 2
  s_mov_b32 s67, 2816
  s_cmov_b32 s67, 1280
  s_mov_b32 s68, 90112
  s_cmov_b32 s68, 112640
  s_mov_b32 s69, 11264
  s_cmov_b32 s69, 5120
  s_cmp_eq_u32 s65, 1
  s_cselect_b64 s[70:71], -1, 0
  v_add_u32 v90, s66, v89
  v_mul_u32_u24 v91, 52, v90
  s_waitcnt vmcnt(10) lgkmcnt(3)
  v_mfma_f32_16x16x32_bf16 v[16:19], v[184:187], v[64:67], v[16:19]
  ds_read_b128 v[48:51], v4 offset:16384
  v_mfma_f32_16x16x32_bf16 v[32:35], v[188:191], v[64:67], v[32:35]
  buffer_load_dwordx4 v[232:235], v8, s[32:35], s51 offen sc1
  s_waitcnt lgkmcnt(3)
  v_mfma_f32_16x16x32_bf16 v[20:23], v[184:187], v[68:71], v[20:23]
  ds_read_b128 v[52:55], v4 offset:16640
  v_mfma_f32_16x16x32_bf16 v[36:39], v[188:191], v[68:71], v[36:39]
  buffer_load_dwordx4 v[236:239], v9, s[40:43], s31 offen sc1
  s_add_u32 s51, s51, 15360
  s_add_u32 s31, s31, s30
  s_waitcnt lgkmcnt(3)
  v_mfma_f32_16x16x32_bf16 v[24:27], v[184:187], v[72:75], v[24:27]
  ds_read_b128 v[56:59], v4 offset:16896
  v_mfma_f32_16x16x32_bf16 v[40:43], v[188:191], v[72:75], v[40:43]
  v_lshrrev_b32 v91, 8, v91
  v_mul_u32_u24 v92, 5, v91
  s_waitcnt lgkmcnt(3)
  v_mfma_f32_16x16x32_bf16 v[28:31], v[184:187], v[76:79], v[28:31]
  ds_read_b128 v[60:63], v4 offset:17152
  v_mfma_f32_16x16x32_bf16 v[44:47], v[188:191], v[76:79], v[44:47]
  v_sub_u32 v92, v90, v92
  v_mul_u32_u24 v91, s67, v91
  s_waitcnt vmcnt(10) lgkmcnt(3)
  v_mfma_f32_16x16x32_bf16 v[16:19], v[192:195], v[48:51], v[16:19]
  ds_read_b128 v[64:67], v5 offset:16384
  v_mfma_f32_16x16x32_bf16 v[32:35], v[196:199], v[48:51], v[32:35]
  v_add_u32 v91, s68, v91
  v_lshrrev_b32 v93, 1, v92
  s_waitcnt lgkmcnt(3)
  v_mfma_f32_16x16x32_bf16 v[20:23], v[192:195], v[52:55], v[20:23]
  ds_read_b128 v[68:71], v5 offset:16640
  v_mfma_f32_16x16x32_bf16 v[36:39], v[196:199], v[52:55], v[36:39]
  v_lshlrev_b32 v93, 9, v93
  v_and_b32 v94, 1, v92
  s_waitcnt lgkmcnt(3)
  v_mfma_f32_16x16x32_bf16 v[24:27], v[192:195], v[56:59], v[24:27]
  ds_read_b128 v[72:75], v5 offset:16896
  v_mfma_f32_16x16x32_bf16 v[40:43], v[196:199], v[56:59], v[40:43]
  v_lshl_add_u32 v93, v94, 3, v93
  v_lshlrev_b32 v94, 3, v92
  s_waitcnt lgkmcnt(3)
  v_mfma_f32_16x16x32_bf16 v[28:31], v[192:195], v[60:63], v[28:31]
  ds_read_b128 v[76:79], v5 offset:17152
  v_mfma_f32_16x16x32_bf16 v[44:47], v[196:199], v[60:63], v[44:47]
  v_add_u32 v94, 1280, v94
  v_cndmask_b32 v93, v93, v94, s[70:71]
  s_waitcnt vmcnt(8) lgkmcnt(3)
  v_mfma_f32_16x16x32_bf16 v[16:19], v[200:203], v[64:67], v[16:19]
  ds_read_b128 v[48:51], v4 offset:24576
  v_mfma_f32_16x16x32_bf16 v[32:35], v[204:207], v[64:67], v[32:35]
  buffer_load_dwordx4 v[240:243], v8, s[32:35], s51 offen sc1
  s_waitcnt lgkmcnt(3)
  v_mfma_f32_16x16x32_bf16 v[20:23], v[200:203], v[68:71], v[20:23]
  ds_read_b128 v[52:55], v4 offset:24832
  v_mfma_f32_16x16x32_bf16 v[36:39], v[204:207], v[68:71], v[36:39]
  buffer_load_dwordx4 v[244:247], v9, s[40:43], s31 offen sc1
  s_add_u32 s51, s51, 15360
  s_add_u32 s31, s31, s30
  s_waitcnt lgkmcnt(3)
  v_mfma_f32_16x16x32_bf16 v[24:27], v[200:203], v[72:75], v[24:27]
  ds_read_b128 v[56:59], v4 offset:25088
  v_mfma_f32_16x16x32_bf16 v[40:43], v[204:207], v[72:75], v[40:43]
  v_add_u32 v91, v91, v93
  v_cmp_eq_u32 s[72:73], 4, v92
  s_waitcnt lgkmcnt(3)
  v_mfma_f32_16x16x32_bf16 v[28:31], v[200:203], v[76:79], v[28:31]
  ds_read_b128 v[60:63], v4 offset:25344
  v_mfma_f32_16x16x32_bf16 v[44:47], v[204:207], v[76:79], v[44:47]
  v_mov_b32 v93, 16
  v_mov_b32 v94, 8
  s_waitcnt vmcnt(8) lgkmcnt(3)
  v_mfma_f32_16x16x32_bf16 v[16:19], v[208:211], v[48:51], v[16:19]
  ds_read_b128 v[64:67], v5 offset:24576
  v_mfma_f32_16x16x32_bf16 v[32:35], v[212:215], v[48:51], v[32:35]
  buffer_load_dwordx4 v[248:251], v8, s[32:35], s51 offen sc1
  s_waitcnt lgkmcnt(3)
  v_mfma_f32_16x16x32_bf16 v[20:23], v[208:211], v[52:55], v[20:23]
  ds_read_b128 v[68:71], v5 offset:24832
  v_mfma_f32_16x16x32_bf16 v[36:39], v[212:215], v[52:55], v[36:39]
  buffer_load_dwordx4 v[252:255], v9, s[40:43], s31 offen sc1
  s_add_u32 s51, s51, 15360
  s_add_u32 s31, s31, s30
  s_waitcnt lgkmcnt(3)
  v_mfma_f32_16x16x32_bf16 v[24:27], v[208:211], v[56:59], v[24:27]
  ds_read_b128 v[72:75], v5 offset:25088
  v_mfma_f32_16x16x32_bf16 v[40:43], v[212:215], v[56:59], v[40:43]
  v_cndmask_b32 v93, v93, v94, s[72:73]
  v_mov_b32 v94, 48
  s_waitcnt lgkmcnt(3)
  v_mfma_f32_16x16x32_bf16 v[28:31], v[208:211], v[60:63], v[28:31]
  ds_read_b128 v[76:79], v5 offset:25344
  v_mfma_f32_16x16x32_bf16 v[44:47], v[212:215], v[60:63], v[44:47]
  v_cndmask_b32 v93, v93, v94, s[70:71]
  v_mad_u32_u24 v80, v88, v93, v91
  s_waitcnt vmcnt(8) lgkmcnt(3)
  v_mfma_f32_16x16x32_bf16 v[16:19], v[216:219], v[64:67], v[16:19]
  ds_read_b128 v[48:51], v4 offset:32768
  v_mfma_f32_16x16x32_bf16 v[32:35], v[220:223], v[64:67], v[32:35]
  buffer_load_dwordx4 v[96:99], v8, s[32:35], s51 offen sc1
  s_waitcnt lgkmcnt(3)
  v_mfma_f32_16x16x32_bf16 v[20:23], v[216:219], v[68:71], v[20:23]
  ds_read_b128 v[52:55], v4 offset:33024
  v_mfma_f32_16x16x32_bf16 v[36:39], v[220:223], v[68:71], v[36:39]
  buffer_load_dwordx4 v[100:103], v9, s[40:43], s31 offen sc1
  s_add_u32 s51, s51, 15360
  s_add_u32 s31, s31, s30
  s_waitcnt lgkmcnt(3)
  v_mfma_f32_16x16x32_bf16 v[24:27], v[216:219], v[72:75], v[24:27]
  ds_read_b128 v[56:59], v4 offset:33280
  v_mfma_f32_16x16x32_bf16 v[40:43], v[220:223], v[72:75], v[40:43]
  v_lshl_add_u32 v81, v93, 4, v80
  v_add_u32 v82, s69, v80
  s_waitcnt lgkmcnt(3)
  v_mfma_f32_16x16x32_bf16 v[28:31], v[216:219], v[76:79], v[28:31]
  ds_read_b128 v[60:63], v4 offset:33536
  v_mfma_f32_16x16x32_bf16 v[44:47], v[220:223], v[76:79], v[44:47]
  v_add_u32 v83, s69, v81
  s_mov_b32 s64, s79
  s_mul_i32 s65, s64, 52
  s_lshr_b32 s65, s65, 8
  s_mul_i32 s66, s65, 5
  s_sub_u32 s66, s64, s66
  s_lshl_b32 s66, s66, 2
  s_cmp_ge_u32 s65, 2
  s_mov_b32 s67, 2816
  s_cmov_b32 s67, 1280
  s_mov_b32 s68, 90112
  s_cmov_b32 s68, 112640
  s_mov_b32 s69, 11264
  s_cmov_b32 s69, 5120
  s_cmp_eq_u32 s65, 1
  s_cselect_b64 s[70:71], -1, 0
  v_add_u32 v90, s66, v89
  s_waitcnt vmcnt(8) lgkmcnt(3)
  v_mfma_f32_16x16x32_bf16 v[16:19], v[224:227], v[48:51], v[16:19]
  ds_read_b128 v[64:67], v5 offset:32768
  v_mfma_f32_16x16x32_bf16 v[32:35], v[228:231], v[48:51], v[32:35]
  buffer_load_dwordx4 v[104:107], v8, s[32:35], s51 offen sc1
  s_waitcnt lgkmcnt(3)
  v_mfma_f32_16x16x32_bf16 v[20:23], v[224:227], v[52:55], v[20:23]
  ds_read_b128 v[68:71], v5 offset:33024
  v_mfma_f32_16x16x32_bf16 v[36:39], v[228:231], v[52:55], v[36:39]
  buffer_load_dwordx4 v[108:111], v9, s[40:43], s31 offen sc1
  s_add_u32 s51, s51, 15360
  s_add_u32 s31, s31, s30
  s_waitcnt lgkmcnt(3)
  v_mfma_f32_16x16x32_bf16 v[24:27], v[224:227], v[56:59], v[24:27]
  ds_read_b128 v[72:75], v5 offset:33280
  v_mfma_f32_16x16x32_bf16 v[40:43], v[228:231], v[56:59], v[40:43]
  v_mul_u32_u24 v91, 52, v90
  v_lshrrev_b32 v91, 8, v91
  s_waitcnt lgkmcnt(3)
  v_mfma_f32_16x16x32_bf16 v[28:31], v[224:227], v[60:63], v[28:31]
  ds_read_b128 v[76:79], v5 offset:33536
  v_mfma_f32_16x16x32_bf16 v[44:47], v[228:231], v[60:63], v[44:47]
  v_mul_u32_u24 v92, 5, v91
  v_sub_u32 v92, v90, v92
  s_waitcnt vmcnt(8) lgkmcnt(3)
  v_mfma_f32_16x16x32_bf16 v[16:19], v[232:235], v[64:67], v[16:19]
  ds_read_b128 v[48:51], v4 offset:40960
  v_mfma_f32_16x16x32_bf16 v[32:35], v[236:239], v[64:67], v[32:35]
  v_mul_u32_u24 v91, s67, v91
  v_add_u32 v91, s68, v91
  s_waitcnt lgkmcnt(3)
  v_mfma_f32_16x16x32_bf16 v[20:23], v[232:235], v[68:71], v[20:23]
  ds_read_b128 v[52:55], v4 offset:41216
  v_mfma_f32_16x16x32_bf16 v[36:39], v[236:239], v[68:71], v[36:39]
  v_lshrrev_b32 v93, 1, v92
  v_lshlrev_b32 v93, 9, v93
  s_waitcnt lgkmcnt(3)
  v_mfma_f32_16x16x32_bf16 v[24:27], v[232:235], v[72:75], v[24:27]
  ds_read_b128 v[56:59], v4 offset:41472
  v_mfma_f32_16x16x32_bf16 v[40:43], v[236:239], v[72:75], v[40:43]
  v_and_b32 v94, 1, v92
  v_lshl_add_u32 v93, v94, 3, v93
  s_waitcnt lgkmcnt(3)
  v_mfma_f32_16x16x32_bf16 v[28:31], v[232:235], v[76:79], v[28:31]
  ds_read_b128 v[60:63], v4 offset:41728
  v_mfma_f32_16x16x32_bf16 v[44:47], v[236:239], v[76:79], v[44:47]
  v_lshlrev_b32 v94, 3, v92
  v_add_u32 v94, 1280, v94
  s_waitcnt vmcnt(6) lgkmcnt(3)
  v_mfma_f32_16x16x32_bf16 v[16:19], v[240:243], v[48:51], v[16:19]
  ds_read_b128 v[64:67], v5 offset:40960
  v_mfma_f32_16x16x32_bf16 v[32:35], v[244:247], v[48:51], v[32:35]
  buffer_load_dwordx4 v[112:115], v8, s[32:35], s51 offen sc1
  s_waitcnt lgkmcnt(3)
  v_mfma_f32_16x16x32_bf16 v[20:23], v[240:243], v[52:55], v[20:23]
  ds_read_b128 v[68:71], v5 offset:41216
  v_mfma_f32_16x16x32_bf16 v[36:39], v[244:247], v[52:55], v[36:39]
  buffer_load_dwordx4 v[116:119], v9, s[40:43], s31 offen sc1
  s_add_u32 s51, s51, 15360
  s_add_u32 s31, s31, s30
  s_waitcnt lgkmcnt(3)
  v_mfma_f32_16x16x32_bf16 v[24:27], v[240:243], v[56:59], v[24:27]
  ds_read_b128 v[72:75], v5 offset:41472
  v_mfma_f32_16x16x32_bf16 v[40:43], v[244:247], v[56:59], v[40:43]
  v_cndmask_b32 v93, v93, v94, s[70:71]
  v_add_u32 v91, v91, v93
  s_waitcnt lgkmcnt(3)
  v_mfma_f32_16x16x32_bf16 v[28:31], v[240:243], v[60:63], v[28:31]
  ds_read_b128 v[76:79], v5 offset:41728
  v_mfma_f32_16x16x32_bf16 v[44:47], v[244:247], v[60:63], v[44:47]
  v_cmp_eq_u32 s[72:73], 4, v92
  v_mov_b32 v93, 16
  s_waitcnt vmcnt(6) lgkmcnt(3)
  v_mfma_f32_16x16x32_bf16 v[16:19], v[248:251], v[64:67], v[16:19]
  ds_read_b128 v[48:51], v4 offset:49152
  v_mfma_f32_16x16x32_bf16 v[32:35], v[252:255], v[64:67], v[32:35]
  buffer_load_dwordx4 v[120:123], v8, s[32:35], s51 offen sc1
  s_waitcnt lgkmcnt(3)
  v_mfma_f32_16x16x32_bf16 v[20:23], v[248:251], v[68:71], v[20:23]
  ds_read_b128 v[52:55], v4 offset:49408
  v_mfma_f32_16x16x32_bf16 v[36:39], v[252:255], v[68:71], v[36:39]
  buffer_load_dwordx4 v[124:127], v9, s[40:43], s31 offen sc1
  s_add_u32 s51, s51, 15360
  s_add_u32 s31, s31, s30
  s_waitcnt lgkmcnt(3)
  v_mfma_f32_16x16x32_bf16 v[24:27], v[248:251], v[72:75], v[24:27]
  ds_read_b128 v[56:59], v4 offset:49664
  v_mfma_f32_16x16x32_bf16 v[40:43], v[252:255], v[72:75], v[40:43]
  v_mov_b32 v94, 8
  v_cndmask_b32 v93, v93, v94, s[72:73]
  s_waitcnt lgkmcnt(3)
  v_mfma_f32_16x16x32_bf16 v[28:31], v[248:251], v[76:79], v[28:31]
  ds_read_b128 v[60:63], v4 offset:49920
  v_mfma_f32_16x16x32_bf16 v[44:47], v[252:255], v[76:79], v[44:47]
  v_mov_b32 v94, 48
  v_cndmask_b32 v93, v93, v94, s[70:71]
  s_waitcnt vmcnt(6) lgkmcnt(3)
  v_mfma_f32_16x16x32_bf16 v[16:19], v[96:99], v[48:51], v[16:19]
  ds_read_b128 v[64:67], v5 offset:49152
  v_mfma_f32_16x16x32_bf16 v[32:35], v[100:103], v[48:51], v[32:35]
  buffer_load_dwordx4 v[128:131], v8, s[32:35], s51 offen sc1
  s_waitcnt lgkmcnt(3)
  v_mfma_f32_16x16x32_bf16 v[20:23], v[96:99], v[52:55], v[20:23]
  ds_read_b128 v[68:71], v5 offset:49408
  v_mfma_f32_16x16x32_bf16 v[36:39], v[100:103], v[52:55], v[36:39]
  buffer_load_dwordx4 v[132:135], v9, s[40:43], s31 offen sc1
  s_add_u32 s51, s51, 15360
  s_add_u32 s31, s31, s30
  s_waitcnt lgkmcnt(3)
  v_mfma_f32_16x16x32_bf16 v[24:27], v[96:99], v[56:59], v[24:27]
  ds_read_b128 v[72:75], v5 offset:49664
  v_mfma_f32_16x16x32_bf16 v[40:43], v[100:103], v[56:59], v[40:43]
  v_mad_u32_u24 v84, v88, v93, v91
  v_lshl_add_u32 v85, v93, 4, v84
  s_waitcnt lgkmcnt(3)
  v_mfma_f32_16x16x32_bf16 v[28:31], v[96:99], v[60:63], v[28:31]
  ds_read_b128 v[76:79], v5 offset:49920
  v_mfma_f32_16x16x32_bf16 v[44:47], v[100:103], v[60:63], v[44:47]
  v_add_u32 v86, s69, v84
  v_add_u32 v87, s69, v85
  s_waitcnt vmcnt(6) lgkmcnt(3)
  v_mfma_f32_16x16x32_bf16 v[16:19], v[104:107], v[64:67], v[16:19]
  ds_read_b128 v[48:51], v4 offset:57344
  v_mfma_f32_16x16x32_bf16 v[32:35], v[108:111], v[64:67], v[32:35]
  buffer_load_dwordx4 v[136:139], v8, s[32:35], s51 offen sc1
  s_waitcnt lgkmcnt(3)
  v_mfma_f32_16x16x32_bf16 v[20:23], v[104:107], v[68:71], v[20:23]
  ds_read_b128 v[52:55], v4 offset:57600
  v_mfma_f32_16x16x32_bf16 v[36:39], v[108:111], v[68:71], v[36:39]
  buffer_load_dwordx4 v[140:143], v9, s[40:43], s31 offen sc1
  s_add_u32 s51, s51, 15360
  s_add_u32 s31, s31, s30
  s_waitcnt lgkmcnt(3)
  v_mfma_f32_16x16x32_bf16 v[24:27], v[104:107], v[72:75], v[24:27]
  ds_read_b128 v[56:59], v4 offset:57856
  v_mfma_f32_16x16x32_bf16 v[40:43], v[108:111], v[72:75], v[40:43]
  s_waitcnt lgkmcnt(3)
  v_mfma_f32_16x16x32_bf16 v[28:31], v[104:107], v[76:79], v[28:31]
  ds_read_b128 v[60:63], v4 offset:58112
  v_mfma_f32_16x16x32_bf16 v[44:47], v[108:111], v[76:79], v[44:47]
  s_waitcnt vmcnt(6) lgkmcnt(3)
  v_mfma_f32_16x16x32_bf16 v[16:19], v[112:115], v[48:51], v[16:19]
  ds_read_b128 v[64:67], v5 offset:57344
  v_mfma_f32_16x16x32_bf16 v[32:35], v[116:119], v[48:51], v[32:35]
  s_waitcnt lgkmcnt(3)
  v_mfma_f32_16x16x32_bf16 v[20:23], v[112:115], v[52:55], v[20:23]
  ds_read_b128 v[68:71], v5 offset:57600
  v_mfma_f32_16x16x32_bf16 v[36:39], v[116:119], v[52:55], v[36:39]
  s_waitcnt lgkmcnt(3)
  v_mfma_f32_16x16x32_bf16 v[24:27], v[112:115], v[56:59], v[24:27]
  ds_read_b128 v[72:75], v5 offset:57856
  v_mfma_f32_16x16x32_bf16 v[40:43], v[116:119], v[56:59], v[40:43]
  s_waitcnt lgkmcnt(3)
  v_mfma_f32_16x16x32_bf16 v[28:31], v[112:115], v[60:63], v[28:31]
  ds_read_b128 v[76:79], v5 offset:58112
  v_mfma_f32_16x16x32_bf16 v[44:47], v[116:119], v[60:63], v[44:47]
  s_waitcnt vmcnt(4) lgkmcnt(3)
  v_mfma_f32_16x16x32_bf16 v[16:19], v[120:123], v[64:67], v[16:19]
  ds_read_b128 v[48:51], v6 offset:0
  v_mfma_f32_16x16x32_bf16 v[32:35], v[124:127], v[64:67], v[32:35]
  buffer_load_dwordx4 v[144:147], v8, s[32:35], s51 offen sc1
  s_waitcnt lgkmcnt(3)
  v_mfma_f32_16x16x32_bf16 v[20:23], v[120:123], v[68:71], v[20:23]
  ds_read_b128 v[52:55], v6 offset:256
  v_mfma_f32_16x16x32_bf16 v[36:39], v[124:127], v[68:71], v[36:39]
  buffer_load_dwordx4 v[148:151], v9, s[40:43], s31 offen sc1
  s_add_u32 s51, s51, 15360
  s_add_u32 s31, s31, s30
  s_waitcnt lgkmcnt(3)
  v_mfma_f32_16x16x32_bf16 v[24:27], v[120:123], v[72:75], v[24:27]
  ds_read_b128 v[56:59], v6 offset:512
  v_mfma_f32_16x16x32_bf16 v[40:43], v[124:127], v[72:75], v[40:43]
  s_waitcnt lgkmcnt(3)
  v_mfma_f32_16x16x32_bf16 v[28:31], v[120:123], v[76:79], v[28:31]
  ds_read_b128 v[60:63], v6 offset:768
  v_mfma_f32_16x16x32_bf16 v[44:47], v[124:127], v[76:79], v[44:47]
  s_waitcnt vmcnt(4) lgkmcnt(3)
  v_mfma_f32_16x16x32_bf16 v[16:19], v[128:131], v[48:51], v[16:19]
  ds_read_b128 v[64:67], v7 offset:0
  v_mfma_f32_16x16x32_bf16 v[32:35], v[132:135], v[48:51], v[32:35]
  buffer_load_dwordx4 v[152:155], v8, s[32:35], s51 offen sc1
  s_waitcnt lgkmcnt(3)
  v_mfma_f32_16x16x32_bf16 v[20:23], v[128:131], v[52:55], v[20:23]
  ds_read_b128 v[68:71], v7 offset:256
  v_mfma_f32_16x16x32_bf16 v[36:39], v[132:135], v[52:55], v[36:39]
  buffer_load_dwordx4 v[156:159], v9, s[40:43], s31 offen sc1
  s_add_u32 s51, s51, 15360
  s_add_u32 s31, s31, s30
  s_waitcnt lgkmcnt(3)
  v_mfma_f32_16x16x32_bf16 v[24:27], v[128:131], v[56:59], v[24:27]
  ds_read_b128 v[72:75], v7 offset:512
  v_mfma_f32_16x16x32_bf16 v[40:43], v[132:135], v[56:59], v[40:43]
  s_waitcnt lgkmcnt(3)
  v_mfma_f32_16x16x32_bf16 v[28:31], v[128:131], v[60:63], v[28:31]
  ds_read_b128 v[76:79], v7 offset:768
  v_mfma_f32_16x16x32_bf16 v[44:47], v[132:135], v[60:63], v[44:47]
  s_waitcnt vmcnt(4) lgkmcnt(3)
  v_mfma_f32_16x16x32_bf16 v[16:19], v[136:139], v[64:67], v[16:19]
  ds_read_b128 v[48:51], v6 offset:8192
  v_mfma_f32_16x16x32_bf16 v[32:35], v[140:143], v[64:67], v[32:35]
  s_waitcnt lgkmcnt(3)
  v_mfma_f32_16x16x32_bf16 v[20:23], v[136:139], v[68:71], v[20:23]
  ds_read_b128 v[52:55], v6 offset:8448
  v_mfma_f32_16x16x32_bf16 v[36:39], v[140:143], v[68:71], v[36:39]
  s_waitcnt lgkmcnt(3)
  v_mfma_f32_16x16x32_bf16 v[24:27], v[136:139], v[72:75], v[24:27]
  ds_read_b128 v[56:59], v6 offset:8704
  v_mfma_f32_16x16x32_bf16 v[40:43], v[140:143], v[72:75], v[40:43]
  s_waitcnt lgkmcnt(3)
  v_mfma_f32_16x16x32_bf16 v[28:31], v[136:139], v[76:79], v[28:31]
  ds_read_b128 v[60:63], v6 offset:8960
  v_mfma_f32_16x16x32_bf16 v[44:47], v[140:143], v[76:79], v[44:47]
  s_waitcnt vmcnt(2) lgkmcnt(3)
  v_mfma_f32_16x16x32_bf16 v[16:19], v[144:147], v[48:51], v[16:19]
  ds_read_b128 v[64:67], v7 offset:8192
  v_mfma_f32_16x16x32_bf16 v[32:35], v[148:151], v[48:51], v[32:35]
  s_waitcnt lgkmcnt(3)
  v_mfma_f32_16x16x32_bf16 v[20:23], v[144:147], v[52:55], v[20:23]
  ds_read_b128 v[68:71], v7 offset:8448
  v_mfma_f32_16x16x32_bf16 v[36:39], v[148:151], v[52:55], v[36:39]
  s_waitcnt lgkmcnt(3)
  v_mfma_f32_16x16x32_bf16 v[24:27], v[144:147], v[56:59], v[24:27]
  ds_read_b128 v[72:75], v7 offset:8704
  v_mfma_f32_16x16x32_bf16 v[40:43], v[148:151], v[56:59], v[40:43]
  s_waitcnt lgkmcnt(3)
  v_mfma_f32_16x16x32_bf16 v[28:31], v[144:147], v[60:63], v[28:31]
  ds_read_b128 v[76:79], v7 offset:8960
  v_mfma_f32_16x16x32_bf16 v[44:47], v[148:151], v[60:63], v[44:47]
  s_waitcnt vmcnt(0) lgkmcnt(3)
  v_mfma_f32_16x16x32_bf16 v[16:19], v[152:155], v[64:67], v[16:19]
  v_mfma_f32_16x16x32_bf16 v[32:35], v[156:159], v[64:67], v[32:35]
  s_waitcnt lgkmcnt(2)
  v_mfma_f32_16x16x32_bf16 v[20:23], v[152:155], v[68:71], v[20:23]
  v_mfma_f32_16x16x32_bf16 v[36:39], v[156:159], v[68:71], v[36:39]
  s_waitcnt lgkmcnt(1)
  v_mfma_f32_16x16x32_bf16 v[24:27], v[152:155], v[72:75], v[24:27]
  v_mfma_f32_16x16x32_bf16 v[40:43], v[156:159], v[72:75], v[40:43]
  s_waitcnt lgkmcnt(0)
  v_mfma_f32_16x16x32_bf16 v[28:31], v[152:155], v[76:79], v[28:31]
  v_mfma_f32_16x16x32_bf16 v[44:47], v[156:159], v[76:79], v[44:47]
  s_cmp_ge_u32 s46, 4
  s_cbranch_scc0 L_w_23
  v_mov_b32 v96, 0x3ea52b5c
  v_mul_f32 v16, v96, v16
  v_mul_f32 v17, v96, v17
  v_mul_f32 v18, v96, v18
  v_mul_f32 v19, v96, v19
  v_mul_f32 v20, v96, v20
  v_mul_f32 v21, v96, v21
  v_mul_f32 v22, v96, v22
  v_mul_f32 v23, v96, v23
  v_mul_f32 v24, v96, v24
  v_mul_f32 v25, v96, v25
  v_mul_f32 v26, v96, v26
  v_mul_f32 v27, v96, v27
  v_mul_f32 v28, v96, v28
  v_mul_f32 v29, v96, v29
  v_mul_f32 v30, v96, v30
  v_mul_f32 v31, v96, v31
  v_mul_f32 v32, v96, v32
  v_mul_f32 v33, v96, v33
  v_mul_f32 v34, v96, v34
  v_mul_f32 v35, v96, v35
  v_mul_f32 v36, v96, v36
  v_mul_f32 v37, v96, v37
  v_mul_f32 v38, v96, v38
  v_mul_f32 v39, v96, v39
  v_mul_f32 v40, v96, v40
  v_mul_f32 v41, v96, v41
  v_mul_f32 v42, v96, v42
  v_mul_f32 v43, v96, v43
  v_mul_f32 v44, v96, v44
  v_mul_f32 v45, v96, v45
  v_mul_f32 v46, v96, v46
  v_mul_f32 v47, v96, v47
L_w_23:
  v_cvt_pk_bf16_f32 v16, v16, v17
  v_cvt_pk_bf16_f32 v17, v18, v19
  ds_write_b64 v80, v[16:17]
  v_cvt_pk_bf16_f32 v20, v20, v21
  v_cvt_pk_bf16_f32 v21, v22, v23
  ds_write_b64 v81, v[20:21]
  v_cvt_pk_bf16_f32 v24, v24, v25
  v_cvt_pk_bf16_f32 v25, v26, v27
  ds_write_b64 v82, v[24:25]
  v_cvt_pk_bf16_f32 v28, v28, v29
  v_cvt_pk_bf16_f32 v29, v30, v31
  ds_write_b64 v83, v[28:29]
  v_cvt_pk_bf16_f32 v32, v32, v33
  v_cvt_pk_bf16_f32 v33, v34, v35
  ds_write_b64 v84, v[32:33]
  v_cvt_pk_bf16_f32 v36, v36, v37
  v_cvt_pk_bf16_f32 v37, v38, v39
  ds_write_b64 v85, v[36:37]
  v_cvt_pk_bf16_f32 v40, v40, v41
  v_cvt_pk_bf16_f32 v41, v42, v43
  ds_write_b64 v86, v[40:41]
  v_cvt_pk_bf16_f32 v44, v44, v45
  v_cvt_pk_bf16_f32 v45, v46, v47
  ds_write_b64 v87, v[44:45]
  s_cmp_lt_u32 s46, 4
  s_cbranch_scc1 L_gp_21
  s_branch L_gd_22
L_g6_20:
  s_waitcnt vmcnt(11) lgkmcnt(3)
  v_mfma_f32_16x16x32_bf16 v[16:19], v[160:163], v[48:51], 0
  ds_read_b128 v[64:67], v5 offset:0
  s_waitcnt lgkmcnt(3)
  v_mfma_f32_16x16x32_bf16 v[20:23], v[160:163], v[52:55], 0
  ds_read_b128 v[68:71], v5 offset:256
  s_waitcnt lgkmcnt(3)
  v_mfma_f32_16x16x32_bf16 v[24:27], v[160:163], v[56:59], 0
  ds_read_b128 v[72:75], v5 offset:512
  s_waitcnt lgkmcnt(3)
  v_mfma_f32_16x16x32_bf16 v[28:31], v[160:163], v[60:63], 0
  ds_read_b128 v[76:79], v5 offset:768
  buffer_load_dwordx4 v[208:211], v8, s[32:35], s51 offen sc1
  s_add_u32 s51, s51, 15360
  s_waitcnt vmcnt(10) lgkmcnt(3)
  v_mfma_f32_16x16x32_bf16 v[16:19], v[168:171], v[64:67], v[16:19]
  ds_read_b128 v[48:51], v4 offset:8192
  v_and_b32 v88, 15, v1
  s_waitcnt lgkmcnt(3)
  v_mfma_f32_16x16x32_bf16 v[20:23], v[168:171], v[68:71], v[20:23]
  ds_read_b128 v[52:55], v4 offset:8448
  v_lshrrev_b32 v89, 4, v1
  s_waitcnt lgkmcnt(3)
  v_mfma_f32_16x16x32_bf16 v[24:27], v[168:171], v[72:75], v[24:27]
  ds_read_b128 v[56:59], v4 offset:8704
  s_mov_b32 s64, s78
  s_mul_i32 s65, s64, 52
  s_lshr_b32 s65, s65, 8
  s_mul_i32 s66, s65, 5
  s_sub_u32 s66, s64, s66
  s_lshl_b32 s66, s66, 2
  s_cmp_ge_u32 s65, 2
  s_mov_b32 s67, 2816
  s_cmov_b32 s67, 1280
  s_mov_b32 s68, 90112
  s_cmov_b32 s68, 112640
  s_mov_b32 s69, 11264
  s_cmov_b32 s69, 5120
  s_cmp_eq_u32 s65, 1
  s_cselect_b64 s[70:71], -1, 0
  v_add_u32 v90, s66, v89
  s_waitcnt lgkmcnt(3)
  v_mfma_f32_16x16x32_bf16 v[28:31], v[168:171], v[76:79], v[28:31]
  ds_read_b128 v[60:63], v4 offset:8960
  v_mul_u32_u24 v91, 52, v90
  buffer_load_dwordx4 v[216:219], v8, s[32:35], s51 offen sc1
  s_add_u32 s51, s51, 15360
  s_waitcnt vmcnt(9) lgkmcnt(3)
  v_mfma_f32_16x16x32_bf16 v[16:19], v[176:179], v[48:51], v[16:19]
  ds_read_b128 v[64:67], v5 offset:8192
  v_lshrrev_b32 v91, 8, v91
  s_waitcnt lgkmcnt(3)
  v_mfma_f32_16x16x32_bf16 v[20:23], v[176:179], v[52:55], v[20:23]
  ds_read_b128 v[68:71], v5 offset:8448
  v_mul_u32_u24 v92, 5, v91
  s_waitcnt lgkmcnt(3)
  v_mfma_f32_16x16x32_bf16 v[24:27], v[176:179], v[56:59], v[24:27]
  ds_read_b128 v[72:75], v5 offset:8704
  v_sub_u32 v92, v90, v92
  s_waitcnt lgkmcnt(3)
  v_mfma_f32_16x16x32_bf16 v[28:31], v[176:179], v[60:63], v[28:31]
  ds_read_b128 v[76:79], v5 offset:8960
  v_mul_u32_u24 v91, s67, v91
  buffer_load_dwordx4 v[224:227], v8, s[32:35], s51 offen sc1
  s_add_u32 s51, s51, 15360
  s_waitcnt vmcnt(8) lgkmcnt(3)
  v_mfma_f32_16x16x32_bf16 v[16:19], v[184:187], v[64:67], v[16:19]
  ds_read_b128 v[48:51], v4 offset:16384
  v_add_u32 v91, s68, v91
  s_waitcnt lgkmcnt(3)
  v_mfma_f32_16x16x32_bf16 v[20:23], v[184:187], v[68:71], v[20:23]
  ds_read_b128 v[52:55], v4 offset:16640
  v_lshrrev_b32 v93, 1, v92
  s_waitcnt lgkmcnt(3)
  v_mfma_f32_16x16x32_bf16 v[24:27], v[184:187], v[72:75], v[24:27]
  ds_read_b128 v[56:59], v4 offset:16896
  v_lshlrev_b32 v93, 9, v93
  s_waitcnt lgkmcnt(3)
  v_mfma_f32_16x16x32_bf16 v[28:31], v[184:187], v[76:79], v[28:31]
  ds_read_b128 v[60:63], v4 offset:17152
  v_and_b32 v94, 1, v92
  buffer_load_dwordx4 v[232:235], v8, s[32:35], s51 offen sc1
  s_add_u32 s51, s51, 15360
  s_waitcnt vmcnt(7) lgkmcnt(3)
  v_mfma_f32_16x16x32_bf16 v[16:19], v[192:195], v[48:51], v[16:19]
  ds_read_b128 v[64:67], v5 offset:16384
  v_lshl_add_u32 v93, v94, 3, v93
  s_waitcnt lgkmcnt(3)
  v_mfma_f32_16x16x32_bf16 v[20:23], v[192:195], v[52:55], v[20:23]
  ds_read_b128 v[68:71], v5 offset:16640
  v_lshlrev_b32 v94, 3, v92
  s_waitcnt lgkmcnt(3)
  v_mfma_f32_16x16x32_bf16 v[24:27], v[192:195], v[56:59], v[24:27]
  ds_read_b128 v[72:75], v5 offset:16896
  v_add_u32 v94, 1280, v94
  s_waitcnt lgkmcnt(3)
  v_mfma_f32_16x16x32_bf16 v[28:31], v[192:195], v[60:63], v[28:31]
  ds_read_b128 v[76:79], v5 offset:17152
  v_cndmask_b32 v93, v93, v94, s[70:71]
  buffer_load_dwordx4 v[240:243], v8, s[32:35], s51 offen sc1
  s_add_u32 s51, s51, 15360
  s_waitcnt vmcnt(6) lgkmcnt(3)
  v_mfma_f32_16x16x32_bf16 v[16:19], v[200:203], v[64:67], v[16:19]
  ds_read_b128 v[48:51], v4 offset:24576
  v_add_u32 v91, v91, v93
  s_waitcnt lgkmcnt(3)
  v_mfma_f32_16x16x32_bf16 v[20:23], v[200:203], v[68:71], v[20:23]
  ds_read_b128 v[52:55], v4 offset:24832
  v_cmp_eq_u32 s[72:73], 4, v92
  s_waitcnt lgkmcnt(3)
  v_mfma_f32_16x16x32_bf16 v[24:27], v[200:203], v[72:75], v[24:27]
  ds_read_b128 v[56:59], v4 offset:25088
  v_mov_b32 v93, 16
  s_waitcnt lgkmcnt(3)
  v_mfma_f32_16x16x32_bf16 v[28:31], v[200:203], v[76:79], v[28:31]
  ds_read_b128 v[60:63], v4 offset:25344
  v_mov_b32 v94, 8
  buffer_load_dwordx4 v[248:251], v8, s[32:35], s51 offen sc1
  s_add_u32 s51, s51, 15360
  s_waitcnt vmcnt(5) lgkmcnt(3)
  v_mfma_f32_16x16x32_bf16 v[16:19], v[208:211], v[48:51], v[16:19]
  ds_read_b128 v[64:67], v5 offset:24576
  v_cndmask_b32 v93, v93, v94, s[72:73]
  s_waitcnt lgkmcnt(3)
  v_mfma_f32_16x16x32_bf16 v[20:23], v[208:211], v[52:55], v[20:23]
  ds_read_b128 v[68:71], v5 offset:24832
  v_mov_b32 v94, 48
  s_waitcnt lgkmcnt(3)
  v_mfma_f32_16x16x32_bf16 v[24:27], v[208:211], v[56:59], v[24:27]
  ds_read_b128 v[72:75], v5 offset:25088
  v_cndmask_b32 v93, v93, v94, s[70:71]
  s_waitcnt lgkmcnt(3)
  v_mfma_f32_16x16x32_bf16 v[28:31], v[208:211], v[60:63], v[28:31]
  ds_read_b128 v[76:79], v5 offset:25344
  v_mad_u32_u24 v80, v88, v93, v91
  buffer_load_dwordx4 v[96:99], v8, s[32:35], s51 offen sc1
  s_add_u32 s51, s51, 15360
  s_waitcnt vmcnt(5) lgkmcnt(3)
  v_mfma_f32_16x16x32_bf16 v[16:19], v[216:219], v[64:67], v[16:19]
  ds_read_b128 v[48:51], v4 offset:32768
  v_lshl_add_u32 v81, v93, 4, v80
  s_waitcnt lgkmcnt(3)
  v_mfma_f32_16x16x32_bf16 v[20:23], v[216:219], v[68:71], v[20:23]
  ds_read_b128 v[52:55], v4 offset:33024
  v_add_u32 v82, s69, v80
  s_waitcnt lgkmcnt(3)
  v_mfma_f32_16x16x32_bf16 v[24:27], v[216:219], v[72:75], v[24:27]
  ds_read_b128 v[56:59], v4 offset:33280
  v_add_u32 v83, s69, v81
  s_waitcnt lgkmcnt(3)
  v_mfma_f32_16x16x32_bf16 v[28:31], v[216:219], v[76:79], v[28:31]
  ds_read_b128 v[60:63], v4 offset:33536
  s_mov_b32 s64, s79
  s_mul_i32 s65, s64, 52
  s_lshr_b32 s65, s65, 8
  s_mul_i32 s66, s65, 5
  s_sub_u32 s66, s64, s66
  s_lshl_b32 s66, s66, 2
  s_cmp_ge_u32 s65, 2
  s_mov_b32 s67, 2816
  s_cmov_b32 s67, 1280
  s_mov_b32 s68, 90112
  s_cmov_b32 s68, 112640
  s_mov_b32 s69, 11264
  s_cmov_b32 s69, 5120
  s_cmp_eq_u32 s65, 1
  s_cselect_b64 s[70:71], -1, 0
  v_add_u32 v90, s66, v89
  buffer_load_dwordx4 v[104:107], v8, s[32:35], s51 offen sc1
  s_add_u32 s51, s51, 15360
  s_waitcnt vmcnt(5) lgkmcnt(3)
  v_mfma_f32_16x16x32_bf16 v[16:19], v[224:227], v[48:51], v[16:19]
  ds_read_b128 v[64:67], v5 offset:32768
  v_mul_u32_u24 v91, 52, v90
  s_waitcnt lgkmcnt(3)
  v_mfma_f32_16x16x32_bf16 v[20:23], v[224:227], v[52:55], v[20:23]
  ds_read_b128 v[68:71], v5 offset:33024
  v_lshrrev_b32 v91, 8, v91
  s_waitcnt lgkmcnt(3)
  v_mfma_f32_16x16x32_bf16 v[24:27], v[224:227], v[56:59], v[24:27]
  ds_read_b128 v[72:75], v5 offset:33280
  v_mul_u32_u24 v92, 5, v91
  s_waitcnt lgkmcnt(3)
  v_mfma_f32_16x16x32_bf16 v[28:31], v[224:227], v[60:63], v[28:31]
  ds_read_b128 v[76:79], v5 offset:33536
  v_sub_u32 v92, v90, v92
  buffer_load_dwordx4 v[112:115], v8, s[32:35], s51 offen sc1
  s_add_u32 s51, s51, 15360
  s_waitcnt vmcnt(5) lgkmcnt(3)
  v_mfma_f32_16x16x32_bf16 v[16:19], v[232:235], v[64:67], v[16:19]
  ds_read_b128 v[48:51], v4 offset:40960
  v_mul_u32_u24 v91, s67, v91
  s_waitcnt lgkmcnt(3)
  v_mfma_f32_16x16x32_bf16 v[20:23], v[232:235], v[68:71], v[20:23]
  ds_read_b128 v[52:55], v4 offset:41216
  v_add_u32 v91, s68, v91
  s_waitcnt lgkmcnt(3)
  v_mfma_f32_16x16x32_bf16 v[24:27], v[232:235], v[72:75], v[24:27]
  ds_read_b128 v[56:59], v4 offset:41472
  v_lshrrev_b32 v93, 1, v92
  s_waitcnt lgkmcnt(3)
  v_mfma_f32_16x16x32_bf16 v[28:31], v[232:235], v[76:79], v[28:31]
  ds_read_b128 v[60:63], v4 offset:41728
  v_lshlrev_b32 v93, 9, v93
  buffer_load_dwordx4 v[120:123], v8, s[32:35], s51 offen sc1
  s_add_u32 s51, s51, 15360
  s_waitcnt vmcnt(5) lgkmcnt(3)
  v_mfma_f32_16x16x32_bf16 v[16:19], v[240:243], v[48:51], v[16:19]
  ds_read_b128 v[64:67], v5 offset:40960
  v_and_b32 v94, 1, v92
  s_waitcnt lgkmcnt(3)
  v_mfma_f32_16x16x32_bf16 v[20:23], v[240:243], v[52:55], v[20:23]
  ds_read_b128 v[68:71], v5 offset:41216
  v_lshl_add_u32 v93, v94, 3, v93
  s_waitcnt lgkmcnt(3)
  v_mfma_f32_16x16x32_bf16 v[24:27], v[240:243], v[56:59], v[24:27]
  ds_read_b128 v[72:75], v5 offset:41472
  v_lshlrev_b32 v94, 3, v92
  s_waitcnt lgkmcnt(3)
  v_mfma_f32_16x16x32_bf16 v[28:31], v[240:243], v[60:63], v[28:31]
  ds_read_b128 v[76:79], v5 offset:41728
  v_add_u32 v94, 1280, v94
  buffer_load_dwordx4 v[128:131], v8, s[32:35], s51 offen sc1
  s_add_u32 s51, s51, 15360
  s_waitcnt vmcnt(5) lgkmcnt(3)
  v_mfma_f32_16x16x32_bf16 v[16:19], v[248:251], v[64:67], v[16:19]
  ds_read_b128 v[48:51], v4 offset:49152
  v_cndmask_b32 v93, v93, v94, s[70:71]
  s_waitcnt lgkmcnt(3)
  v_mfma_f32_16x16x32_bf16 v[20:23], v[248:251], v[68:71], v[20:23]
  ds_read_b128 v[52:55], v4 offset:49408
  v_add_u32 v91, v91, v93
  s_waitcnt lgkmcnt(3)
  v_mfma_f32_16x16x32_bf16 v[24:27], v[248:251], v[72:75], v[24:27]
  ds_read_b128 v[56:59], v4 offset:49664
  v_cmp_eq_u32 s[72:73], 4, v92
  s_waitcnt lgkmcnt(3)
  v_mfma_f32_16x16x32_bf16 v[28:31], v[248:251], v[76:79], v[28:31]
  ds_read_b128 v[60:63], v4 offset:49920
  v_mov_b32 v93, 16
  buffer_load_dwordx4 v[136:139], v8, s[32:35], s51 offen sc1
  s_add_u32 s51, s51, 15360
  s_waitcnt vmcnt(5) lgkmcnt(3)
  v_mfma_f32_16x16x32_bf16 v[16:19], v[96:99], v[48:51], v[16:19]
  ds_read_b128 v[64:67], v5 offset:49152
  v_mov_b32 v94, 8
  s_waitcnt lgkmcnt(3)
  v_mfma_f32_16x16x32_bf16 v[20:23], v[96:99], v[52:55], v[20:23]
  ds_read_b128 v[68:71], v5 offset:49408
  v_cndmask_b32 v93, v93, v94, s[72:73]
  s_waitcnt lgkmcnt(3)
  v_mfma_f32_16x16x32_bf16 v[24:27], v[96:99], v[56:59], v[24:27]
  ds_read_b128 v[72:75], v5 offset:49664
  v_mov_b32 v94, 48
  s_waitcnt lgkmcnt(3)
  v_mfma_f32_16x16x32_bf16 v[28:31], v[96:99], v[60:63], v[28:31]
  ds_read_b128 v[76:79], v5 offset:49920
  v_cndmask_b32 v93, v93, v94, s[70:71]
  buffer_load_dwordx4 v[144:147], v8, s[32:35], s51 offen sc1
  s_add_u32 s51, s51, 15360
  s_waitcnt vmcnt(5) lgkmcnt(3)
  v_mfma_f32_16x16x32_bf16 v[16:19], v[104:107], v[64:67], v[16:19]
  ds_read_b128 v[48:51], v4 offset:57344
  v_mad_u32_u24 v84, v88, v93, v91
  s_waitcnt lgkmcnt(3)
  v_mfma_f32_16x16x32_bf16 v[20:23], v[104:107], v[68:71], v[20:23]
  ds_read_b128 v[52:55], v4 offset:57600
  v_lshl_add_u32 v85, v93, 4, v84
  s_waitcnt lgkmcnt(3)
  v_mfma_f32_16x16x32_bf16 v[24:27], v[104:107], v[72:75], v[24:27]
  ds_read_b128 v[56:59], v4 offset:57856
  v_add_u32 v86, s69, v84
  s_waitcnt lgkmcnt(3)
  v_mfma_f32_16x16x32_bf16 v[28:31], v[104:107], v[76:79], v[28:31]
  ds_read_b128 v[60:63], v4 offset:58112
  v_add_u32 v87, s69, v85
  buffer_load_dwordx4 v[152:155], v8, s[32:35], s51 offen sc1
  s_add_u32 s51, s51, 15360
  s_waitcnt vmcnt(5) lgkmcnt(3)
  v_mfma_f32_16x16x32_bf16 v[16:19], v[112:115], v[48:51], v[16:19]
  ds_read_b128 v[64:67], v5 offset:57344
  s_waitcnt lgkmcnt(3)
  v_mfma_f32_16x16x32_bf16 v[20:23], v[112:115], v[52:55], v[20:23]
  ds_read_b128 v[68:71], v5 offset:57600
  s_waitcnt lgkmcnt(3)
  v_mfma_f32_16x16x32_bf16 v[24:27], v[112:115], v[56:59], v[24:27]
  ds_read_b128 v[72:75], v5 offset:57856
  s_waitcnt lgkmcnt(3)
  v_mfma_f32_16x16x32_bf16 v[28:31], v[112:115], v[60:63], v[28:31]
  ds_read_b128 v[76:79], v5 offset:58112
  buffer_load_dwordx4 v[212:215], v9, s[40:43], s31 offen sc1
  s_add_u32 s31, s31, s30
  s_waitcnt vmcnt(5) lgkmcnt(3)
  v_mfma_f32_16x16x32_bf16 v[16:19], v[120:123], v[64:67], v[16:19]
  ds_read_b128 v[48:51], v6 offset:0
  s_waitcnt lgkmcnt(3)
  v_mfma_f32_16x16x32_bf16 v[20:23], v[120:123], v[68:71], v[20:23]
  ds_read_b128 v[52:55], v6 offset:256
  s_waitcnt lgkmcnt(3)
  v_mfma_f32_16x16x32_bf16 v[24:27], v[120:123], v[72:75], v[24:27]
  ds_read_b128 v[56:59], v6 offset:512
  s_waitcnt lgkmcnt(3)
  v_mfma_f32_16x16x32_bf16 v[28:31], v[120:123], v[76:79], v[28:31]
  ds_read_b128 v[60:63], v6 offset:768
  buffer_load_dwordx4 v[220:223], v9, s[40:43], s31 offen sc1
  s_add_u32 s31, s31, s30
  s_waitcnt vmcnt(5) lgkmcnt(3)
  v_mfma_f32_16x16x32_bf16 v[16:19], v[128:131], v[48:51], v[16:19]
  ds_read_b128 v[64:67], v7 offset:0
  s_waitcnt lgkmcnt(3)
  v_mfma_f32_16x16x32_bf16 v[20:23], v[128:131], v[52:55], v[20:23]
  ds_read_b128 v[68:71], v7 offset:256
  s_waitcnt lgkmcnt(3)
  v_mfma_f32_16x16x32_bf16 v[24:27], v[128:131], v[56:59], v[24:27]
  ds_read_b128 v[72:75], v7 offset:512
  s_waitcnt lgkmcnt(3)
  v_mfma_f32_16x16x32_bf16 v[28:31], v[128:131], v[60:63], v[28:31]
  ds_read_b128 v[76:79], v7 offset:768
  buffer_load_dwordx4 v[228:231], v9, s[40:43], s31 offen sc1
  s_add_u32 s31, s31, s30
  s_waitcnt vmcnt(5) lgkmcnt(3)
  v_mfma_f32_16x16x32_bf16 v[16:19], v[136:139], v[64:67], v[16:19]
  ds_read_b128 v[48:51], v6 offset:8192
  s_waitcnt lgkmcnt(3)
  v_mfma_f32_16x16x32_bf16 v[20:23], v[136:139], v[68:71], v[20:23]
  ds_read_b128 v[52:55], v6 offset:8448
  s_waitcnt lgkmcnt(3)
  v_mfma_f32_16x16x32_bf16 v[24:27], v[136:139], v[72:75], v[24:27]
  ds_read_b128 v[56:59], v6 offset:8704
  s_waitcnt lgkmcnt(3)
  v_mfma_f32_16x16x32_bf16 v[28:31], v[136:139], v[76:79], v[28:31]
  ds_read_b128 v[60:63], v6 offset:8960
  buffer_load_dwordx4 v[236:239], v9, s[40:43], s31 offen sc1
  s_add_u32 s31, s31, s30
  s_waitcnt vmcnt(5) lgkmcnt(3)
  v_mfma_f32_16x16x32_bf16 v[16:19], v[144:147], v[48:51], v[16:19]
  ds_read_b128 v[64:67], v7 offset:8192
  s_waitcnt lgkmcnt(3)
  v_mfma_f32_16x16x32_bf16 v[20:23], v[144:147], v[52:55], v[20:23]
  ds_read_b128 v[68:71], v7 offset:8448
  s_waitcnt lgkmcnt(3)
  v_mfma_f32_16x16x32_bf16 v[24:27], v[144:147], v[56:59], v[24:27]
  ds_read_b128 v[72:75], v7 offset:8704
  s_waitcnt lgkmcnt(3)
  v_mfma_f32_16x16x32_bf16 v[28:31], v[144:147], v[60:63], v[28:31]
  ds_read_b128 v[76:79], v7 offset:8960
  buffer_load_dwordx4 v[244:247], v9, s[40:43], s31 offen sc1
  s_add_u32 s31, s31, s30
  s_waitcnt vmcnt(5) lgkmcnt(3)
  v_mfma_f32_16x16x32_bf16 v[16:19], v[152:155], v[64:67], v[16:19]
  s_waitcnt lgkmcnt(2)
  v_mfma_f32_16x16x32_bf16 v[20:23], v[152:155], v[68:71], v[20:23]
  s_waitcnt lgkmcnt(1)
  v_mfma_f32_16x16x32_bf16 v[24:27], v[152:155], v[72:75], v[24:27]
  s_waitcnt lgkmcnt(0)
  v_mfma_f32_16x16x32_bf16 v[28:31], v[152:155], v[76:79], v[28:31]
  buffer_load_dwordx4 v[252:255], v9, s[40:43], s31 offen sc1
  s_add_u32 s31, s31, s30
  v_cvt_pk_bf16_f32 v16, v16, v17
  v_cvt_pk_bf16_f32 v17, v18, v19
  ds_write_b64 v80, v[16:17]
  v_cvt_pk_bf16_f32 v20, v20, v21
  v_cvt_pk_bf16_f32 v21, v22, v23
  ds_write_b64 v81, v[20:21]
  v_cvt_pk_bf16_f32 v24, v24, v25
  v_cvt_pk_bf16_f32 v25, v26, v27
  ds_write_b64 v82, v[24:25]
  v_cvt_pk_bf16_f32 v28, v28, v29
  v_cvt_pk_bf16_f32 v29, v30, v31
  ds_write_b64 v83, v[28:29]
  s_cmp_eq_u32 s46, 7
  s_cbranch_scc1 L_gp_21
  s_setprio 0
  s_waitcnt lgkmcnt(0)
  v_mov_b32 v16, 89608
  v_mov_b32 v17, 1
  s_mov_b64 exec, 1
  ds_add_u32 v16, v17
  s_mov_b64 exec, -1
  ds_read_b128 v[48:51], v4 offset:0
  ds_read_b128 v[52:55], v4 offset:256
  ds_read_b128 v[56:59], v4 offset:512
  ds_read_b128 v[60:63], v4 offset:768
  s_waitcnt vmcnt(30) lgkmcnt(3)
  v_mfma_f32_16x16x32_bf16 v[32:35], v[164:167], v[48:51], 0
  ds_read_b128 v[64:67], v5 offset:0
  s_waitcnt lgkmcnt(3)
  v_mfma_f32_16x16x32_bf16 v[36:39], v[164:167], v[52:55], 0
  ds_read_b128 v[68:71], v5 offset:256
  s_waitcnt lgkmcnt(3)
  v_mfma_f32_16x16x32_bf16 v[40:43], v[164:167], v[56:59], 0
  ds_read_b128 v[72:75], v5 offset:512
  s_waitcnt lgkmcnt(3)
  v_mfma_f32_16x16x32_bf16 v[44:47], v[164:167], v[60:63], 0
  ds_read_b128 v[76:79], v5 offset:768
  buffer_load_dwordx4 v[100:103], v9, s[40:43], s31 offen sc1
  s_add_u32 s31, s31, s30
  s_waitcnt vmcnt(29) lgkmcnt(3)
  v_mfma_f32_16x16x32_bf16 v[32:35], v[172:175], v[64:67], v[32:35]
  ds_read_b128 v[48:51], v4 offset:8192
  s_waitcnt lgkmcnt(3)
  v_mfma_f32_16x16x32_bf16 v[36:39], v[172:175], v[68:71], v[36:39]
  ds_read_b128 v[52:55], v4 offset:8448
  s_waitcnt lgkmcnt(3)
  v_mfma_f32_16x16x32_bf16 v[40:43], v[172:175], v[72:75], v[40:43]
  ds_read_b128 v[56:59], v4 offset:8704
  s_waitcnt lgkmcnt(3)
  v_mfma_f32_16x16x32_bf16 v[44:47], v[172:175], v[76:79], v[44:47]
  ds_read_b128 v[60:63], v4 offset:8960
  buffer_load_dwordx4 v[108:111], v9, s[40:43], s31 offen sc1
  s_add_u32 s31, s31, s30
  s_waitcnt vmcnt(28) lgkmcnt(3)
  v_mfma_f32_16x16x32_bf16 v[32:35], v[180:183], v[48:51], v[32:35]
  ds_read_b128 v[64:67], v5 offset:8192
  s_waitcnt lgkmcnt(3)
  v_mfma_f32_16x16x32_bf16 v[36:39], v[180:183], v[52:55], v[36:39]
  ds_read_b128 v[68:71], v5 offset:8448
  s_waitcnt lgkmcnt(3)
  v_mfma_f32_16x16x32_bf16 v[40:43], v[180:183], v[56:59], v[40:43]
  ds_read_b128 v[72:75], v5 offset:8704
  s_waitcnt lgkmcnt(3)
  v_mfma_f32_16x16x32_bf16 v[44:47], v[180:183], v[60:63], v[44:47]
  ds_read_b128 v[76:79], v5 offset:8960
  buffer_load_dwordx4 v[116:119], v9, s[40:43], s31 offen sc1
  s_add_u32 s31, s31, s30
  s_waitcnt vmcnt(27) lgkmcnt(3)
  v_mfma_f32_16x16x32_bf16 v[32:35], v[188:191], v[64:67], v[32:35]
  ds_read_b128 v[48:51], v4 offset:16384
  s_waitcnt lgkmcnt(3)
  v_mfma_f32_16x16x32_bf16 v[36:39], v[188:191], v[68:71], v[36:39]
  ds_read_b128 v[52:55], v4 offset:16640
  s_waitcnt lgkmcnt(3)
  v_mfma_f32_16x16x32_bf16 v[40:43], v[188:191], v[72:75], v[40:43]
  ds_read_b128 v[56:59], v4 offset:16896
  s_waitcnt lgkmcnt(3)
  v_mfma_f32_16x16x32_bf16 v[44:47], v[188:191], v[76:79], v[44:47]
  ds_read_b128 v[60:63], v4 offset:17152
  buffer_load_dwordx4 v[124:127], v9, s[40:43], s31 offen sc1
  s_add_u32 s31, s31, s30
  s_waitcnt vmcnt(26) lgkmcnt(3)
  v_mfma_f32_16x16x32_bf16 v[32:35], v[196:199], v[48:51], v[32:35]
  ds_read_b128 v[64:67], v5 offset:16384
  s_waitcnt lgkmcnt(3)
  v_mfma_f32_16x16x32_bf16 v[36:39], v[196:199], v[52:55], v[36:39]
  ds_read_b128 v[68:71], v5 offset:16640
  s_waitcnt lgkmcnt(3)
  v_mfma_f32_16x16x32_bf16 v[40:43], v[196:199], v[56:59], v[40:43]
  ds_read_b128 v[72:75], v5 offset:16896
  s_waitcnt lgkmcnt(3)
  v_mfma_f32_16x16x32_bf16 v[44:47], v[196:199], v[60:63], v[44:47]
  ds_read_b128 v[76:79], v5 offset:17152
  buffer_load_dwordx4 v[132:135], v9, s[40:43], s31 offen sc1
  s_add_u32 s31, s31, s30
  s_waitcnt vmcnt(25) lgkmcnt(3)
  v_mfma_f32_16x16x32_bf16 v[32:35], v[204:207], v[64:67], v[32:35]
  ds_read_b128 v[48:51], v4 offset:24576
  s_waitcnt lgkmcnt(3)
  v_mfma_f32_16x16x32_bf16 v[36:39], v[204:207], v[68:71], v[36:39]
  ds_read_b128 v[52:55], v4 offset:24832
  s_waitcnt lgkmcnt(3)
  v_mfma_f32_16x16x32_bf16 v[40:43], v[204:207], v[72:75], v[40:43]
  ds_read_b128 v[56:59], v4 offset:25088
  s_waitcnt lgkmcnt(3)
  v_mfma_f32_16x16x32_bf16 v[44:47], v[204:207], v[76:79], v[44:47]
  ds_read_b128 v[60:63], v4 offset:25344
  buffer_load_dwordx4 v[140:143], v9, s[40:43], s31 offen sc1
  s_add_u32 s31, s31, s30
  s_waitcnt vmcnt(11) lgkmcnt(3)
  v_mfma_f32_16x16x32_bf16 v[32:35], v[212:215], v[48:51], v[32:35]
  ds_read_b128 v[64:67], v5 offset:24576
  s_waitcnt lgkmcnt(3)
  v_mfma_f32_16x16x32_bf16 v[36:39], v[212:215], v[52:55], v[36:39]
  ds_read_b128 v[68:71], v5 offset:24832
  s_waitcnt lgkmcnt(3)
  v_mfma_f32_16x16x32_bf16 v[40:43], v[212:215], v[56:59], v[40:43]
  ds_read_b128 v[72:75], v5 offset:25088
  s_waitcnt lgkmcnt(3)
  v_mfma_f32_16x16x32_bf16 v[44:47], v[212:215], v[60:63], v[44:47]
  ds_read_b128 v[76:79], v5 offset:25344
  buffer_load_dwordx4 v[148:151], v9, s[40:43], s31 offen sc1
  s_add_u32 s31, s31, s30
  s_waitcnt vmcnt(11) lgkmcnt(3)
  v_mfma_f32_16x16x32_bf16 v[32:35], v[220:223], v[64:67], v[32:35]
  ds_read_b128 v[48:51], v4 offset:32768
  s_waitcnt lgkmcnt(3)
  v_mfma_f32_16x16x32_bf16 v[36:39], v[220:223], v[68:71], v[36:39]
  ds_read_b128 v[52:55], v4 offset:33024
  s_waitcnt lgkmcnt(3)
  v_mfma_f32_16x16x32_bf16 v[40:43], v[220:223], v[72:75], v[40:43]
  ds_read_b128 v[56:59], v4 offset:33280
  s_waitcnt lgkmcnt(3)
  v_mfma_f32_16x16x32_bf16 v[44:47], v[220:223], v[76:79], v[44:47]
  ds_read_b128 v[60:63], v4 offset:33536
  buffer_load_dwordx4 v[156:159], v9, s[40:43], s31 offen sc1
  s_add_u32 s31, s31, s30
  s_waitcnt vmcnt(11) lgkmcnt(3)
  v_mfma_f32_16x16x32_bf16 v[32:35], v[228:231], v[48:51], v[32:35]
  ds_read_b128 v[64:67], v5 offset:32768
  s_waitcnt lgkmcnt(3)
  v_mfma_f32_16x16x32_bf16 v[36:39], v[228:231], v[52:55], v[36:39]
  ds_read_b128 v[68:71], v5 offset:33024
  s_waitcnt lgkmcnt(3)
  v_mfma_f32_16x16x32_bf16 v[40:43], v[228:231], v[56:59], v[40:43]
  ds_read_b128 v[72:75], v5 offset:33280
  s_waitcnt lgkmcnt(3)
  v_mfma_f32_16x16x32_bf16 v[44:47], v[228:231], v[60:63], v[44:47]
  ds_read_b128 v[76:79], v5 offset:33536
  s_waitcnt vmcnt(10) lgkmcnt(3)
  v_mfma_f32_16x16x32_bf16 v[32:35], v[236:239], v[64:67], v[32:35]
  ds_read_b128 v[48:51], v4 offset:40960
  s_waitcnt lgkmcnt(3)
  v_mfma_f32_16x16x32_bf16 v[36:39], v[236:239], v[68:71], v[36:39]
  ds_read_b128 v[52:55], v4 offset:41216
  s_waitcnt lgkmcnt(3)
  v_mfma_f32_16x16x32_bf16 v[40:43], v[236:239], v[72:75], v[40:43]
  ds_read_b128 v[56:59], v4 offset:41472
  s_waitcnt lgkmcnt(3)
  v_mfma_f32_16x16x32_bf16 v[44:47], v[236:239], v[76:79], v[44:47]
  ds_read_b128 v[60:63], v4 offset:41728
  s_waitcnt vmcnt(9) lgkmcnt(3)
  v_mfma_f32_16x16x32_bf16 v[32:35], v[244:247], v[48:51], v[32:35]
  ds_read_b128 v[64:67], v5 offset:40960
  s_waitcnt lgkmcnt(3)
  v_mfma_f32_16x16x32_bf16 v[36:39], v[244:247], v[52:55], v[36:39]
  ds_read_b128 v[68:71], v5 offset:41216
  s_waitcnt lgkmcnt(3)
  v_mfma_f32_16x16x32_bf16 v[40:43], v[244:247], v[56:59], v[40:43]
  ds_read_b128 v[72:75], v5 offset:41472
  s_waitcnt lgkmcnt(3)
  v_mfma_f32_16x16x32_bf16 v[44:47], v[244:247], v[60:63], v[44:47]
  ds_read_b128 v[76:79], v5 offset:41728
  s_waitcnt vmcnt(8) lgkmcnt(3)
  v_mfma_f32_16x16x32_bf16 v[32:35], v[252:255], v[64:67], v[32:35]
  ds_read_b128 v[48:51], v4 offset:49152
  s_waitcnt lgkmcnt(3)
  v_mfma_f32_16x16x32_bf16 v[36:39], v[252:255], v[68:71], v[36:39]
  ds_read_b128 v[52:55], v4 offset:49408
  s_waitcnt lgkmcnt(3)
  v_mfma_f32_16x16x32_bf16 v[40:43], v[252:255], v[72:75], v[40:43]
  ds_read_b128 v[56:59], v4 offset:49664
  s_waitcnt lgkmcnt(3)
  v_mfma_f32_16x16x32_bf16 v[44:47], v[252:255], v[76:79], v[44:47]
  ds_read_b128 v[60:63], v4 offset:49920
  s_waitcnt vmcnt(7) lgkmcnt(3)
  v_mfma_f32_16x16x32_bf16 v[32:35], v[100:103], v[48:51], v[32:35]
  ds_read_b128 v[64:67], v5 offset:49152
  s_waitcnt lgkmcnt(3)
  v_mfma_f32_16x16x32_bf16 v[36:39], v[100:103], v[52:55], v[36:39]
  ds_read_b128 v[68:71], v5 offset:49408
  s_waitcnt lgkmcnt(3)
  v_mfma_f32_16x16x32_bf16 v[40:43], v[100:103], v[56:59], v[40:43]
  ds_read_b128 v[72:75], v5 offset:49664
  s_waitcnt lgkmcnt(3)
  v_mfma_f32_16x16x32_bf16 v[44:47], v[100:103], v[60:63], v[44:47]
  ds_read_b128 v[76:79], v5 offset:49920
  s_waitcnt vmcnt(6) lgkmcnt(3)
  v_mfma_f32_16x16x32_bf16 v[32:35], v[108:111], v[64:67], v[32:35]
  ds_read_b128 v[48:51], v4 offset:57344
  s_waitcnt lgkmcnt(3)
  v_mfma_f32_16x16x32_bf16 v[36:39], v[108:111], v[68:71], v[36:39]
  ds_read_b128 v[52:55], v4 offset:57600
  s_waitcnt lgkmcnt(3)
  v_mfma_f32_16x16x32_bf16 v[40:43], v[108:111], v[72:75], v[40:43]
  ds_read_b128 v[56:59], v4 offset:57856
  s_waitcnt lgkmcnt(3)
  v_mfma_f32_16x16x32_bf16 v[44:47], v[108:111], v[76:79], v[44:47]
  ds_read_b128 v[60:63], v4 offset:58112
  s_waitcnt vmcnt(5) lgkmcnt(3)
  v_mfma_f32_16x16x32_bf16 v[32:35], v[116:119], v[48:51], v[32:35]
  ds_read_b128 v[64:67], v5 offset:57344
  s_waitcnt lgkmcnt(3)
  v_mfma_f32_16x16x32_bf16 v[36:39], v[116:119], v[52:55], v[36:39]
  ds_read_b128 v[68:71], v5 offset:57600
  s_waitcnt lgkmcnt(3)
  v_mfma_f32_16x16x32_bf16 v[40:43], v[116:119], v[56:59], v[40:43]
  ds_read_b128 v[72:75], v5 offset:57856
  s_waitcnt lgkmcnt(3)
  v_mfma_f32_16x16x32_bf16 v[44:47], v[116:119], v[60:63], v[44:47]
  ds_read_b128 v[76:79], v5 offset:58112
  s_waitcnt vmcnt(4) lgkmcnt(3)
  v_mfma_f32_16x16x32_bf16 v[32:35], v[124:127], v[64:67], v[32:35]
  ds_read_b128 v[48:51], v6 offset:0
  s_waitcnt lgkmcnt(3)
  v_mfma_f32_16x16x32_bf16 v[36:39], v[124:127], v[68:71], v[36:39]
  ds_read_b128 v[52:55], v6 offset:256
  s_waitcnt lgkmcnt(3)
  v_mfma_f32_16x16x32_bf16 v[40:43], v[124:127], v[72:75], v[40:43]
  ds_read_b128 v[56:59], v6 offset:512
  s_waitcnt lgkmcnt(3)
  v_mfma_f32_16x16x32_bf16 v[44:47], v[124:127], v[76:79], v[44:47]
  ds_read_b128 v[60:63], v6 offset:768
  s_waitcnt vmcnt(3) lgkmcnt(3)
  v_mfma_f32_16x16x32_bf16 v[32:35], v[132:135], v[48:51], v[32:35]
  ds_read_b128 v[64:67], v7 offset:0
  s_waitcnt lgkmcnt(3)
  v_mfma_f32_16x16x32_bf16 v[36:39], v[132:135], v[52:55], v[36:39]
  ds_read_b128 v[68:71], v7 offset:256
  s_waitcnt lgkmcnt(3)
  v_mfma_f32_16x16x32_bf16 v[40:43], v[132:135], v[56:59], v[40:43]
  ds_read_b128 v[72:75], v7 offset:512
  s_waitcnt lgkmcnt(3)
  v_mfma_f32_16x16x32_bf16 v[44:47], v[132:135], v[60:63], v[44:47]
  ds_read_b128 v[76:79], v7 offset:768
  s_waitcnt vmcnt(2) lgkmcnt(3)
  v_mfma_f32_16x16x32_bf16 v[32:35], v[140:143], v[64:67], v[32:35]
  ds_read_b128 v[48:51], v6 offset:8192
  s_waitcnt lgkmcnt(3)
  v_mfma_f32_16x16x32_bf16 v[36:39], v[140:143], v[68:71], v[36:39]
  ds_read_b128 v[52:55], v6 offset:8448
  s_waitcnt lgkmcnt(3)
  v_mfma_f32_16x16x32_bf16 v[40:43], v[140:143], v[72:75], v[40:43]
  ds_read_b128 v[56:59], v6 offset:8704
  s_waitcnt lgkmcnt(3)
  v_mfma_f32_16x16x32_bf16 v[44:47], v[140:143], v[76:79], v[44:47]
  ds_read_b128 v[60:63], v6 offset:8960
  s_waitcnt vmcnt(1) lgkmcnt(3)
  v_mfma_f32_16x16x32_bf16 v[32:35], v[148:151], v[48:51], v[32:35]
  ds_read_b128 v[64:67], v7 offset:8192
  s_waitcnt lgkmcnt(3)
  v_mfma_f32_16x16x32_bf16 v[36:39], v[148:151], v[52:55], v[36:39]
  ds_read_b128 v[68:71], v7 offset:8448
  s_waitcnt lgkmcnt(3)
  v_mfma_f32_16x16x32_bf16 v[40:43], v[148:151], v[56:59], v[40:43]
  ds_read_b128 v[72:75], v7 offset:8704
  s_waitcnt lgkmcnt(3)
  v_mfma_f32_16x16x32_bf16 v[44:47], v[148:151], v[60:63], v[44:47]
  ds_read_b128 v[76:79], v7 offset:8960
  s_waitcnt vmcnt(0) lgkmcnt(3)
  v_mfma_f32_16x16x32_bf16 v[32:35], v[156:159], v[64:67], v[32:35]
  s_waitcnt lgkmcnt(2)
  v_mfma_f32_16x16x32_bf16 v[36:39], v[156:159], v[68:71], v[36:39]
  s_waitcnt lgkmcnt(1)
  v_mfma_f32_16x16x32_bf16 v[40:43], v[156:159], v[72:75], v[40:43]
  s_waitcnt lgkmcnt(0)
  v_mfma_f32_16x16x32_bf16 v[44:47], v[156:159], v[76:79], v[44:47]
  v_mov_b32 v96, 0x3ea52b5c
  s_nop 0
  v_mul_f32 v32, v96, v32
  v_mul_f32 v33, v96, v33
  v_mul_f32 v34, v96, v34
  v_mul_f32 v35, v96, v35
  v_mul_f32 v36, v96, v36
  v_mul_f32 v37, v96, v37
  v_mul_f32 v38, v96, v38
  v_mul_f32 v39, v96, v39
  v_mul_f32 v40, v96, v40
  v_mul_f32 v41, v96, v41
  v_mul_f32 v42, v96, v42
  v_mul_f32 v43, v96, v43
  v_mul_f32 v44, v96, v44
  v_mul_f32 v45, v96, v45
  v_mul_f32 v46, v96, v46
  v_mul_f32 v47, v96, v47
  v_cvt_pk_bf16_f32 v32, v32, v33
  v_cvt_pk_bf16_f32 v33, v34, v35
  ds_write_b64 v84, v[32:33]
  v_cvt_pk_bf16_f32 v36, v36, v37
  v_cvt_pk_bf16_f32 v37, v38, v39
  ds_write_b64 v85, v[36:37]
  v_cvt_pk_bf16_f32 v40, v40, v41
  v_cvt_pk_bf16_f32 v41, v42, v43
  ds_write_b64 v86, v[40:41]
  v_cvt_pk_bf16_f32 v44, v44, v45
  v_cvt_pk_bf16_f32 v45, v46, v47
  ds_write_b64 v87, v[44:45]
  s_branch L_gd_22
L_gp_21:
  s_lshl_b32 s50, s44, 3
  s_add_u32 s50, s50, s45
  s_mul_i32 s50, s50, 22528
  s_add_u32 s50, s50, 8388608
  s_min_u32 s51, s46, 4
  s_lshl_b32 s51, s51, 10
  v_add_u32 v48, s51, v2
  v_add_u32 v49, 90112, v48
  s_lshl_b32 s54, s45, 12
  s_lshl_b32 s51, s44, 7
  s_add_u32 s54, s54, s51
  s_add_u32 s54, s54, 851968
  s_waitcnt lgkmcnt(0)
  v_mov_b32 v8, 89608
  v_mov_b32 v9, 1
  s_mov_b64 exec, 1
  ds_add_u32 v8, v9
  s_mov_b64 exec, -1
  s_mov_b32 s61, 0
L_lj_24:
  ds_read_b32 v9, v8
  s_waitcnt lgkmcnt(0)
  v_readfirstlane_b32 s60, v9
  s_nop 1
  s_cmp_ge_u32 s60, 6
  s_cbranch_scc1 L_ljd_25
  s_add_u32 s61, s61, 1
  s_cmp_lt_u32 s61, 320000
  s_cbranch_scc1 L_lj_24
L_ljd_25:
  ds_read_b128 v[64:67], v49 offset:0
  ds_read_b128 v[68:71], v49 offset:5120
  ds_read_b128 v[72:75], v49 offset:10240
  ds_read_b128 v[76:79], v49 offset:15360
  ds_read_b128 v[80:83], v49 offset:20480
  s_waitcnt lgkmcnt(4)
  buffer_store_dwordx4 v[64:67], v48, s[32:35], s50 offen sc1
  s_add_u32 s50, s50, 5120
  s_waitcnt lgkmcnt(3)
  buffer_store_dwordx4 v[68:71], v48, s[32:35], s50 offen sc1
  s_add_u32 s50, s50, 5120
  s_waitcnt lgkmcnt(2)
  buffer_store_dwordx4 v[72:75], v48, s[32:35], s50 offen sc1
  s_add_u32 s50, s50, 5120
  s_waitcnt lgkmcnt(1)
  buffer_store_dwordx4 v[76:79], v48, s[32:35], s50 offen sc1
  s_add_u32 s50, s50, 5120
  s_cmp_lt_u32 s46, 2
  s_cbranch_scc0 L_w_26
  s_waitcnt lgkmcnt(0)
  buffer_store_dwordx4 v[80:83], v48, s[32:35], s50 offen sc1
  s_add_u32 s50, s50, 5120
L_w_26:
  v_mov_b32 v16, 89600
  v_mov_b32 v17, 1
  s_waitcnt vmcnt(0) lgkmcnt(0)
  s_mov_b64 exec, 1
  ds_add_rtn_u32 v17, v16, v17
  s_mov_b64 exec, -1
  s_waitcnt lgkmcnt(0)
  v_readfirstlane_b32 s51, v17
  s_nop 1
  s_cmp_eq_u32 s51, 4
  s_cbranch_scc0 L_kvs_27
  s_mov_b64 exec, 1
  buffer_store_dword v3, off, s[32:35], s54 sc1
  s_mov_b64 exec, -1
L_kvs_27:
L_gd_22:
  s_setprio 0
  v_mov_b32 v246, v10
  v_mov_b32 v247, v11
  v_mov_b32 v248, v12
  v_mov_b32 v249, v13
  v_mov_b32 v250, v14
  v_mov_b32 v251, v15
  s_mul_i32 s51, s97, 11264
  s_mul_i32 s52, s96, 2816
  s_add_u32 s51, s51, s52
  v_add_u32 v88, s51, v2
  v_and_b32 v224, 31, v1
  v_lshlrev_b32 v225, 3, v224
  v_add_u32 v225, 1024, v225
  v_add_u32 v90, s51, v225
  v_lshrrev_b32 v226, 5, v1
  v_bfe_u32 v227, v1, 2, 2
  v_lshl_add_u32 v227, v226, 2, v227
  v_mul_u32_u24 v227, 48, v227
  v_bfe_u32 v228, v1, 4, 1
  v_lshl_add_u32 v227, v228, 5, v227
  v_and_b32 v228, 3, v1
  v_lshl_add_u32 v227, v228, 3, v227
  v_add_u32 v227, 1280, v227
  v_add_u32 v92, s51, v227
  v_add_u32 v89, 56320, v88
  v_add_u32 v91, 56320, v90
  v_add_u32 v93, 56320, v92
  s_mul_i32 s51, s97, 5120
  s_mul_i32 s52, s96, 1280
  s_add_u32 s51, s51, s52
  s_add_u32 s51, s51, 112640
  v_add_u32 v232, s51, v2
  v_add_u32 v233, s51, v225
  v_mov_b32 v14, 0
  v_mov_b32 v15, 0
  v_mov_b32 v22, 0
  v_mov_b32 v23, 0
  v_mov_b32 v30, 0
  v_mov_b32 v31, 0
  v_mov_b32 v38, 0
  v_mov_b32 v39, 0
  v_lshlrev_b32 v226, 2, v226
  v_add_u32 v228, 0, v226
  v_cmp_le_u32 s[64:65], v228, v224
  v_add_u32 v228, 1, v226
  v_cmp_le_u32 s[66:67], v228, v224
  v_add_u32 v228, 2, v226
  v_cmp_le_u32 s[68:69], v228, v224
  v_add_u32 v228, 3, v226
  v_cmp_le_u32 s[70:71], v228, v224
  v_add_u32 v228, 8, v226
  v_cmp_le_u32 s[72:73], v228, v224
  v_add_u32 v228, 9, v226
  v_cmp_le_u32 s[74:75], v228, v224
  v_add_u32 v228, 10, v226
  v_cmp_le_u32 s[76:77], v228, v224
  v_add_u32 v228, 11, v226
  v_cmp_le_u32 s[78:79], v228, v224
  v_add_u32 v228, 16, v226
  v_cmp_le_u32 s[80:81], v228, v224
  v_add_u32 v228, 17, v226
  v_cmp_le_u32 s[82:83], v228, v224
  v_add_u32 v228, 18, v226
  v_cmp_le_u32 s[84:85], v228, v224
  v_add_u32 v228, 19, v226
  v_cmp_le_u32 s[86:87], v228, v224
  v_add_u32 v228, 24, v226
  v_cmp_le_u32 s[88:89], v228, v224
  v_add_u32 v228, 25, v226
  v_cmp_le_u32 s[90:91], v228, v224
  v_add_u32 v228, 26, v226
  v_cmp_le_u32 s[92:93], v228, v224
  v_add_u32 v228, 27, v226
  v_cmp_le_u32 s[94:95], v228, v224
  v_mov_b32 v228, 0
  v_mov_b32 v229, 0xffff
  v_mov_b32 v230, 0xffff0000
  v_cndmask_b32 v216, v228, v229, s[64:65]
  v_cndmask_b32 v231, v228, v230, s[66:67]
  v_or_b32 v216, v216, v231
  v_cndmask_b32 v217, v228, v229, s[68:69]
  v_cndmask_b32 v231, v228, v230, s[70:71]
  v_or_b32 v217, v217, v231
  v_cndmask_b32 v218, v228, v229, s[72:73]
  v_cndmask_b32 v231, v228, v230, s[74:75]
  v_or_b32 v218, v218, v231
  v_cndmask_b32 v219, v228, v229, s[76:77]
  v_cndmask_b32 v231, v228, v230, s[78:79]
  v_or_b32 v219, v219, v231
  v_cndmask_b32 v220, v228, v229, s[80:81]
  v_cndmask_b32 v231, v228, v230, s[82:83]
  v_or_b32 v220, v220, v231
  v_cndmask_b32 v221, v228, v229, s[84:85]
  v_cndmask_b32 v231, v228, v230, s[86:87]
  v_or_b32 v221, v221, v231
  v_cndmask_b32 v222, v228, v229, s[88:89]
  v_cndmask_b32 v231, v228, v230, s[90:91]
  v_or_b32 v222, v222, v231
  v_cndmask_b32 v223, v228, v229, s[92:93]
  v_cndmask_b32 v231, v228, v230, s[94:95]
  v_or_b32 v223, v223, v231
  s_cmp_lt_u32 s46, 4
  s_cbranch_scc0 L_pre_28
  s_cmp_ge_u32 s48, 22
  s_cbranch_scc0 L_pre_28
  s_cmp_ge_u32 s48, 27
  s_cselect_b32 s51, 640, 0
  s_add_u32 s51, s51, 87040
  v_lshrrev_b32 v42, 4, v1
  v_lshlrev_b32 v42, 4, v42
  v_add_u32 v42, s51, v42
  ds_read_b128 v[100:103], v42 offset:0
  ds_read_b128 v[104:107], v42 offset:64
  ds_read_b128 v[108:111], v42 offset:128
  ds_read_b128 v[112:115], v42 offset:192
  ds_read_b128 v[116:119], v42 offset:256
  ds_read_b128 v[120:123], v42 offset:320
  ds_read_b128 v[124:127], v42 offset:384
  ds_read_b128 v[128:131], v42 offset:448
  ds_read_b128 v[132:135], v42 offset:512
  ds_read_b128 v[136:139], v42 offset:576
L_pre_28:
  s_cmp_eq_u32 s46, 7
  s_cbranch_scc0 L_w_29
  v_and_b32 v224, 3, v1
  v_add_u32 v224, s44, v224
  v_subrev_u32 v224, 4, v224
  v_max_i32 v224, 0, v224
  v_lshlrev_b32 v224, 7, v224
  s_lshl_b32 s51, s45, 12
  s_add_u32 s51, s51, 851968
  v_add_u32 v224, s51, v224
  s_mov_b32 s61, 0
L_poll_30:
  buffer_load_dword v225, v224, s[32:35], 0 offen sc1
L_pchk_32:
  s_waitcnt vmcnt(0)
  v_cmp_ne_u32 vcc, s47, v225
  s_nop 1
  s_cmp_eq_u64 vcc, 0
  s_cbranch_scc1 L_pdone_31
  s_add_u32 s61, s61, 1
  s_cmp_lt_u32 s61, 40000
  s_cbranch_scc1 L_poll_30
L_pdone_31:
L_w_29:
  s_waitcnt lgkmcnt(0)
  s_barrier
  s_lshr_b32 s51, s46, 1
  s_add_u32 s52, s44, s51
  s_sub_i32 s52, s52, 4
  s_max_i32 s52, s52, 0
  s_lshl_b32 s52, s52, 3
  s_add_u32 s52, s52, s45
  s_mul_i32 s52, s52, 22528
  s_and_b32 s53, s46, 1
  s_mul_i32 s53, s53, 11264
  s_add_u32 s52, s52, s53
  s_add_u32 s52, s52, 8388608
  s_mul_i32 s53, s46, 11264
  s_mov_b32 m0, s53
  s_nop 0
  buffer_load_dwordx4 v2, s[32:35], s52 offen sc1 lds
  buffer_load_dwordx4 v2, s[32:35], s52 offen offset:1024 sc1 lds
  buffer_load_dwordx4 v2, s[32:35], s52 offen offset:2048 sc1 lds
  buffer_load_dwordx4 v2, s[32:35], s52 offen offset:3072 sc1 lds
  s_add_u32 s52, s52, 4096
  s_add_u32 s53, s53, 4096
  s_mov_b32 m0, s53
  s_nop 0
  buffer_load_dwordx4 v2, s[32:35], s52 offen sc1 lds
  buffer_load_dwordx4 v2, s[32:35], s52 offen offset:1024 sc1 lds
  buffer_load_dwordx4 v2, s[32:35], s52 offen offset:2048 sc1 lds
  buffer_load_dwordx4 v2, s[32:35], s52 offen offset:3072 sc1 lds
  s_add_u32 s52, s52, 4096
  s_add_u32 s53, s53, 4096
  s_mov_b32 m0, s53
  s_nop 0
  buffer_load_dwordx4 v2, s[32:35], s52 offen sc1 lds
  buffer_load_dwordx4 v2, s[32:35], s52 offen offset:1024 sc1 lds
  buffer_load_dwordx4 v2, s[32:35], s52 offen offset:2048 sc1 lds
  s_lshl_b32 s51, s44, 1
  s_add_u32 s51, s51, s97
  s_sub_i32 s50, 8, s51
  ds_read_b128 v[8:11], v232
  ds_read_b64 v[12:13], v233
  v_cmp_gt_u32 s[58:59], 32, v1
  v_mov_b32 v228, 0
  s_waitcnt lgkmcnt(0)
  v_cndmask_b32 v12, v228, v12, s[58:59]
  v_cndmask_b32 v13, v228, v13, s[58:59]
  s_waitcnt vmcnt(0)
  s_barrier
  s_cmp_ge_u32 s48, 22
  s_cbranch_scc1 L_s2m_33
  s_cmp_ge_u32 s48, 20
  s_cbranch_scc1 L_s2d_34
  s_cmp_eq_u32 s46, 7
  s_cbranch_scc1 L_s2d_34
  s_mov_b32 s40, s12
  s_mov_b32 s41, s13
  s_mov_b32 s42, 2211840
  s_mov_b32 s43, 0x20000
  s_lshl_b32 s52, s46, 6
  v_add_u32 v140, s52, v1
  v_mul_u32_u24 v142, 4682, v140
  v_lshrrev_b32 v142, 16, v142
  v_mul_u32_u24 v143, 14, v142
  v_sub_u32 v143, v140, v143
  v_mul_u32_u24 v142, 3456, v142
  v_lshl_add_u32 v141, v143, 4, v142
  s_mul_i32 s52, s48, 110592
  s_mul_i32 s53, s45, 224
  s_cmp_eq_u32 s45, 7
  s_cselect_b32 s53, 1536, s53
  s_add_u32 s52, s52, s53
  s_add_u32 s54, s52, 1728
  s_lshl_b32 s55, s46, 10
  s_add_u32 m0, s55, 133120
  s_nop 0
  buffer_load_dwordx4 v141, s[40:43], s54 offen nt lds
  s_add_u32 m0, s55, 140288
  s_nop 0
  buffer_load_dwordx4 v141, s[40:43], s52 offen nt lds
  s_cmp_lt_u32 s46, 5
  s_cbranch_scc0 L_s2d_34
  s_mov_b32 s40, s18
  s_mov_b32 s41, s19
  s_mov_b32 s42, 1105920
  s_mov_b32 s43, 0x20000
  v_mul_u32_u24 v142, 6554, v140
  v_lshrrev_b32 v142, 16, v142
  v_mul_u32_u24 v143, 10, v142
  v_sub_u32 v143, v140, v143
  v_mul_u32_u24 v142, 1280, v142
  v_lshl_add_u32 v141, v143, 4, v142
  s_mul_i32 s52, s48, 40960
  s_mul_i32 s54, s45, 160
  s_add_u32 s52, s52, s54
  s_add_u32 m0, s55, 122880
  s_nop 0
  buffer_load_dwordx4 v141, s[40:43], s52 offen nt lds
  s_cmp_lt_u32 s48, 7
  s_cbranch_scc0 L_s2d_34
  s_add_u32 s52, s52, 819200
  s_add_u32 m0, s55, 128000
  s_nop 0
  buffer_load_dwordx4 v141, s[40:43], s52 offen nt lds
  s_branch L_s2d_34
L_s2m_33:
  s_mov_b32 s40, s22
  s_mov_b32 s41, s23
  s_mov_b32 s42, 4915200
  s_mov_b32 s43, 0x20000
  s_sub_u32 s52, s48, 22
  s_lshl_b32 s52, s52, 3
  s_add_u32 s52, s52, s45
  s_cmp_ge_u32 s52, 40
  s_cselect_b32 s53, 2452480, 0
  s_lshl_b32 s52, s52, 7
  s_add_u32 s52, s52, s53
  s_mul_i32 s53, s46, 307200
  s_add_u32 s52, s52, s53
  s_add_u32 s52, s52, 2560
  s_mul_i32 s55, s46, 5120
  v_lshrrev_b32 v140, 3, v1
  v_mul_u32_u24 v140, 7680, v140
  v_and_b32 v141, 7, v1
  v_lshl_add_u32 v140, v141, 4, v140
  s_add_u32 m0, s55, 122880
  s_nop 0
  buffer_load_dwordx4 v140, s[40:43], s52 offen nt lds
  s_add_u32 s52, s52, 61440
  s_add_u32 m0, s55, 123904
  s_nop 0
  buffer_load_dwordx4 v140, s[40:43], s52 offen nt lds
  s_add_u32 s52, s52, 61440
  s_add_u32 m0, s55, 124928
  s_nop 0
  buffer_load_dwordx4 v140, s[40:43], s52 offen nt lds
  s_add_u32 s52, s52, 61440
  s_add_u32 m0, s55, 125952
  s_nop 0
  buffer_load_dwordx4 v140, s[40:43], s52 offen nt lds
  s_add_u32 s52, s52, 61440
  s_add_u32 m0, s55, 126976
  s_nop 0
  buffer_load_dwordx4 v140, s[40:43], s52 offen nt lds
  s_add_u32 s52, s52, 61440
L_s2d_34:
  s_cmp_ge_u32 s46, 4
  s_cbranch_scc0 L_w_35
  s_setprio 1
L_w_35:
  ds_read_b128 v[16:19], v88 offset:0
  ds_read_b64 v[20:21], v90 offset:0
  ds_read_b128 v[24:27], v89 offset:33792
  ds_read_b64 v[28:29], v91 offset:33792
  s_waitcnt lgkmcnt(2)
  v_mfma_f32_32x32x16_bf16 v[40:55], v[16:19], v[8:11], 0
  ds_read_b128 v[32:35], v88 offset:11264
  ds_read_b64 v[36:37], v90 offset:11264
  v_mfma_f32_32x32x16_bf16 v[40:55], v[20:23], v[12:15], v[40:55]
  s_waitcnt lgkmcnt(2)
  v_mfma_f32_32x32x16_bf16 v[56:71], v[24:27], v[8:11], 0
  ds_read_b128 v[16:19], v88 offset:22528
  ds_read_b64 v[20:21], v90 offset:22528
  v_mfma_f32_32x32x16_bf16 v[56:71], v[28:31], v[12:15], v[56:71]
  s_cmp_gt_i32 s50, 0
  s_cbranch_scc1 L_inv_36
L_invb_37:
  s_waitcnt lgkmcnt(2)
  v_mfma_f32_32x32x16_bf16 v[72:87], v[32:35], v[8:11], 0
  ds_read_b128 v[24:27], v88 offset:33792
  ds_read_b64 v[28:29], v90 offset:33792
  v_mfma_f32_32x32x16_bf16 v[72:87], v[36:39], v[12:15], v[72:87]
  s_nop 4
  v_cndmask_b32 v56, v40, v56, s[64:65]
  v_cndmask_b32 v57, v41, v57, s[66:67]
  v_cndmask_b32 v58, v42, v58, s[68:69]
  v_cndmask_b32 v59, v43, v59, s[70:71]
  v_cndmask_b32 v60, v44, v60, s[72:73]
  v_cndmask_b32 v61, v45, v61, s[74:75]
  v_cndmask_b32 v62, v46, v62, s[76:77]
  v_cndmask_b32 v63, v47, v63, s[78:79]
  v_cndmask_b32 v64, v48, v64, s[80:81]
  v_cndmask_b32 v65, v49, v65, s[82:83]
  v_cndmask_b32 v66, v50, v66, s[84:85]
  v_cndmask_b32 v67, v51, v67, s[86:87]
  v_cndmask_b32 v68, v52, v68, s[88:89]
  v_cndmask_b32 v69, v53, v69, s[90:91]
  v_cndmask_b32 v70, v54, v70, s[92:93]
  v_cndmask_b32 v71, v55, v71, s[94:95]
  v_max_f32 v94, v56, v57
  v_max_f32 v231, v58, v59
  s_waitcnt lgkmcnt(2)
  v_mfma_f32_32x32x16_bf16 v[40:55], v[16:19], v[8:11], 0
  v_max3_f32 v94, v94, v60, v61
  v_max3_f32 v231, v231, v62, v63
  v_max3_f32 v94, v94, v64, v65
  ds_read_b128 v[32:35], v88 offset:45056
  ds_read_b64 v[36:37], v90 offset:45056
  v_mfma_f32_32x32x16_bf16 v[40:55], v[20:23], v[12:15], v[40:55]
  v_max3_f32 v231, v231, v66, v67
  v_max3_f32 v94, v94, v68, v69
  v_max3_f32 v231, v231, v70, v71
  s_cmp_gt_i32 s50, 1
  s_cbranch_scc1 L_inv_38
L_invb_39:
  v_max3_f32 v94, v94, v72, v73
  v_max3_f32 v231, v231, v74, v75
  s_waitcnt lgkmcnt(2)
  v_mfma_f32_32x32x16_bf16 v[56:71], v[24:27], v[8:11], 0
  v_max3_f32 v94, v94, v76, v77
  v_max3_f32 v231, v231, v78, v79
  v_max3_f32 v94, v94, v80, v81
  ds_read_b128 v[16:19], v89 offset:0
  ds_read_b64 v[20:21], v91 offset:0
  v_mfma_f32_32x32x16_bf16 v[56:71], v[28:31], v[12:15], v[56:71]
  v_max3_f32 v231, v231, v82, v83
  v_max3_f32 v94, v94, v84, v85
  v_max3_f32 v231, v231, v86, v87
  s_cmp_gt_i32 s50, 2
  s_cbranch_scc1 L_inv_40
L_invb_41:
  v_max3_f32 v94, v94, v40, v41
  v_max3_f32 v231, v231, v42, v43
  s_waitcnt lgkmcnt(2)
  v_mfma_f32_32x32x16_bf16 v[72:87], v[32:35], v[8:11], 0
  v_max3_f32 v94, v94, v44, v45
  v_max3_f32 v231, v231, v46, v47
  v_max3_f32 v94, v94, v48, v49
  ds_read_b128 v[24:27], v89 offset:11264
  ds_read_b64 v[28:29], v91 offset:11264
  v_mfma_f32_32x32x16_bf16 v[72:87], v[36:39], v[12:15], v[72:87]
  v_max3_f32 v231, v231, v50, v51
  v_max3_f32 v94, v94, v52, v53
  v_max3_f32 v231, v231, v54, v55
  s_cmp_gt_i32 s50, 3
  s_cbranch_scc1 L_inv_42
L_invb_43:
  v_max3_f32 v94, v94, v56, v57
  v_max3_f32 v231, v231, v58, v59
  s_waitcnt lgkmcnt(2)
  v_mfma_f32_32x32x16_bf16 v[40:55], v[16:19], v[8:11], 0
  v_max3_f32 v94, v94, v60, v61
  v_max3_f32 v231, v231, v62, v63
  v_max3_f32 v94, v94, v64, v65
  ds_read_b128 v[32:35], v89 offset:22528
  ds_read_b64 v[36:37], v91 offset:22528
  v_mfma_f32_32x32x16_bf16 v[40:55], v[20:23], v[12:15], v[40:55]
  v_max3_f32 v231, v231, v66, v67
  v_max3_f32 v94, v94, v68, v69
  v_max3_f32 v231, v231, v70, v71
  s_cmp_gt_i32 s50, 4
  s_cbranch_scc1 L_inv_44
L_invb_45:
  v_max3_f32 v94, v94, v72, v73
  v_max3_f32 v231, v231, v74, v75
  s_waitcnt lgkmcnt(2)
  v_mfma_f32_32x32x16_bf16 v[56:71], v[24:27], v[8:11], 0
  v_max3_f32 v94, v94, v76, v77
  v_max3_f32 v231, v231, v78, v79
  v_max3_f32 v94, v94, v80, v81
  v_mfma_f32_32x32x16_bf16 v[56:71], v[28:31], v[12:15], v[56:71]
  v_max3_f32 v231, v231, v82, v83
  v_max3_f32 v94, v94, v84, v85
  v_max3_f32 v231, v231, v86, v87
  s_cmp_gt_i32 s50, 5
  s_cbranch_scc1 L_inv_46
L_invb_47:
  v_max3_f32 v94, v94, v40, v41
  v_max3_f32 v231, v231, v42, v43
  s_waitcnt lgkmcnt(0)
  v_mfma_f32_32x32x16_bf16 v[72:87], v[32:35], v[8:11], 0
  v_max3_f32 v94, v94, v44, v45
  v_max3_f32 v231, v231, v46, v47
  v_max3_f32 v94, v94, v48, v49
  v_mfma_f32_32x32x16_bf16 v[72:87], v[36:39], v[12:15], v[72:87]
  v_max3_f32 v231, v231, v50, v51
  v_max3_f32 v94, v94, v52, v53
  v_max3_f32 v231, v231, v54, v55
  s_cmp_gt_i32 s50, 6
  s_cbranch_scc1 L_inv_48
L_invb_49:
  v_max3_f32 v94, v94, v56, v57
  v_max3_f32 v231, v231, v58, v59
  v_max3_f32 v94, v94, v60, v61
  v_max3_f32 v231, v231, v62, v63
  v_max3_f32 v94, v94, v64, v65
  v_max3_f32 v231, v231, v66, v67
  v_max3_f32 v94, v94, v68, v69
  v_max3_f32 v231, v231, v70, v71
  s_cmp_gt_i32 s50, 7
  s_cbranch_scc1 L_inv_50
L_invb_51:
  v_max3_f32 v94, v94, v72, v73
  v_max3_f32 v231, v231, v74, v75
  v_max3_f32 v94, v94, v76, v77
  v_max3_f32 v231, v231, v78, v79
  v_max3_f32 v94, v94, v80, v81
  v_max3_f32 v231, v231, v82, v83
  v_max3_f32 v94, v94, v84, v85
  v_max3_f32 v231, v231, v86, v87
  v_max_f32 v94, v94, v231
  s_waitcnt vmcnt(0)
  s_barrier
  s_cmp_ge_u32 s48, 22
  s_cbranch_scc1 L_j2m_52
  s_cmp_ge_u32 s48, 20
  s_cbranch_scc1 L_j2d_53
  s_cmp_eq_u32 s46, 7
  s_cbranch_scc1 L_j2d_53
  v_lshrrev_b32 v142, 4, v1
  v_bfe_u32 v143, v1, 2, 2
  v_lshl_add_u32 v142, v142, 3, v143
  v_mul_u32_u24 v142, 224, v142
  v_and_b32 v143, 3, v1
  v_lshl_add_u32 v140, v143, 3, v142
  v_lshrrev_b32 v142, 4, v1
  v_bfe_u32 v143, v1, 2, 2
  v_lshl_add_u32 v142, v142, 3, v143
  v_mul_u32_u24 v142, 160, v142
  v_and_b32 v143, 3, v1
  v_lshl_add_u32 v141, v143, 3, v142
  s_lshl_b32 s57, s46, 5
  s_add_u32 s57, s57, 122880
  v_add_u32 v140, s57, v140
  v_add_u32 v141, s57, v141
  s_lshl_b32 s57, s46, 10
  s_mul_i32 s51, s45, 20
  s_add_u32 s51, s51, s48
  s_mul_i32 s52, s51, 14336
  s_add_u32 s52, s52, s57
  s_add_u32 s52, s52, 4718592
  s_add_u32 s55, s52, 7168
  s_mul_i32 s51, s45, 27
  s_add_u32 s51, s51, s48
  s_mul_i32 s54, s51, 5120
  s_add_u32 s54, s54, s57
  s_add_u32 s54, s54, 7077888
  s_add_u32 s56, s54, 102400
  ds_read_b64_tr_b16 v[100:101], v140 offset:10240
  ds_read_b64_tr_b16 v[102:103], v140 offset:11136
  ds_read_b64_tr_b16 v[104:105], v140 offset:17408
  ds_read_b64_tr_b16 v[106:107], v140 offset:18304
  ds_read_b64_tr_b16 v[108:109], v141 offset:0
  ds_read_b64_tr_b16 v[110:111], v141 offset:640
  ds_read_b64_tr_b16 v[112:113], v141 offset:5120
  ds_read_b64_tr_b16 v[114:115], v141 offset:5760
  s_waitcnt lgkmcnt(0)
  buffer_store_dwordx4 v[100:103], v2, s[32:35], s52 offen sc1
  buffer_store_dwordx4 v[104:107], v2, s[32:35], s55 offen sc1
  s_cmp_lt_u32 s46, 5
  s_cbranch_scc0 L_j2d_53
  buffer_store_dwordx4 v[108:111], v2, s[32:35], s54 offen sc1
  s_cmp_lt_u32 s48, 7
  s_cbranch_scc0 L_j2d_53
  buffer_store_dwordx4 v[112:115], v2, s[32:35], s56 offen sc1
  s_branch L_j2d_53
L_j2m_52:
  s_cmp_lt_u32 s46, 4
  s_cbranch_scc0 L_j2d_53
  s_sub_u32 s52, s48, 22
  s_lshl_b32 s52, s52, 3
  s_add_u32 s52, s52, s45
  s_lshl_b32 s57, s52, 8
  s_lshl_b32 s51, s46, 6
  s_add_u32 s57, s57, s51
  s_add_u32 s57, s57, 65536
  v_lshrrev_b32 v233, 4, v1
  v_bfe_u32 v234, v1, 2, 2
  v_lshl_add_u32 v233, v233, 3, v234
  v_mul_u32_u24 v233, 128, v233
  v_and_b32 v234, 3, v1
  v_lshl_add_u32 v232, v234, 3, v233
  s_lshl_b32 s51, s46, 5
  s_add_u32 s51, s51, 122880
  v_add_u32 v232, s51, v232
  ds_read_b64_tr_b16 v[140:141], v232 offset:0
  ds_read_b64_tr_b16 v[142:143], v232 offset:512
  ds_read_b64_tr_b16 v[144:145], v232 offset:4096
  ds_read_b64_tr_b16 v[146:147], v232 offset:4608
  ds_read_b64_tr_b16 v[148:149], v232 offset:8192
  ds_read_b64_tr_b16 v[150:151], v232 offset:8704
  ds_read_b64_tr_b16 v[152:153], v232 offset:12288
  ds_read_b64_tr_b16 v[154:155], v232 offset:12800
  ds_read_b64_tr_b16 v[156:157], v232 offset:16384
  ds_read_b64_tr_b16 v[158:159], v232 offset:16896
  s_waitcnt lgkmcnt(0)
  v_mfma_f32_16x16x32_bf16 v[236:239], v[140:143], v[100:103], 0
  v_mfma_f32_16x16x32_bf16 v[236:239], v[144:147], v[104:107], v[236:239]
  v_mfma_f32_16x16x32_bf16 v[236:239], v[148:151], v[108:111], v[236:239]
  v_mfma_f32_16x16x32_bf16 v[236:239], v[152:155], v[112:115], v[236:239]
  v_mfma_f32_16x16x32_bf16 v[236:239], v[156:159], v[116:119], v[236:239]
  ds_read_b64_tr_b16 v[140:141], v232 offset:20480
  ds_read_b64_tr_b16 v[142:143], v232 offset:20992
  ds_read_b64_tr_b16 v[144:145], v232 offset:24576
  ds_read_b64_tr_b16 v[146:147], v232 offset:25088
  ds_read_b64_tr_b16 v[148:149], v232 offset:28672
  ds_read_b64_tr_b16 v[150:151], v232 offset:29184
  ds_read_b64_tr_b16 v[152:153], v232 offset:32768
  ds_read_b64_tr_b16 v[154:155], v232 offset:33280
  ds_read_b64_tr_b16 v[156:157], v232 offset:36864
  ds_read_b64_tr_b16 v[158:159], v232 offset:37376
  s_waitcnt lgkmcnt(0)
  v_mfma_f32_16x16x32_bf16 v[236:239], v[140:143], v[120:123], v[236:239]
  v_mfma_f32_16x16x32_bf16 v[236:239], v[144:147], v[124:127], v[236:239]
  v_mfma_f32_16x16x32_bf16 v[236:239], v[148:151], v[128:131], v[236:239]
  v_mfma_f32_16x16x32_bf16 v[236:239], v[152:155], v[132:135], v[236:239]
  v_mfma_f32_16x16x32_bf16 v[236:239], v[156:159], v[136:139], v[236:239]
  v_and_b32 v233, 15, v1
  v_cmp_eq_u32 s[58:59], 0, v233
  v_mov_b32 v233, 0x40000000
  s_nop 0
  v_cndmask_b32 v233, v233, v1, s[58:59]
  v_mov_b32 v234, 0xff
  s_lshr_b32 s60, s47, 0
  v_mov_b32 v235, s60
  v_bfi_b32 v236, v234, v235, v236
  s_lshr_b32 s60, s47, 8
  v_mov_b32 v235, s60
  v_bfi_b32 v237, v234, v235, v237
  s_lshr_b32 s60, s47, 16
  v_mov_b32 v235, s60
  v_bfi_b32 v238, v234, v235, v238
  s_lshr_b32 s60, s47, 24
  v_mov_b32 v235, s60
  v_bfi_b32 v239, v234, v235, v239
  buffer_store_dwordx4 v[236:239], v233, s[32:35], s57 offen sc1
L_j2d_53:
  ds_read_b128 v[16:19], v88 offset:0
  ds_read_b64 v[20:21], v90 offset:0
  ds_read_b128 v[24:27], v89 offset:33792
  ds_read_b64 v[28:29], v91 offset:33792
  v_mov_b32 v224, v94
  s_nop 1
  v_permlane32_swap_b32 v224, v94
  v_max_f32 v94, v94, v224
  v_sub_f32 v160, 0, v94
  v_sub_f32 v161, 0, v94
  v_sub_f32 v162, 0, v94
  v_sub_f32 v163, 0, v94
  v_sub_f32 v164, 0, v94
  v_sub_f32 v165, 0, v94
  v_sub_f32 v166, 0, v94
  v_sub_f32 v167, 0, v94
  v_sub_f32 v168, 0, v94
  v_sub_f32 v169, 0, v94
  v_sub_f32 v170, 0, v94
  v_sub_f32 v171, 0, v94
  v_sub_f32 v172, 0, v94
  v_sub_f32 v173, 0, v94
  v_sub_f32 v174, 0, v94
  v_sub_f32 v175, 0, v94
  ds_read_b128 v[32:35], v88 offset:11264
  ds_read_b64 v[36:37], v90 offset:11264
  s_waitcnt lgkmcnt(4)
  v_mfma_f32_32x32x16_bf16 v[40:55], v[16:19], v[8:11], v[160:175]
  v_mfma_f32_32x32x16_bf16 v[40:55], v[20:23], v[12:15], v[40:55]
  ds_read_b64_tr_b16 v[192:193], v92 offset:0
  ds_read_b64_tr_b16 v[194:195], v92 offset:384
  ds_read_b64_tr_b16 v[196:197], v92 offset:768
  ds_read_b64_tr_b16 v[198:199], v92 offset:1152
  s_mul_i32 s53, s45, 20
  s_mul_i32 s52, s96, 5
  s_add_u32 s53, s53, s52
  s_mul_i32 s53, s53, 5120
  s_mul_i32 s52, s97, 3072
  s_add_u32 s53, s53, s52
  s_add_u32 s53, s53, 3670016
  s_lshl_b32 s52, s97, 30
  v_add_u32 v96, s52, v2
  buffer_load_dwordx4 v[100:103], v2, s[32:35], s53 offen offset:0 sc1
  ds_read_b128 v[16:19], v88 offset:22528
  ds_read_b64 v[20:21], v90 offset:22528
  s_waitcnt lgkmcnt(8)
  v_mfma_f32_32x32x16_bf16 v[56:71], v[24:27], v[8:11], v[160:175]
  v_mfma_f32_32x32x16_bf16 v[56:71], v[28:31], v[12:15], v[56:71]
  ds_read_b64_tr_b16 v[200:201], v93 offset:33792
  ds_read_b64_tr_b16 v[202:203], v93 offset:34176
  ds_read_b64_tr_b16 v[204:205], v93 offset:34560
  ds_read_b64_tr_b16 v[206:207], v93 offset:34944
  buffer_load_dwordx4 v[104:107], v2, s[32:35], s53 offen offset:1024 sc1
  s_cmp_gt_i32 s50, 0
  s_cbranch_scc1 L_inv_54
L_invb_55:
  ds_read_b128 v[24:27], v88 offset:33792
  ds_read_b64 v[28:29], v90 offset:33792
  s_waitcnt lgkmcnt(12)
  v_mfma_f32_32x32x16_bf16 v[72:87], v[32:35], v[8:11], v[160:175]
  v_mfma_f32_32x32x16_bf16 v[72:87], v[36:39], v[12:15], v[72:87]
  v_cndmask_b32 v56, v40, v56, s[64:65]
  v_cndmask_b32 v57, v41, v57, s[66:67]
  v_cndmask_b32 v58, v42, v58, s[68:69]
  v_cndmask_b32 v59, v43, v59, s[70:71]
  v_cndmask_b32 v60, v44, v60, s[72:73]
  v_cndmask_b32 v61, v45, v61, s[74:75]
  v_cndmask_b32 v62, v46, v62, s[76:77]
  v_cndmask_b32 v63, v47, v63, s[78:79]
  v_cndmask_b32 v64, v48, v64, s[80:81]
  v_cndmask_b32 v65, v49, v65, s[82:83]
  v_cndmask_b32 v66, v50, v66, s[84:85]
  v_cndmask_b32 v67, v51, v67, s[86:87]
  v_cndmask_b32 v68, v52, v68, s[88:89]
  v_cndmask_b32 v69, v53, v69, s[90:91]
  v_cndmask_b32 v70, v54, v70, s[92:93]
  v_cndmask_b32 v71, v55, v71, s[94:95]
  v_exp_f32 v56, v56
  v_exp_f32 v57, v57
  v_exp_f32 v58, v58
  v_exp_f32 v59, v59
  v_cvt_pk_bf16_f32 v56, v56, v57
  v_exp_f32 v60, v60
  v_exp_f32 v61, v61
  v_cvt_pk_bf16_f32 v57, v58, v59
  v_exp_f32 v62, v62
  v_exp_f32 v63, v63
  v_cvt_pk_bf16_f32 v58, v60, v61
  v_exp_f32 v64, v64
  v_exp_f32 v65, v65
  v_cvt_pk_bf16_f32 v59, v62, v63
  v_exp_f32 v66, v66
  v_exp_f32 v67, v67
  v_cvt_pk_bf16_f32 v60, v64, v65
  v_exp_f32 v68, v68
  v_exp_f32 v69, v69
  v_cvt_pk_bf16_f32 v61, v66, v67
  v_exp_f32 v70, v70
  v_exp_f32 v71, v71
  v_cvt_pk_bf16_f32 v62, v68, v69
  v_cvt_pk_bf16_f32 v63, v70, v71
  v_and_b32 v208, v56, v216
  v_and_b32 v209, v57, v217
  v_and_b32 v210, v58, v218
  v_and_b32 v211, v59, v219
  v_and_b32 v212, v60, v220
  v_and_b32 v213, v61, v221
  v_and_b32 v214, v62, v222
  v_and_b32 v215, v63, v223
  v_xor_b32 v56, v56, v208
  v_xor_b32 v57, v57, v209
  v_xor_b32 v58, v58, v210
  v_xor_b32 v59, v59, v211
  v_xor_b32 v60, v60, v212
  v_xor_b32 v61, v61, v213
  v_xor_b32 v62, v62, v214
  v_xor_b32 v63, v63, v215
  s_waitcnt lgkmcnt(2)
  v_mfma_f32_32x32x16_bf16 v[176:191], v[192:195], v[56:59], 0
  v_mfma_f32_32x32x16_bf16 v[176:191], v[196:199], v[60:63], v[176:191]
  v_mfma_f32_32x32x16_bf16 v[176:191], v[200:203], v[208:211], v[176:191]
  v_mfma_f32_32x32x16_bf16 v[176:191], v[204:207], v[212:215], v[176:191]
  ds_read_b64_tr_b16 v[192:193], v92 offset:11264
  ds_read_b64_tr_b16 v[194:195], v92 offset:11648
  ds_read_b64_tr_b16 v[196:197], v92 offset:12032
  ds_read_b64_tr_b16 v[198:199], v92 offset:12416
  ds_read_b64_tr_b16 v[200:201], v92 offset:22528
  ds_read_b64_tr_b16 v[202:203], v92 offset:22912
  ds_read_b64_tr_b16 v[204:205], v92 offset:23296
  ds_read_b64_tr_b16 v[206:207], v92 offset:23680
  buffer_load_dwordx4 v[108:111], v96, s[32:35], s53 offen offset:2048 sc1
  s_add_u32 s53, s53, 5120
  buffer_load_dwordx4 v[112:115], v2, s[32:35], s53 offen offset:0 sc1
  ds_read_b128 v[32:35], v88 offset:45056
  ds_read_b64 v[36:37], v90 offset:45056
  s_waitcnt lgkmcnt(15)
  v_mfma_f32_32x32x16_bf16 v[40:55], v[16:19], v[8:11], v[160:175]
  s_cmp_gt_i32 s50, 1
  s_cbranch_scc1 L_inv_56
L_invb_57:
  v_exp_f32 v72, v72
  v_exp_f32 v73, v73
  v_exp_f32 v74, v74
  v_exp_f32 v75, v75
  v_cvt_pk_bf16_f32 v72, v72, v73
  v_mfma_f32_32x32x16_bf16 v[40:55], v[20:23], v[12:15], v[40:55]
  v_exp_f32 v76, v76
  v_exp_f32 v77, v77
  v_cvt_pk_bf16_f32 v73, v74, v75
  v_exp_f32 v78, v78
  v_exp_f32 v79, v79
  v_cvt_pk_bf16_f32 v74, v76, v77
  v_exp_f32 v80, v80
  v_exp_f32 v81, v81
  v_cvt_pk_bf16_f32 v75, v78, v79
  v_exp_f32 v82, v82
  v_exp_f32 v83, v83
  v_cvt_pk_bf16_f32 v76, v80, v81
  s_waitcnt lgkmcnt(6)
  v_mfma_f32_32x32x16_bf16 v[176:191], v[192:195], v[72:75], v[176:191]
  v_exp_f32 v84, v84
  v_exp_f32 v85, v85
  v_cvt_pk_bf16_f32 v77, v82, v83
  v_exp_f32 v86, v86
  v_exp_f32 v87, v87
  v_cvt_pk_bf16_f32 v78, v84, v85
  v_cvt_pk_bf16_f32 v79, v86, v87
  s_nop 1
  v_mfma_f32_32x32x16_bf16 v[176:191], v[196:199], v[76:79], v[176:191]
  ds_read_b64_tr_b16 v[192:193], v92 offset:33792
  ds_read_b64_tr_b16 v[194:195], v92 offset:34176
  ds_read_b64_tr_b16 v[196:197], v92 offset:34560
  ds_read_b64_tr_b16 v[198:199], v92 offset:34944
  buffer_load_dwordx4 v[116:119], v2, s[32:35], s53 offen offset:1024 sc1
  buffer_load_dwordx4 v[120:123], v96, s[32:35], s53 offen offset:2048 sc1
  s_add_u32 s53, s53, 5120
  buffer_load_dwordx4 v[124:127], v2, s[32:35], s53 offen offset:0 sc1
  ds_read_b128 v[16:19], v89 offset:0
  ds_read_b64 v[20:21], v91 offset:0
  s_waitcnt lgkmcnt(15)
  v_mfma_f32_32x32x16_bf16 v[56:71], v[24:27], v[8:11], v[160:175]
  s_cmp_gt_i32 s50, 2
  s_cbranch_scc1 L_inv_58
L_invb_59:
  v_exp_f32 v40, v40
  v_exp_f32 v41, v41
  v_exp_f32 v42, v42
  v_exp_f32 v43, v43
  v_cvt_pk_bf16_f32 v40, v40, v41
  v_mfma_f32_32x32x16_bf16 v[56:71], v[28:31], v[12:15], v[56:71]
  v_exp_f32 v44, v44
  v_exp_f32 v45, v45
  v_cvt_pk_bf16_f32 v41, v42, v43
  v_exp_f32 v46, v46
  v_exp_f32 v47, v47
  v_cvt_pk_bf16_f32 v42, v44, v45
  v_exp_f32 v48, v48
  v_exp_f32 v49, v49
  v_cvt_pk_bf16_f32 v43, v46, v47
  v_exp_f32 v50, v50
  v_exp_f32 v51, v51
  v_cvt_pk_bf16_f32 v44, v48, v49
  s_waitcnt lgkmcnt(8)
  v_mfma_f32_32x32x16_bf16 v[176:191], v[200:203], v[40:43], v[176:191]
  v_exp_f32 v52, v52
  v_exp_f32 v53, v53
  v_cvt_pk_bf16_f32 v45, v50, v51
  v_exp_f32 v54, v54
  v_exp_f32 v55, v55
  v_cvt_pk_bf16_f32 v46, v52, v53
  v_cvt_pk_bf16_f32 v47, v54, v55
  s_nop 1
  v_mfma_f32_32x32x16_bf16 v[176:191], v[204:207], v[44:47], v[176:191]
  ds_read_b64_tr_b16 v[200:201], v92 offset:45056
  ds_read_b64_tr_b16 v[202:203], v92 offset:45440
  ds_read_b64_tr_b16 v[204:205], v92 offset:45824
  ds_read_b64_tr_b16 v[206:207], v92 offset:46208
  buffer_load_dwordx4 v[128:131], v2, s[32:35], s53 offen offset:1024 sc1
  buffer_load_dwordx4 v[132:135], v96, s[32:35], s53 offen offset:2048 sc1
  s_add_u32 s53, s53, 5120
  buffer_load_dwordx4 v[136:139], v2, s[32:35], s53 offen offset:0 sc1
  s_cmp_lt_u32 s48, 20
  s_cbranch_scc0 L_fp2_60
  s_cmp_lt_u32 s46, 7
  s_cbranch_scc0 L_fp2_60
  s_lshl_b32 s54, s45, 12
  s_lshl_b32 s52, s48, 7
  s_add_u32 s54, s54, s52
  s_lshl_b32 s52, s46, 2
  s_add_u32 s54, s54, s52
  s_add_u32 s54, s54, 819200
  s_waitcnt vmcnt(10)
  s_mov_b64 exec, 1
  buffer_store_dword v3, off, s[32:35], s54 sc1
  s_mov_b64 exec, -1
L_fp2_60:
  s_sub_u32 s51, s46, 6
  s_cmp_lt_u32 s51, 2
  s_cbranch_scc0 L_tch_61
  s_mov_b32 s36, s14
  s_mov_b32 s37, s15
  s_mov_b32 s38, 8388608
  s_mov_b32 s39, 0x20000
  s_lshl_b32 s52, s45, 2
  s_add_u32 s51, s51, s52
  s_add_u32 s51, s51, 0
  s_lshl_b32 s51, s51, 13
  s_lshl_b32 s52, s44, 18
  s_add_u32 s51, s51, s52
  v_lshlrev_b32 v224, 7, v1
  buffer_load_dword v95, v224, s[36:39], s51 offen
L_tch_61:
  ds_read_b128 v[24:27], v89 offset:11264
  ds_read_b64 v[28:29], v91 offset:11264
  s_waitcnt lgkmcnt(12)
  v_mfma_f32_32x32x16_bf16 v[72:87], v[32:35], v[8:11], v[160:175]
  s_cmp_gt_i32 s50, 3
  s_cbranch_scc1 L_inv_62
L_invb_63:
  v_exp_f32 v56, v56
  v_exp_f32 v57, v57
  v_exp_f32 v58, v58
  v_exp_f32 v59, v59
  v_cvt_pk_bf16_f32 v56, v56, v57
  v_mfma_f32_32x32x16_bf16 v[72:87], v[36:39], v[12:15], v[72:87]
  v_exp_f32 v60, v60
  v_exp_f32 v61, v61
  v_cvt_pk_bf16_f32 v57, v58, v59
  v_exp_f32 v62, v62
  v_exp_f32 v63, v63
  v_cvt_pk_bf16_f32 v58, v60, v61
  v_exp_f32 v64, v64
  v_exp_f32 v65, v65
  v_cvt_pk_bf16_f32 v59, v62, v63
  v_exp_f32 v66, v66
  v_exp_f32 v67, v67
  v_cvt_pk_bf16_f32 v60, v64, v65
  s_waitcnt lgkmcnt(8)
  v_mfma_f32_32x32x16_bf16 v[176:191], v[192:195], v[56:59], v[176:191]
  v_exp_f32 v68, v68
  v_exp_f32 v69, v69
  v_cvt_pk_bf16_f32 v61, v66, v67
  v_exp_f32 v70, v70
  v_exp_f32 v71, v71
  v_cvt_pk_bf16_f32 v62, v68, v69
  v_cvt_pk_bf16_f32 v63, v70, v71
  s_nop 1
  v_mfma_f32_32x32x16_bf16 v[176:191], v[196:199], v[60:63], v[176:191]
  ds_read_b64_tr_b16 v[192:193], v93 offset:0
  ds_read_b64_tr_b16 v[194:195], v93 offset:384
  ds_read_b64_tr_b16 v[196:197], v93 offset:768
  ds_read_b64_tr_b16 v[198:199], v93 offset:1152
  buffer_load_dwordx4 v[140:143], v2, s[32:35], s53 offen offset:1024 sc1
  buffer_load_dwordx4 v[144:147], v96, s[32:35], s53 offen offset:2048 sc1
  s_add_u32 s53, s53, 5120
  buffer_load_dwordx4 v[148:151], v2, s[32:35], s53 offen offset:0 sc1
  ds_read_b128 v[32:35], v89 offset:22528
  ds_read_b64 v[36:37], v91 offset:22528
  s_waitcnt lgkmcnt(12)
  v_mfma_f32_32x32x16_bf16 v[40:55], v[16:19], v[8:11], v[160:175]
  s_cmp_gt_i32 s50, 4
  s_cbranch_scc1 L_inv_64
L_invb_65:
  v_exp_f32 v72, v72
  v_exp_f32 v73, v73
  v_exp_f32 v74, v74
  v_exp_f32 v75, v75
  v_cvt_pk_bf16_f32 v72, v72, v73
  v_mfma_f32_32x32x16_bf16 v[40:55], v[20:23], v[12:15], v[40:55]
  v_exp_f32 v76, v76
  v_exp_f32 v77, v77
  v_cvt_pk_bf16_f32 v73, v74, v75
  v_exp_f32 v78, v78
  v_exp_f32 v79, v79
  v_cvt_pk_bf16_f32 v74, v76, v77
  v_exp_f32 v80, v80
  v_exp_f32 v81, v81
  v_cvt_pk_bf16_f32 v75, v78, v79
  v_exp_f32 v82, v82
  v_exp_f32 v83, v83
  v_cvt_pk_bf16_f32 v76, v80, v81
  s_waitcnt lgkmcnt(8)
  v_mfma_f32_32x32x16_bf16 v[176:191], v[200:203], v[72:75], v[176:191]
  v_exp_f32 v84, v84
  v_exp_f32 v85, v85
  v_cvt_pk_bf16_f32 v77, v82, v83
  v_exp_f32 v86, v86
  v_exp_f32 v87, v87
  v_cvt_pk_bf16_f32 v78, v84, v85
  v_cvt_pk_bf16_f32 v79, v86, v87
  s_nop 1
  v_mfma_f32_32x32x16_bf16 v[176:191], v[204:207], v[76:79], v[176:191]
  ds_read_b64_tr_b16 v[200:201], v93 offset:11264
  ds_read_b64_tr_b16 v[202:203], v93 offset:11648
  ds_read_b64_tr_b16 v[204:205], v93 offset:12032
  ds_read_b64_tr_b16 v[206:207], v93 offset:12416
  buffer_load_dwordx4 v[152:155], v2, s[32:35], s53 offen offset:1024 sc1
  buffer_load_dwordx4 v[156:159], v96, s[32:35], s53 offen offset:2048 sc1
  s_sub_u32 s51, s46, 4
  s_cmp_lt_u32 s51, 2
  s_cbranch_scc0 L_tch_66
  s_mov_b32 s36, s14
  s_mov_b32 s37, s15
  s_mov_b32 s38, 8388608
  s_mov_b32 s39, 0x20000
  s_lshl_b32 s52, s45, 2
  s_add_u32 s51, s51, s52
  s_add_u32 s51, s51, 2
  s_lshl_b32 s51, s51, 13
  s_lshl_b32 s52, s44, 18
  s_add_u32 s51, s51, s52
  v_lshlrev_b32 v224, 7, v1
  buffer_load_dword v95, v224, s[36:39], s51 offen
L_tch_66:
  s_waitcnt lgkmcnt(10)
  v_mfma_f32_32x32x16_bf16 v[56:71], v[24:27], v[8:11], v[160:175]
  s_cmp_gt_i32 s50, 5
  s_cbranch_scc1 L_inv_67
L_invb_68:
  v_exp_f32 v40, v40
  v_exp_f32 v41, v41
  v_exp_f32 v42, v42
  v_exp_f32 v43, v43
  v_cvt_pk_bf16_f32 v40, v40, v41
  v_mfma_f32_32x32x16_bf16 v[56:71], v[28:31], v[12:15], v[56:71]
  v_exp_f32 v44, v44
  v_exp_f32 v45, v45
  v_cvt_pk_bf16_f32 v41, v42, v43
  v_exp_f32 v46, v46
  v_exp_f32 v47, v47
  v_cvt_pk_bf16_f32 v42, v44, v45
  v_exp_f32 v48, v48
  v_exp_f32 v49, v49
  v_cvt_pk_bf16_f32 v43, v46, v47
  v_exp_f32 v50, v50
  v_exp_f32 v51, v51
  v_cvt_pk_bf16_f32 v44, v48, v49
  s_waitcnt lgkmcnt(6)
  v_mfma_f32_32x32x16_bf16 v[176:191], v[192:195], v[40:43], v[176:191]
  v_exp_f32 v52, v52
  v_exp_f32 v53, v53
  v_cvt_pk_bf16_f32 v45, v50, v51
  v_exp_f32 v54, v54
  v_exp_f32 v55, v55
  v_cvt_pk_bf16_f32 v46, v52, v53
  v_cvt_pk_bf16_f32 v47, v54, v55
  s_nop 1
  v_mfma_f32_32x32x16_bf16 v[176:191], v[196:199], v[44:47], v[176:191]
  ds_read_b64_tr_b16 v[192:193], v93 offset:22528
  ds_read_b64_tr_b16 v[194:195], v93 offset:22912
  ds_read_b64_tr_b16 v[196:197], v93 offset:23296
  ds_read_b64_tr_b16 v[198:199], v93 offset:23680
  s_waitcnt lgkmcnt(8)
  v_mfma_f32_32x32x16_bf16 v[72:87], v[32:35], v[8:11], v[160:175]
  s_cmp_gt_i32 s50, 6
  s_cbranch_scc1 L_inv_69
L_invb_70:
  v_exp_f32 v56, v56
  v_exp_f32 v57, v57
  v_exp_f32 v58, v58
  v_exp_f32 v59, v59
  v_cvt_pk_bf16_f32 v56, v56, v57
  v_mfma_f32_32x32x16_bf16 v[72:87], v[36:39], v[12:15], v[72:87]
  v_exp_f32 v60, v60
  v_exp_f32 v61, v61
  v_cvt_pk_bf16_f32 v57, v58, v59
  v_exp_f32 v62, v62
  v_exp_f32 v63, v63
  v_cvt_pk_bf16_f32 v58, v60, v61
  v_exp_f32 v64, v64
  v_exp_f32 v65, v65
  v_cvt_pk_bf16_f32 v59, v62, v63
  v_exp_f32 v66, v66
  v_exp_f32 v67, v67
  v_cvt_pk_bf16_f32 v60, v64, v65
  s_waitcnt lgkmcnt(4)
  v_mfma_f32_32x32x16_bf16 v[176:191], v[200:203], v[56:59], v[176:191]
  v_exp_f32 v68, v68
  v_exp_f32 v69, v69
  v_cvt_pk_bf16_f32 v61, v66, v67
  v_exp_f32 v70, v70
  v_exp_f32 v71, v71
  v_cvt_pk_bf16_f32 v62, v68, v69
  v_cvt_pk_bf16_f32 v63, v70, v71
  s_nop 1
  v_mfma_f32_32x32x16_bf16 v[176:191], v[204:207], v[60:63], v[176:191]
  s_cmp_gt_i32 s50, 7
  s_cbranch_scc1 L_inv_71
L_invb_72:
  v_exp_f32 v72, v72
  v_exp_f32 v73, v73
  v_exp_f32 v74, v74
  v_exp_f32 v75, v75
  v_cvt_pk_bf16_f32 v72, v72, v73
  v_exp_f32 v76, v76
  v_exp_f32 v77, v77
  v_cvt_pk_bf16_f32 v73, v74, v75
  v_exp_f32 v78, v78
  v_exp_f32 v79, v79
  v_cvt_pk_bf16_f32 v74, v76, v77
  v_exp_f32 v80, v80
  v_exp_f32 v81, v81
  v_cvt_pk_bf16_f32 v75, v78, v79
  v_exp_f32 v82, v82
  v_exp_f32 v83, v83
  v_cvt_pk_bf16_f32 v76, v80, v81
  s_waitcnt lgkmcnt(0)
  v_mfma_f32_32x32x16_bf16 v[176:191], v[192:195], v[72:75], v[176:191]
  v_exp_f32 v84, v84
  v_exp_f32 v85, v85
  v_cvt_pk_bf16_f32 v77, v82, v83
  v_exp_f32 v86, v86
  v_exp_f32 v87, v87
  v_cvt_pk_bf16_f32 v78, v84, v85
  v_cvt_pk_bf16_f32 v79, v86, v87
  s_nop 1
  v_mfma_f32_32x32x16_bf16 v[176:191], v[196:199], v[76:79], v[176:191]
  s_setprio 0
  s_nop 10
  v_mov_b32 v224, v184
  v_mov_b32 v225, v184
  s_nop 1
  v_permlane32_swap_b32 v224, v225
  v_rcp_f32 v225, v225
  v_lshrrev_b32 v226, 5, v1
  s_mul_i32 s51, s96, 5
  v_add_u32 v226, s51, v226
  v_and_b32 v227, 31, v1
  s_lshl_b32 s52, s97, 5
  v_add_u32 v227, s52, v227
  v_lshlrev_b32 v227, 4, v227
  v_add_u32 v227, 112640, v227
  v_mul_f32 v176, v176, v225
  v_mul_f32 v177, v177, v225
  v_mul_f32 v178, v178, v225
  v_mul_f32 v179, v179, v225
  v_mul_f32 v180, v180, v225
  v_mul_f32 v181, v181, v225
  v_mul_f32 v182, v182, v225
  v_mul_f32 v183, v183, v225
  v_mul_f32 v184, v184, v225
  v_mul_f32 v185, v185, v225
  v_mul_f32 v186, v186, v225
  v_mul_f32 v187, v187, v225
  v_lshrrev_b32 v228, 1, v226
  v_and_b32 v229, 1, v226
  v_lshlrev_b32 v229, 3, v229
  v_lshl_add_u32 v228, v228, 10, v229
  v_add_u32 v228, v228, v227
  v_cvt_pk_bf16_f32 v176, v176, v177
  v_cvt_pk_bf16_f32 v177, v178, v179
  v_cvt_pk_bf16_f32 v178, v180, v181
  v_cvt_pk_bf16_f32 v179, v182, v183
  v_cvt_pk_bf16_f32 v180, v184, v185
  v_cvt_pk_bf16_f32 v181, v186, v187
  ds_write_b64 v228, v[176:177]
  ds_write_b64 v228, v[178:179] offset:1024
  s_mov_b32 exec_hi, 0
  ds_write_b64 v228, v[180:181] offset:2048
  s_mov_b32 exec_hi, -1
  s_mul_i32 s51, s44, 81920
  s_mul_i32 s52, s45, 10240
  s_add_u32 s51, s51, s52
  s_add_u32 s51, s51, 14155776
  s_lshl_b32 s54, s44, 10
  s_lshl_b32 s52, s45, 7
  s_add_u32 s54, s54, s52
  s_add_u32 s54, s54, 917504
  s_add_u32 s52, s96, 0
  s_min_u32 s52, s52, 9
  s_lshl_b32 s52, s52, 10
  v_add_u32 v16, s52, v2
  v_add_u32 v20, 112640, v16
  s_add_u32 s52, s96, 4
  s_min_u32 s52, s52, 9
  s_lshl_b32 s52, s52, 10
  v_add_u32 v17, s52, v2
  v_add_u32 v21, 112640, v17
  s_add_u32 s52, s96, 8
  s_min_u32 s52, s52, 9
  s_lshl_b32 s52, s52, 10
  v_add_u32 v18, s52, v2
  v_add_u32 v22, 112640, v18
  s_waitcnt lgkmcnt(0)
  s_barrier
  s_cmp_lt_u32 s46, 4
  s_cbranch_scc0 L_w_73
  ds_read_b128 v[24:27], v20
  ds_read_b128 v[28:31], v21
  ds_read_b128 v[32:35], v22
  s_waitcnt lgkmcnt(2)
  buffer_store_dwordx4 v[24:27], v16, s[32:35], s51 offen sc1
  s_waitcnt lgkmcnt(1)
  buffer_store_dwordx4 v[28:31], v17, s[32:35], s51 offen sc1
  s_cmp_lt_u32 s46, 2
  s_cbranch_scc0 L_w_74
  s_waitcnt lgkmcnt(0)
  buffer_store_dwordx4 v[32:35], v18, s[32:35], s51 offen sc1
L_w_74:
  s_waitcnt vmcnt(0) lgkmcnt(0)
L_w_73:
  s_barrier
  s_cmp_eq_u32 s46, 0
  s_cbranch_scc0 L_w_75
  s_mov_b64 exec, 1
  buffer_store_dword v3, off, s[32:35], s54 sc1
  s_mov_b64 exec, -1
L_w_75:
  s_cmp_eq_u32 s46, 7
  s_cbranch_scc0 L_w_76
  v_mov_b32 v16, 0
  v_mov_b32 v17, 97280
  ds_write_b32 v17, v16
L_w_76:
  v_and_b32 v4, 15, v1
  v_lshlrev_b32 v4, 4, v4
  v_lshrrev_b32 v5, 4, v1
  v_lshl_add_u32 v4, v5, 10, v4
  s_mul_i32 s51, s96, 20480
  s_add_u32 s52, s96, 0
  s_and_b32 s52, s52, 3
  s_lshl_b32 s52, s52, 8
  s_add_u32 s52, s52, s51
  s_add_u32 s52, s52, 0
  v_add_u32 v96, s52, v4
  s_add_u32 s52, s96, 1
  s_and_b32 s52, s52, 3
  s_lshl_b32 s52, s52, 8
  s_add_u32 s52, s52, s51
  s_add_u32 s52, s52, 0
  v_add_u32 v97, s52, v4
  s_add_u32 s52, s96, 2
  s_and_b32 s52, s52, 3
  s_lshl_b32 s52, s52, 8
  s_add_u32 s52, s52, s51
  s_add_u32 s52, s52, 0
  v_add_u32 v98, s52, v4
  s_add_u32 s52, s96, 3
  s_and_b32 s52, s52, 3
  s_lshl_b32 s52, s52, 8
  s_add_u32 s52, s52, s51
  s_add_u32 s52, s52, 0
  v_add_u32 v99, s52, v4
  s_mul_i32 s52, s97, 3072
  s_add_u32 s51, s96, 0
  s_and_b32 s51, s51, 3
  s_mul_i32 s51, s51, 15360
  s_add_u32 s51, s51, s52
  s_add_u32 s51, s51, 98304
  v_add_u32 v4, s51, v2
  s_add_u32 s51, s96, 1
  s_and_b32 s51, s51, 3
  s_mul_i32 s51, s51, 15360
  s_add_u32 s51, s51, s52
  s_add_u32 s51, s51, 98304
  v_add_u32 v5, s51, v2
  s_add_u32 s51, s96, 2
  s_and_b32 s51, s51, 3
  s_mul_i32 s51, s51, 15360
  s_add_u32 s51, s51, s52
  s_add_u32 s51, s51, 103424
  v_add_u32 v6, s51, v2
  s_add_u32 s51, s96, 3
  s_and_b32 s51, s51, 3
  s_mul_i32 s51, s51, 15360
  s_add_u32 s51, s51, s52
  s_add_u32 s51, s51, 108544
  v_add_u32 v7, s51, v2
  s_cmp_ge_u32 s46, 4
  s_cbranch_scc1 L_tb4_78
  s_cmp_eq_u32 s46, 3
  s_cbranch_scc1 L_tb3_77
  v_min_u32 v41, 159, v0
  v_lshlrev_b32 v40, 5, v41
  s_mov_b32 s54, 68096
  s_mov_b32 s55, 78336
  buffer_load_dwordx4 v[48:51], v40, s[32:35], s54 offen offset:0 sc1
  buffer_load_dwordx4 v[52:55], v40, s[32:35], s54 offen offset:16 sc1
  buffer_load_dwordx4 v[56:59], v40, s[32:35], s55 offen offset:0 sc1
  buffer_load_dwordx4 v[60:63], v40, s[32:35], s55 offen offset:16 sc1
  s_lshl_b32 s51, s44, 10
  s_lshl_b32 s52, s46, 7
  s_add_u32 s51, s51, s52
  s_add_u32 s51, s51, 917504
  v_mov_b32 v8, s51
  s_mov_b32 s61, 0
L_poll_83:
  buffer_load_dword v9, v8, s[32:35], 0 offen sc1
L_pchk_85:
  s_waitcnt vmcnt(0)
  v_cmp_ne_u32 vcc, s47, v9
  s_nop 1
  s_cmp_eq_u64 vcc, 0
  s_cbranch_scc1 L_pdone_84
  s_add_u32 s61, s61, 1
  s_cmp_lt_u32 s61, 40000
  s_cbranch_scc1 L_poll_83
L_pdone_84:
  s_mul_i32 s53, s46, 10240
  s_mul_i32 s52, s44, 81920
  s_add_u32 s52, s52, s53
  s_add_u32 s52, s52, 14155776
  s_mov_b32 m0, s53
  s_nop 0
  buffer_load_dwordx4 v2, s[32:35], s52 offen sc1 lds
  buffer_load_dwordx4 v2, s[32:35], s52 offen offset:1024 sc1 lds
  buffer_load_dwordx4 v2, s[32:35], s52 offen offset:2048 sc1 lds
  buffer_load_dwordx4 v2, s[32:35], s52 offen offset:3072 sc1 lds
  s_add_u32 s52, s52, 4096
  s_add_u32 s53, s53, 4096
  s_mov_b32 m0, s53
  s_nop 0
  buffer_load_dwordx4 v2, s[32:35], s52 offen sc1 lds
  buffer_load_dwordx4 v2, s[32:35], s52 offen offset:1024 sc1 lds
  buffer_load_dwordx4 v2, s[32:35], s52 offen offset:2048 sc1 lds
  buffer_load_dwordx4 v2, s[32:35], s52 offen offset:3072 sc1 lds
  s_add_u32 s52, s52, 4096
  s_add_u32 s53, s53, 4096
  s_mov_b32 m0, s53
  s_nop 0
  buffer_load_dwordx4 v2, s[32:35], s52 offen sc1 lds
  buffer_load_dwordx4 v2, s[32:35], s52 offen offset:1024 sc1 lds
  s_mov_b32 s61, 0
  s_mov_b32 s60, 0x0c0c0400
  s_branch L_tc_82
L_tl_80:
  buffer_load_dwordx4 v[48:51], v40, s[32:35], s54 offen offset:0 sc1
  buffer_load_dwordx4 v[52:55], v40, s[32:35], s54 offen offset:16 sc1
  buffer_load_dwordx4 v[56:59], v40, s[32:35], s55 offen offset:0 sc1
  buffer_load_dwordx4 v[60:63], v40, s[32:35], s55 offen offset:16 sc1
  s_waitcnt vmcnt(0)
L_tc_82:
  v_perm_b32 v42, v49, v48, s60
  v_perm_b32 v43, v51, v50, s60
  v_lshl_or_b32 v42, v43, 16, v42
  v_cmp_ne_u32 vcc, s47, v42
  v_perm_b32 v42, v53, v52, s60
  v_perm_b32 v43, v55, v54, s60
  v_lshl_or_b32 v42, v43, 16, v42
  v_cmp_ne_u32 s[58:59], s47, v42
  s_nop 1
  s_or_b64 vcc, vcc, s[58:59]
  v_perm_b32 v42, v57, v56, s60
  v_perm_b32 v43, v59, v58, s60
  v_lshl_or_b32 v42, v43, 16, v42
  v_cmp_ne_u32 s[58:59], s47, v42
  s_nop 1
  s_or_b64 vcc, vcc, s[58:59]
  v_perm_b32 v42, v61, v60, s60
  v_perm_b32 v43, v63, v62, s60
  v_lshl_or_b32 v42, v43, 16, v42
  v_cmp_ne_u32 s[58:59], s47, v42
  s_nop 1
  s_or_b64 vcc, vcc, s[58:59]
  s_cmp_eq_u64 vcc, 0
  s_cbranch_scc1 L_td_81
  s_add_u32 s61, s61, 1
  s_cmp_lt_u32 s61, 40000
  s_cbranch_scc1 L_tl_80
L_td_81:
  v_and_b32 v48, 0xffffff00, v48
  v_and_b32 v49, 0xffffff00, v49
  v_and_b32 v50, 0xffffff00, v50
  v_and_b32 v51, 0xffffff00, v51
  v_and_b32 v52, 0xffffff00, v52
  v_and_b32 v53, 0xffffff00, v53
  v_and_b32 v54, 0xffffff00, v54
  v_and_b32 v55, 0xffffff00, v55
  v_and_b32 v56, 0xffffff00, v56
  v_and_b32 v57, 0xffffff00, v57
  v_and_b32 v58, 0xffffff00, v58
  v_and_b32 v59, 0xffffff00, v59
  v_and_b32 v60, 0xffffff00, v60
  v_and_b32 v61, 0xffffff00, v61
  v_and_b32 v62, 0xffffff00, v62
  v_and_b32 v63, 0xffffff00, v63
  v_add_f32 v48, v48, v56
  v_add_f32 v49, v49, v57
  v_add_f32 v50, v50, v58
  v_add_f32 v51, v51, v59
  v_add_f32 v52, v52, v60
  v_add_f32 v53, v53, v61
  v_add_f32 v54, v54, v62
  v_add_f32 v55, v55, v63
  s_movk_i32 s60, 80
  v_cmp_le_u32 s[58:59], s60, v41
  v_mov_b32 v42, 0
  v_mov_b32 v43, 1.0
  v_cndmask_b32 v42, v42, v43, s[58:59]
  v_lshlrev_b32 v41, 4, v41
  v_add_u32 v40, 83200, v41
  v_add_u32 v41, 80640, v41
  v_cndmask_b32 v40, v40, v41, s[58:59]
  v_cvt_pk_bf16_f32 v43, v48, v49
  v_lshlrev_b32 v48, 16, v43
  v_and_b32 v49, 0xffff0000, v43
  v_add_f32 v48, v48, v42
  v_add_f32 v49, v49, v42
  v_cvt_pk_bf16_f32 v44, v48, v49
  v_cvt_pk_bf16_f32 v43, v50, v51
  v_lshlrev_b32 v50, 16, v43
  v_and_b32 v51, 0xffff0000, v43
  v_add_f32 v50, v50, v42
  v_add_f32 v51, v51, v42
  v_cvt_pk_bf16_f32 v45, v50, v51
  v_cvt_pk_bf16_f32 v43, v52, v53
  v_lshlrev_b32 v52, 16, v43
  v_and_b32 v53, 0xffff0000, v43
  v_add_f32 v52, v52, v42
  v_add_f32 v53, v53, v42
  v_cvt_pk_bf16_f32 v46, v52, v53
  v_cvt_pk_bf16_f32 v43, v54, v55
  v_lshlrev_b32 v54, 16, v43
  v_and_b32 v55, 0xffff0000, v43
  v_add_f32 v54, v54, v42
  v_add_f32 v55, v55, v42
  v_cvt_pk_bf16_f32 v47, v54, v55
  s_branch L_tbd_79
L_tb3_77:
  v_min_u32 v40, 19, v1
  v_lshlrev_b32 v40, 4, v40
  s_mul_i32 s54, s45, 320
  s_add_u32 s54, s54, 65536
  s_add_u32 s55, s54, 10240
  buffer_load_dwordx4 v[44:47], v40, s[32:35], s54 offen sc1
  buffer_load_dwordx4 v[48:51], v40, s[32:35], s55 offen sc1
  s_lshl_b32 s51, s44, 10
  s_lshl_b32 s52, s46, 7
  s_add_u32 s51, s51, s52
  s_add_u32 s51, s51, 917504
  v_mov_b32 v8, s51
  s_mov_b32 s61, 0
L_poll_89:
  buffer_load_dword v9, v8, s[32:35], 0 offen sc1
L_pchk_91:
  s_waitcnt vmcnt(0)
  v_cmp_ne_u32 vcc, s47, v9
  s_nop 1
  s_cmp_eq_u64 vcc, 0
  s_cbranch_scc1 L_pdone_90
  s_add_u32 s61, s61, 1
  s_cmp_lt_u32 s61, 40000
  s_cbranch_scc1 L_poll_89
L_pdone_90:
  s_mul_i32 s53, s46, 10240
  s_mul_i32 s52, s44, 81920
  s_add_u32 s52, s52, s53
  s_add_u32 s52, s52, 14155776
  s_mov_b32 m0, s53
  s_nop 0
  buffer_load_dwordx4 v2, s[32:35], s52 offen sc1 lds
  buffer_load_dwordx4 v2, s[32:35], s52 offen offset:1024 sc1 lds
  buffer_load_dwordx4 v2, s[32:35], s52 offen offset:2048 sc1 lds
  buffer_load_dwordx4 v2, s[32:35], s52 offen offset:3072 sc1 lds
  s_add_u32 s52, s52, 4096
  s_add_u32 s53, s53, 4096
  s_mov_b32 m0, s53
  s_nop 0
  buffer_load_dwordx4 v2, s[32:35], s52 offen sc1 lds
  buffer_load_dwordx4 v2, s[32:35], s52 offen offset:1024 sc1 lds
  buffer_load_dwordx4 v2, s[32:35], s52 offen offset:2048 sc1 lds
  buffer_load_dwordx4 v2, s[32:35], s52 offen offset:3072 sc1 lds
  s_add_u32 s52, s52, 4096
  s_add_u32 s53, s53, 4096
  s_mov_b32 m0, s53
  s_nop 0
  buffer_load_dwordx4 v2, s[32:35], s52 offen sc1 lds
  buffer_load_dwordx4 v2, s[32:35], s52 offen offset:1024 sc1 lds
  s_mov_b32 s61, 0
  s_mov_b32 s60, 0x0c0c0400
  s_branch L_tc_88
L_tl_86:
  buffer_load_dwordx4 v[44:47], v40, s[32:35], s54 offen sc1
  buffer_load_dwordx4 v[48:51], v40, s[32:35], s55 offen sc1
  s_waitcnt vmcnt(0)
L_tc_88:
  v_perm_b32 v42, v45, v44, s60
  v_perm_b32 v43, v47, v46, s60
  v_lshl_or_b32 v42, v43, 16, v42
  v_cmp_ne_u32 vcc, s47, v42
  v_perm_b32 v42, v49, v48, s60
  v_perm_b32 v43, v51, v50, s60
  v_lshl_or_b32 v42, v43, 16, v42
  v_cmp_ne_u32 s[58:59], s47, v42
  s_nop 1
  s_or_b64 vcc, vcc, s[58:59]
  s_cmp_eq_u64 vcc, 0
  s_cbranch_scc1 L_td_87
  s_add_u32 s61, s61, 1
  s_cmp_lt_u32 s61, 40000
  s_cbranch_scc1 L_tl_86
L_td_87:
  v_and_b32 v44, 0xffffff00, v44
  v_and_b32 v45, 0xffffff00, v45
  v_and_b32 v46, 0xffffff00, v46
  v_and_b32 v47, 0xffffff00, v47
  v_and_b32 v48, 0xffffff00, v48
  v_and_b32 v49, 0xffffff00, v49
  v_and_b32 v50, 0xffffff00, v50
  v_and_b32 v51, 0xffffff00, v51
  v_add_f32 v44, v44, v48
  v_add_f32 v45, v45, v49
  v_add_f32 v46, v46, v50
  v_add_f32 v47, v47, v51
  v_cvt_pk_bf16_f32 v48, v44, v45
  v_cvt_pk_bf16_f32 v49, v46, v47
  v_lshlrev_b32 v44, 16, v48
  v_and_b32 v45, 0xffff0000, v48
  v_lshlrev_b32 v46, 16, v49
  v_and_b32 v47, 0xffff0000, v49
  v_add_u32 v40, 84480, v40
L_tbd_79:
  ds_write_b128 v40, v[44:47]
  s_branch L_tbz_92
L_tb4_78:
  s_lshl_b32 s51, s44, 10
  s_lshl_b32 s52, s46, 7
  s_add_u32 s51, s51, s52
  s_add_u32 s51, s51, 917504
  v_mov_b32 v8, s51
  s_cmp_eq_u32 s46, 7
  s_cbranch_scc0 L_w_93
  s_lshl_b32 s51, s45, 12
  s_add_u32 s51, s51, 819200
  v_add_u32 v20, 0, v1
  v_min_u32 v20, 139, v20
  v_mul_u32_u24 v21, 147, v20
  v_lshrrev_b32 v21, 10, v21
  v_mul_u32_u24 v21, 100, v21
  v_lshl_add_u32 v21, v20, 2, v21
  v_add_u32 v16, s51, v21
  v_add_u32 v20, 64, v1
  v_min_u32 v20, 139, v20
  v_mul_u32_u24 v21, 147, v20
  v_lshrrev_b32 v21, 10, v21
  v_mul_u32_u24 v21, 100, v21
  v_lshl_add_u32 v21, v20, 2, v21
  v_add_u32 v17, s51, v21
  v_add_u32 v20, 128, v1
  v_min_u32 v20, 139, v20
  v_mul_u32_u24 v21, 147, v20
  v_lshrrev_b32 v21, 10, v21
  v_mul_u32_u24 v21, 100, v21
  v_lshl_add_u32 v21, v20, 2, v21
  v_add_u32 v18, s51, v21
  s_mov_b32 s61, 0
L_poll_95:
  buffer_load_dword v9, v8, s[32:35], 0 offen sc1
  buffer_load_dword v20, v16, s[32:35], 0 offen sc1
  buffer_load_dword v21, v17, s[32:35], 0 offen sc1
  buffer_load_dword v22, v18, s[32:35], 0 offen sc1
L_pchk_97:
  s_waitcnt vmcnt(0)
  v_cmp_ne_u32 vcc, s47, v9
  v_cmp_ne_u32 s[58:59], s47, v20
  s_nop 1
  s_or_b64 vcc, vcc, s[58:59]
  v_cmp_ne_u32 s[58:59], s47, v21
  s_nop 1
  s_or_b64 vcc, vcc, s[58:59]
  v_cmp_ne_u32 s[58:59], s47, v22
  s_nop 1
  s_or_b64 vcc, vcc, s[58:59]
  s_cmp_eq_u64 vcc, 0
  s_cbranch_scc1 L_pdone_96
  s_add_u32 s61, s61, 1
  s_cmp_lt_u32 s61, 40000
  s_cbranch_scc1 L_poll_95
L_pdone_96:
  s_branch L_s2o_94
L_w_93:
  s_mov_b32 s61, 0
L_poll_98:
  buffer_load_dword v9, v8, s[32:35], 0 offen sc1
L_pchk_100:
  s_waitcnt vmcnt(0)
  v_cmp_ne_u32 vcc, s47, v9
  s_nop 1
  s_cmp_eq_u64 vcc, 0
  s_cbranch_scc1 L_pdone_99
  s_add_u32 s61, s61, 1
  s_cmp_lt_u32 s61, 40000
  s_cbranch_scc1 L_poll_98
L_pdone_99:
L_s2o_94:
  s_mul_i32 s53, s46, 10240
  s_mul_i32 s52, s44, 81920
  s_add_u32 s52, s52, s53
  s_add_u32 s52, s52, 14155776
  s_mov_b32 m0, s53
  s_nop 0
  buffer_load_dwordx4 v2, s[32:35], s52 offen sc1 lds
  buffer_load_dwordx4 v2, s[32:35], s52 offen offset:1024 sc1 lds
  buffer_load_dwordx4 v2, s[32:35], s52 offen offset:2048 sc1 lds
  buffer_load_dwordx4 v2, s[32:35], s52 offen offset:3072 sc1 lds
  s_add_u32 s52, s52, 4096
  s_add_u32 s53, s53, 4096
  s_mov_b32 m0, s53
  s_nop 0
  buffer_load_dwordx4 v2, s[32:35], s52 offen sc1 lds
  buffer_load_dwordx4 v2, s[32:35], s52 offen offset:1024 sc1 lds
  buffer_load_dwordx4 v2, s[32:35], s52 offen offset:2048 sc1 lds
  buffer_load_dwordx4 v2, s[32:35], s52 offen offset:3072 sc1 lds
  s_add_u32 s52, s52, 4096
  s_add_u32 s53, s53, 4096
  s_mov_b32 m0, s53
  s_nop 0
  buffer_load_dwordx4 v2, s[32:35], s52 offen sc1 lds
  buffer_load_dwordx4 v2, s[32:35], s52 offen offset:1024 sc1 lds
L_tbz_92:
  s_cmp_ge_u32 s45, 6
  s_cselect_b32 s55, 6, 7
  s_cmp_lt_u32 s46, s55
  s_cselect_b32 s51, 0, 0x40000000
  s_lshl_b32 s52, s46, 10
  s_add_u32 s51, s51, s52
  v_add_u32 v8, s51, v2
  s_mul_i32 s56, s45, 286720
  s_add_u32 s56, s56, 4718592
  s_mov_b32 s57, s56
  s_waitcnt vmcnt(0) lgkmcnt(0)
  s_barrier
  ds_read_b128 v[16:19], v97 offset:0
  ds_read_b128 v[20:23], v97 offset:4096
  ds_read_b128 v[24:27], v97 offset:8192
  ds_read_b128 v[28:31], v97 offset:12288
  s_cmp_eq_u32 s97, 0
  s_cbranch_scc0 L_g2_101
  s_waitcnt lgkmcnt(3)
  v_mfma_f32_16x16x32_bf16 v[60:63], v[100:103], v[16:19], 0
  ds_read_b128 v[32:35], v97 offset:16384
  v_mfma_f32_16x16x32_bf16 v[64:67], v[104:107], v[16:19], 0
  v_mfma_f32_16x16x32_bf16 v[68:71], v[108:111], v[16:19], 0
  buffer_load_dwordx4 v[160:163], v8, s[32:35], s57 offen sc1
  s_waitcnt lgkmcnt(3)
  v_mfma_f32_16x16x32_bf16 v[60:63], v[112:115], v[20:23], v[60:63]
  ds_read_b128 v[36:39], v98 offset:0
  v_mfma_f32_16x16x32_bf16 v[64:67], v[116:119], v[20:23], v[64:67]
  v_mfma_f32_16x16x32_bf16 v[68:71], v[120:123], v[20:23], v[68:71]
  s_add_u32 s57, s57, 14336
  buffer_load_dwordx4 v[164:167], v8, s[32:35], s57 offen sc1
  s_waitcnt lgkmcnt(3)
  v_mfma_f32_16x16x32_bf16 v[60:63], v[124:127], v[24:27], v[60:63]
  ds_read_b128 v[40:43], v98 offset:4096
  v_mfma_f32_16x16x32_bf16 v[64:67], v[128:131], v[24:27], v[64:67]
  v_mfma_f32_16x16x32_bf16 v[68:71], v[132:135], v[24:27], v[68:71]
  s_add_u32 s57, s57, 14336
  buffer_load_dwordx4 v[168:171], v8, s[32:35], s57 offen sc1
  s_waitcnt lgkmcnt(3)
  v_mfma_f32_16x16x32_bf16 v[60:63], v[136:139], v[28:31], v[60:63]
  ds_read_b128 v[44:47], v98 offset:8192
  v_mfma_f32_16x16x32_bf16 v[64:67], v[140:143], v[28:31], v[64:67]
  v_mfma_f32_16x16x32_bf16 v[68:71], v[144:147], v[28:31], v[68:71]
  s_add_u32 s57, s57, 14336
  buffer_load_dwordx4 v[172:175], v8, s[32:35], s57 offen sc1
  s_waitcnt lgkmcnt(3)
  v_mfma_f32_16x16x32_bf16 v[60:63], v[148:151], v[32:35], v[60:63]
  ds_read_b128 v[16:19], v98 offset:12288
  v_mfma_f32_16x16x32_bf16 v[64:67], v[152:155], v[32:35], v[64:67]
  v_mfma_f32_16x16x32_bf16 v[68:71], v[156:159], v[32:35], v[68:71]
  s_add_u32 s57, s57, 14336
  buffer_load_dwordx4 v[176:179], v8, s[32:35], s57 offen sc1
  s_waitcnt lgkmcnt(3)
  v_mfma_f32_16x16x32_bf16 v[72:75], v[100:103], v[36:39], 0
  ds_read_b128 v[20:23], v98 offset:16384
  v_mfma_f32_16x16x32_bf16 v[76:79], v[104:107], v[36:39], 0
  v_mfma_f32_16x16x32_bf16 v[80:83], v[108:111], v[36:39], 0
  s_add_u32 s57, s57, 14336
  buffer_load_dwordx4 v[180:183], v8, s[32:35], s57 offen sc1
  s_waitcnt lgkmcnt(3)
  v_mfma_f32_16x16x32_bf16 v[72:75], v[112:115], v[40:43], v[72:75]
  ds_read_b128 v[24:27], v99 offset:0
  v_mfma_f32_16x16x32_bf16 v[76:79], v[116:119], v[40:43], v[76:79]
  ds_write_b128 v5, v[60:63] offset:0
  v_mfma_f32_16x16x32_bf16 v[80:83], v[120:123], v[40:43], v[80:83]
  s_add_u32 s57, s57, 14336
  buffer_load_dwordx4 v[184:187], v8, s[32:35], s57 offen sc1
  s_waitcnt lgkmcnt(4)
  v_mfma_f32_16x16x32_bf16 v[72:75], v[124:127], v[44:47], v[72:75]
  ds_read_b128 v[28:31], v99 offset:4096
  v_mfma_f32_16x16x32_bf16 v[76:79], v[128:131], v[44:47], v[76:79]
  ds_write_b128 v5, v[64:67] offset:1024
  v_mfma_f32_16x16x32_bf16 v[80:83], v[132:135], v[44:47], v[80:83]
  s_add_u32 s57, s57, 14336
  buffer_load_dwordx4 v[188:191], v8, s[32:35], s57 offen sc1
  s_waitcnt lgkmcnt(5)
  v_mfma_f32_16x16x32_bf16 v[72:75], v[136:139], v[16:19], v[72:75]
  ds_read_b128 v[32:35], v99 offset:8192
  v_mfma_f32_16x16x32_bf16 v[76:79], v[140:143], v[16:19], v[76:79]
  ds_write_b128 v5, v[68:71] offset:2048
  v_mfma_f32_16x16x32_bf16 v[80:83], v[144:147], v[16:19], v[80:83]
  s_add_u32 s57, s57, 14336
  buffer_load_dwordx4 v[192:195], v8, s[32:35], s57 offen sc1
  s_waitcnt lgkmcnt(6)
  v_mfma_f32_16x16x32_bf16 v[72:75], v[148:151], v[20:23], v[72:75]
  ds_read_b128 v[36:39], v99 offset:12288
  v_mfma_f32_16x16x32_bf16 v[76:79], v[152:155], v[20:23], v[76:79]
  v_mfma_f32_16x16x32_bf16 v[80:83], v[156:159], v[20:23], v[80:83]
  s_add_u32 s57, s57, 14336
  buffer_load_dwordx4 v[196:199], v8, s[32:35], s57 offen sc1
  s_waitcnt lgkmcnt(6)
  v_mfma_f32_16x16x32_bf16 v[84:87], v[100:103], v[24:27], 0
  ds_read_b128 v[40:43], v99 offset:16384
  v_mfma_f32_16x16x32_bf16 v[88:91], v[104:107], v[24:27], 0
  v_mfma_f32_16x16x32_bf16 v[92:95], v[108:111], v[24:27], 0
  s_add_u32 s57, s57, 14336
  buffer_load_dwordx4 v[200:203], v8, s[32:35], s57 offen sc1
  s_waitcnt lgkmcnt(5)
  v_mfma_f32_16x16x32_bf16 v[84:87], v[112:115], v[28:31], v[84:87]
  ds_read_b128 v[44:47], v96 offset:0
  v_mfma_f32_16x16x32_bf16 v[88:91], v[116:119], v[28:31], v[88:91]
  ds_write_b128 v6, v[72:75] offset:0
  v_mfma_f32_16x16x32_bf16 v[92:95], v[120:123], v[28:31], v[92:95]
  s_add_u32 s57, s57, 14336
  buffer_load_dwordx4 v[204:207], v8, s[32:35], s57 offen sc1
  s_waitcnt lgkmcnt(5)
  v_mfma_f32_16x16x32_bf16 v[84:87], v[124:127], v[32:35], v[84:87]
  ds_read_b128 v[16:19], v96 offset:4096
  v_mfma_f32_16x16x32_bf16 v[88:91], v[128:131], v[32:35], v[88:91]
  ds_write_b128 v6, v[76:79] offset:1024
  v_mfma_f32_16x16x32_bf16 v[92:95], v[132:135], v[32:35], v[92:95]
  s_add_u32 s57, s57, 14336
  buffer_load_dwordx4 v[208:211], v8, s[32:35], s57 offen sc1
  s_waitcnt lgkmcnt(5)
  v_mfma_f32_16x16x32_bf16 v[84:87], v[136:139], v[36:39], v[84:87]
  ds_read_b128 v[20:23], v96 offset:8192
  v_mfma_f32_16x16x32_bf16 v[88:91], v[140:143], v[36:39], v[88:91]
  ds_write_b128 v6, v[80:83] offset:2048
  v_mfma_f32_16x16x32_bf16 v[92:95], v[144:147], v[36:39], v[92:95]
  s_add_u32 s57, s57, 14336
  buffer_load_dwordx4 v[212:215], v8, s[32:35], s57 offen sc1
  s_waitcnt lgkmcnt(6)
  v_mfma_f32_16x16x32_bf16 v[84:87], v[148:151], v[40:43], v[84:87]
  ds_read_b128 v[24:27], v96 offset:12288
  v_mfma_f32_16x16x32_bf16 v[88:91], v[152:155], v[40:43], v[88:91]
  v_mfma_f32_16x16x32_bf16 v[92:95], v[156:159], v[40:43], v[92:95]
  s_waitcnt lgkmcnt(6)
  v_mfma_f32_16x16x32_bf16 v[48:51], v[100:103], v[44:47], 0
  ds_read_b128 v[28:31], v96 offset:16384
  v_mfma_f32_16x16x32_bf16 v[52:55], v[104:107], v[44:47], 0
  v_mfma_f32_16x16x32_bf16 v[56:59], v[108:111], v[44:47], 0
  s_waitcnt lgkmcnt(5)
  v_mfma_f32_16x16x32_bf16 v[48:51], v[112:115], v[16:19], v[48:51]
  v_mfma_f32_16x16x32_bf16 v[52:55], v[116:119], v[16:19], v[52:55]
  ds_write_b128 v7, v[84:87] offset:0
  v_mfma_f32_16x16x32_bf16 v[56:59], v[120:123], v[16:19], v[56:59]
  s_waitcnt lgkmcnt(4)
  v_mfma_f32_16x16x32_bf16 v[48:51], v[124:127], v[20:23], v[48:51]
  v_mfma_f32_16x16x32_bf16 v[52:55], v[128:131], v[20:23], v[52:55]
  ds_write_b128 v7, v[88:91] offset:1024
  v_mfma_f32_16x16x32_bf16 v[56:59], v[132:135], v[20:23], v[56:59]
  s_waitcnt lgkmcnt(3)
  v_mfma_f32_16x16x32_bf16 v[48:51], v[136:139], v[24:27], v[48:51]
  v_mfma_f32_16x16x32_bf16 v[52:55], v[140:143], v[24:27], v[52:55]
  ds_write_b128 v7, v[92:95] offset:2048
  v_mfma_f32_16x16x32_bf16 v[56:59], v[144:147], v[24:27], v[56:59]
  s_waitcnt lgkmcnt(3)
  v_mfma_f32_16x16x32_bf16 v[48:51], v[148:151], v[28:31], v[48:51]
  v_mfma_f32_16x16x32_bf16 v[52:55], v[152:155], v[28:31], v[52:55]
  v_mfma_f32_16x16x32_bf16 v[56:59], v[156:159], v[28:31], v[56:59]
  s_branch L_ge_102
L_g2_101:
  s_waitcnt lgkmcnt(3)
  v_mfma_f32_16x16x32_bf16 v[60:63], v[100:103], v[16:19], 0
  ds_read_b128 v[32:35], v97 offset:16384
  v_mfma_f32_16x16x32_bf16 v[64:67], v[104:107], v[16:19], 0
  buffer_load_dwordx4 v[160:163], v8, s[32:35], s57 offen sc1
  s_waitcnt lgkmcnt(3)
  v_mfma_f32_16x16x32_bf16 v[60:63], v[112:115], v[20:23], v[60:63]
  ds_read_b128 v[36:39], v98 offset:0
  v_mfma_f32_16x16x32_bf16 v[64:67], v[116:119], v[20:23], v[64:67]
  s_add_u32 s57, s57, 14336
  buffer_load_dwordx4 v[164:167], v8, s[32:35], s57 offen sc1
  s_waitcnt lgkmcnt(3)
  v_mfma_f32_16x16x32_bf16 v[60:63], v[124:127], v[24:27], v[60:63]
  ds_read_b128 v[40:43], v98 offset:4096
  v_mfma_f32_16x16x32_bf16 v[64:67], v[128:131], v[24:27], v[64:67]
  s_add_u32 s57, s57, 14336
  buffer_load_dwordx4 v[168:171], v8, s[32:35], s57 offen sc1
  s_waitcnt lgkmcnt(3)
  v_mfma_f32_16x16x32_bf16 v[60:63], v[136:139], v[28:31], v[60:63]
  ds_read_b128 v[44:47], v98 offset:8192
  v_mfma_f32_16x16x32_bf16 v[64:67], v[140:143], v[28:31], v[64:67]
  s_add_u32 s57, s57, 14336
  buffer_load_dwordx4 v[172:175], v8, s[32:35], s57 offen sc1
  s_waitcnt lgkmcnt(3)
  v_mfma_f32_16x16x32_bf16 v[60:63], v[148:151], v[32:35], v[60:63]
  ds_read_b128 v[16:19], v98 offset:12288
  v_mfma_f32_16x16x32_bf16 v[64:67], v[152:155], v[32:35], v[64:67]
  s_add_u32 s57, s57, 14336
  buffer_load_dwordx4 v[176:179], v8, s[32:35], s57 offen sc1
  s_waitcnt lgkmcnt(3)
  v_mfma_f32_16x16x32_bf16 v[72:75], v[100:103], v[36:39], 0
  ds_read_b128 v[20:23], v98 offset:16384
  v_mfma_f32_16x16x32_bf16 v[76:79], v[104:107], v[36:39], 0
  s_add_u32 s57, s57, 14336
  buffer_load_dwordx4 v[180:183], v8, s[32:35], s57 offen sc1
  s_waitcnt lgkmcnt(3)
  v_mfma_f32_16x16x32_bf16 v[72:75], v[112:115], v[40:43], v[72:75]
  ds_read_b128 v[24:27], v99 offset:0
  v_mfma_f32_16x16x32_bf16 v[76:79], v[116:119], v[40:43], v[76:79]
  ds_write_b128 v5, v[60:63] offset:0
  s_add_u32 s57, s57, 14336
  buffer_load_dwordx4 v[184:187], v8, s[32:35], s57 offen sc1
  s_waitcnt lgkmcnt(4)
  v_mfma_f32_16x16x32_bf16 v[72:75], v[124:127], v[44:47], v[72:75]
  ds_read_b128 v[28:31], v99 offset:4096
  v_mfma_f32_16x16x32_bf16 v[76:79], v[128:131], v[44:47], v[76:79]
  ds_write_b128 v5, v[64:67] offset:1024
  s_add_u32 s57, s57, 14336
  buffer_load_dwordx4 v[188:191], v8, s[32:35], s57 offen sc1
  s_waitcnt lgkmcnt(5)
  v_mfma_f32_16x16x32_bf16 v[72:75], v[136:139], v[16:19], v[72:75]
  ds_read_b128 v[32:35], v99 offset:8192
  v_mfma_f32_16x16x32_bf16 v[76:79], v[140:143], v[16:19], v[76:79]
  s_add_u32 s57, s57, 14336
  buffer_load_dwordx4 v[192:195], v8, s[32:35], s57 offen sc1
  s_waitcnt lgkmcnt(5)
  v_mfma_f32_16x16x32_bf16 v[72:75], v[148:151], v[20:23], v[72:75]
  ds_read_b128 v[36:39], v99 offset:12288
  v_mfma_f32_16x16x32_bf16 v[76:79], v[152:155], v[20:23], v[76:79]
  s_add_u32 s57, s57, 14336
  buffer_load_dwordx4 v[196:199], v8, s[32:35], s57 offen sc1
  s_waitcnt lgkmcnt(5)
  v_mfma_f32_16x16x32_bf16 v[84:87], v[100:103], v[24:27], 0
  ds_read_b128 v[40:43], v99 offset:16384
  v_mfma_f32_16x16x32_bf16 v[88:91], v[104:107], v[24:27], 0
  s_add_u32 s57, s57, 14336
  buffer_load_dwordx4 v[200:203], v8, s[32:35], s57 offen sc1
  s_waitcnt lgkmcnt(4)
  v_mfma_f32_16x16x32_bf16 v[84:87], v[112:115], v[28:31], v[84:87]
  ds_read_b128 v[44:47], v96 offset:0
  v_mfma_f32_16x16x32_bf16 v[88:91], v[116:119], v[28:31], v[88:91]
  ds_write_b128 v6, v[72:75] offset:0
  s_add_u32 s57, s57, 14336
  buffer_load_dwordx4 v[204:207], v8, s[32:35], s57 offen sc1
  s_waitcnt lgkmcnt(4)
  v_mfma_f32_16x16x32_bf16 v[84:87], v[124:127], v[32:35], v[84:87]
  ds_read_b128 v[16:19], v96 offset:4096
  v_mfma_f32_16x16x32_bf16 v[88:91], v[128:131], v[32:35], v[88:91]
  ds_write_b128 v6, v[76:79] offset:1024
  s_add_u32 s57, s57, 14336
  buffer_load_dwordx4 v[208:211], v8, s[32:35], s57 offen sc1
  s_waitcnt lgkmcnt(5)
  v_mfma_f32_16x16x32_bf16 v[84:87], v[136:139], v[36:39], v[84:87]
  ds_read_b128 v[20:23], v96 offset:8192
  v_mfma_f32_16x16x32_bf16 v[88:91], v[140:143], v[36:39], v[88:91]
  s_add_u32 s57, s57, 14336
  buffer_load_dwordx4 v[212:215], v8, s[32:35], s57 offen sc1
  s_waitcnt lgkmcnt(5)
  v_mfma_f32_16x16x32_bf16 v[84:87], v[148:151], v[40:43], v[84:87]
  ds_read_b128 v[24:27], v96 offset:12288
  v_mfma_f32_16x16x32_bf16 v[88:91], v[152:155], v[40:43], v[88:91]
  s_waitcnt lgkmcnt(5)
  v_mfma_f32_16x16x32_bf16 v[48:51], v[100:103], v[44:47], 0
  ds_read_b128 v[28:31], v96 offset:16384
  v_mfma_f32_16x16x32_bf16 v[52:55], v[104:107], v[44:47], 0
  s_waitcnt lgkmcnt(4)
  v_mfma_f32_16x16x32_bf16 v[48:51], v[112:115], v[16:19], v[48:51]
  v_mfma_f32_16x16x32_bf16 v[52:55], v[116:119], v[16:19], v[52:55]
  ds_write_b128 v7, v[84:87] offset:0
  s_waitcnt lgkmcnt(3)
  v_mfma_f32_16x16x32_bf16 v[48:51], v[124:127], v[20:23], v[48:51]
  v_mfma_f32_16x16x32_bf16 v[52:55], v[128:131], v[20:23], v[52:55]
  ds_write_b128 v7, v[88:91] offset:1024
  s_waitcnt lgkmcnt(3)
  v_mfma_f32_16x16x32_bf16 v[48:51], v[136:139], v[24:27], v[48:51]
  v_mfma_f32_16x16x32_bf16 v[52:55], v[140:143], v[24:27], v[52:55]
  s_waitcnt lgkmcnt(2)
  v_mfma_f32_16x16x32_bf16 v[48:51], v[148:151], v[28:31], v[48:51]
  v_mfma_f32_16x16x32_bf16 v[52:55], v[152:155], v[28:31], v[52:55]
L_ge_102:
  v_lshrrev_b32 v16, 4, v1
  v_lshlrev_b32 v16, 4, v16
  s_mul_i32 s51, s97, 192
  s_add_u32 s51, s51, 84480
  v_add_u32 v16, s51, v16
  ds_read_b128 v[136:139], v16 offset:0
  ds_read_b128 v[140:143], v16 offset:64
  ds_read_b128 v[144:147], v16 offset:128
  v_lshrrev_b32 v17, 4, v1
  s_mul_i32 s51, s45, 160
  s_mul_i32 s52, s97, 96
  s_add_u32 s51, s51, s52
  s_add_u32 s51, s51, 81920
  v_lshlrev_b32 v18, 3, v17
  v_add_u32 v18, s51, v18
  ds_read_b64 v[40:41], v18 offset:0
  ds_read_b64 v[42:43], v18 offset:32
  ds_read_b64 v[44:45], v18 offset:64
  v_and_b32 v16, 15, v1
  v_and_b32 v18, 1, v17
  v_lshrrev_b32 v19, 1, v17
  v_lshl_add_u32 v20, v18, 1, v19
  v_lshlrev_b32 v20, 10, v20
  v_lshl_add_u32 v28, v16, 4, v20
  v_lshlrev_b32 v19, 10, v19
  v_lshl_add_u32 v19, v16, 4, v19
  v_lshl_or_b32 v29, v18, 30, v19
  s_lshl_b32 s51, s97, 30
  v_or_b32 v29, s51, v29
  v_and_b32 v19, 31, v1
  v_lshlrev_b32 v19, 2, v19
  v_lshrrev_b32 v18, 5, v1
  v_lshl_or_b32 v30, v18, 30, v19
  s_waitcnt lgkmcnt(0)
  s_barrier
  ds_read_b128 v[100:103], v4 offset:0
  ds_read_b128 v[104:107], v4 offset:5120
  ds_read_b128 v[108:111], v4 offset:10240
  ds_read_b128 v[112:115], v4 offset:1024
  ds_read_b128 v[116:119], v4 offset:6144
  ds_read_b128 v[120:123], v4 offset:11264
  ds_read_b128 v[124:127], v4 offset:2048
  ds_read_b128 v[128:131], v4 offset:7168
  ds_read_b128 v[132:135], v4 offset:12288
  s_waitcnt lgkmcnt(6)
  v_add_f32 v100, v100, v104
  v_add_f32 v48, v48, v108
  v_add_f32 v101, v101, v105
  v_add_f32 v49, v49, v109
  v_add_f32 v102, v102, v106
  v_add_f32 v50, v50, v110
  v_add_f32 v103, v103, v107
  v_add_f32 v51, v51, v111
  v_add_f32 v48, v48, v100
  v_add_f32 v49, v49, v101
  v_add_f32 v50, v50, v102
  v_add_f32 v51, v51, v103
  s_waitcnt lgkmcnt(3)
  v_add_f32 v112, v112, v116
  v_add_f32 v52, v52, v120
  v_add_f32 v113, v113, v117
  v_add_f32 v53, v53, v121
  v_add_f32 v114, v114, v118
  v_add_f32 v54, v54, v122
  v_add_f32 v115, v115, v119
  v_add_f32 v55, v55, v123
  v_add_f32 v52, v52, v112
  v_add_f32 v53, v53, v113
  v_add_f32 v54, v54, v114
  v_add_f32 v55, v55, v115
  s_waitcnt lgkmcnt(0)
  v_add_f32 v124, v124, v128
  v_add_f32 v56, v56, v132
  v_add_f32 v125, v125, v129
  v_add_f32 v57, v57, v133
  v_add_f32 v126, v126, v130
  v_add_f32 v58, v58, v134
  v_add_f32 v127, v127, v131
  v_add_f32 v59, v59, v135
  v_add_f32 v56, v56, v124
  v_add_f32 v57, v57, v125
  v_add_f32 v58, v58, v126
  v_add_f32 v59, v59, v127
  v_lshlrev_b32 v148, 16, v40
  v_and_b32 v149, 0xffff0000, v40
  v_lshlrev_b32 v150, 16, v41
  v_and_b32 v151, 0xffff0000, v41
  v_lshlrev_b32 v152, 16, v42
  v_and_b32 v153, 0xffff0000, v42
  v_lshlrev_b32 v154, 16, v43
  v_and_b32 v155, 0xffff0000, v43
  v_lshlrev_b32 v156, 16, v44
  v_and_b32 v157, 0xffff0000, v44
  v_lshlrev_b32 v158, 16, v45
  v_and_b32 v159, 0xffff0000, v45
  v_lshlrev_b32 v16, 16, v246
  v_and_b32 v17, 0xffff0000, v246
  v_lshlrev_b32 v18, 16, v247
  v_and_b32 v19, 0xffff0000, v247
  v_fmac_f32 v16, v136, v48
  v_fmac_f32 v17, v137, v49
  v_fmac_f32 v18, v138, v50
  v_fmac_f32 v19, v139, v51
  v_lshlrev_b32 v20, 16, v248
  v_and_b32 v21, 0xffff0000, v248
  v_lshlrev_b32 v22, 16, v249
  v_and_b32 v23, 0xffff0000, v249
  v_fmac_f32 v20, v140, v52
  v_fmac_f32 v21, v141, v53
  v_fmac_f32 v22, v142, v54
  v_fmac_f32 v23, v143, v55
  v_lshlrev_b32 v24, 16, v250
  v_and_b32 v25, 0xffff0000, v250
  v_lshlrev_b32 v26, 16, v251
  v_and_b32 v27, 0xffff0000, v251
  v_fmac_f32 v24, v144, v56
  v_fmac_f32 v25, v145, v57
  v_fmac_f32 v26, v146, v58
  v_fmac_f32 v27, v147, v59
  v_mul_f32 v148, v148, v16
  v_mul_f32 v149, v149, v17
  v_mul_f32 v150, v150, v18
  v_mul_f32 v151, v151, v19
  v_mul_f32 v152, v152, v20
  v_mul_f32 v153, v153, v21
  v_mul_f32 v154, v154, v22
  v_mul_f32 v155, v155, v23
  v_mul_f32 v156, v156, v24
  v_mul_f32 v157, v157, v25
  v_mul_f32 v158, v158, v26
  v_mul_f32 v159, v159, v27
  v_cvt_pk_bf16_f32 v32, v148, v149
  v_cvt_pk_bf16_f32 v33, v150, v151
  v_cvt_pk_bf16_f32 v34, v152, v153
  v_cvt_pk_bf16_f32 v35, v154, v155
  v_cvt_pk_bf16_f32 v36, v156, v157
  v_cvt_pk_bf16_f32 v37, v158, v159
  s_mul_i32 s51, s44, 81920
  s_mul_i32 s52, s45, 10240
  s_add_u32 s51, s51, s52
  s_mul_i32 s52, s97, 6144
  s_add_u32 s51, s51, s52
  s_lshl_b32 s52, s96, 8
  s_add_u32 s51, s51, s52
  s_add_u32 s51, s51, 16777216
  s_add_u32 s53, s51, 4096
  v_permlane16_swap_b32 v32, v34
  v_permlane16_swap_b32 v33, v35
  v_permlane16_swap_b32 v36, v38
  v_permlane16_swap_b32 v37, v39
  buffer_store_dwordx4 v[32:35], v28, s[32:35], s51 offen sc1
  buffer_store_dwordx4 v[36:39], v29, s[32:35], s53 offen sc1
  v_add_f32 v46, v16, v17
  v_mul_f32 v47, v16, v16
  v_fmac_f32 v47, v17, v17
  v_add_f32 v46, v46, v18
  v_fmac_f32 v47, v18, v18
  v_add_f32 v46, v46, v19
  v_fmac_f32 v47, v19, v19
  v_add_f32 v46, v46, v20
  v_fmac_f32 v47, v20, v20
  v_add_f32 v46, v46, v21
  v_fmac_f32 v47, v21, v21
  v_add_f32 v46, v46, v22
  v_fmac_f32 v47, v22, v22
  v_add_f32 v46, v46, v23
  v_fmac_f32 v47, v23, v23
  s_cmp_eq_u32 s97, 0
  s_cbranch_scc0 L_st_104
  v_add_f32 v46, v46, v24
  v_fmac_f32 v47, v24, v24
  v_add_f32 v46, v46, v25
  v_fmac_f32 v47, v25, v25
  v_add_f32 v46, v46, v26
  v_fmac_f32 v47, v26, v26
  v_add_f32 v46, v46, v27
  v_fmac_f32 v47, v27, v27
L_st_104:
  s_lshl_b32 s51, s44, 4
  s_lshl_b32 s52, s45, 1
  s_add_u32 s51, s51, s52
  s_add_u32 s51, s51, s97
  s_lshl_b32 s51, s51, 2
  s_add_u32 s51, s51, s96
  s_lshl_b32 s51, s51, 7
  s_add_u32 s51, s51, 262144
  v_permlane16_swap_b32 v46, v47
  v_add_f32 v46, v46, v47
  v_mov_b32 v47, v46
  s_nop 1
  v_permlane32_swap_b32 v46, v47
  v_add_f32 v46, v46, v47
  buffer_store_dword v46, v30, s[32:35], s51 offen sc1
  v_cvt_pk_bf16_f32 v240, v16, v17
  v_cvt_pk_bf16_f32 v241, v18, v19
  v_cvt_pk_bf16_f32 v242, v20, v21
  v_cvt_pk_bf16_f32 v243, v22, v23
  v_cvt_pk_bf16_f32 v244, v24, v25
  v_cvt_pk_bf16_f32 v245, v26, v27
  s_lshl_b32 s54, s44, 10
  s_lshl_b32 s52, s45, 7
  s_add_u32 s54, s54, s52
  s_add_u32 s54, s54, 950272
  s_waitcnt vmcnt(0)
  s_barrier
  s_cmp_eq_u32 s46, 7
  s_cbranch_scc0 L_w_105
  s_mov_b64 exec, 1
  buffer_store_dword v3, off, s[32:35], s54 sc1
  s_mov_b64 exec, -1
L_w_105:
  s_add_u32 s57, s57, 14336
  buffer_load_dwordx4 v[216:219], v8, s[32:35], s57 offen sc1
  s_add_u32 s57, s57, 14336
  buffer_load_dwordx4 v[220:223], v8, s[32:35], s57 offen sc1
  s_add_u32 s57, s57, 14336
  buffer_load_dwordx4 v[224:227], v8, s[32:35], s57 offen sc1
  s_add_u32 s57, s57, 14336
  buffer_load_dwordx4 v[228:231], v8, s[32:35], s57 offen sc1
  s_add_u32 s57, s57, 14336
  buffer_load_dwordx4 v[232:235], v8, s[32:35], s57 offen sc1
  s_add_u32 s57, s57, 14336
  buffer_load_dwordx4 v[236:239], v8, s[32:35], s57 offen sc1
  s_add_u32 s57, s57, 14336
  s_add_u32 s57, s56, 7168
  s_mov_b32 s36, s14
  s_mov_b32 s37, s15
  s_mov_b32 s38, 8388608
  s_mov_b32 s39, 0x20000
  v_lshrrev_b32 v9, 3, v1
  v_and_b32 v10, 6, v9
  v_and_b32 v11, 7, v1
  v_xor_b32 v10, v10, v11
  v_lshlrev_b32 v9, 12, v9
  v_lshl_add_u32 v9, v10, 4, v9
  s_lshl_b32 s30, s44, 18
  s_lshl_b32 s31, s46, 15
  s_add_u32 s30, s30, s31
  s_lshl_b32 s31, s46, 10
  v_and_b32 v10, 15, v1
  v_lshrrev_b32 v11, 4, v1
  v_lshlrev_b32 v4, 4, v10
  v_lshl_add_u32 v4, v11, 10, v4
  v_add_u32 v5, 0x10000, v4
  v_min_u32 v12, 1, v10
  v_mul_u32_u24 v12, 1280, v12
  v_lshl_add_u32 v12, v11, 4, v12
  v_add_u32 v6, 81920, v12
  v_lshlrev_b32 v7, 3, v10
  s_mov_b32 s40, s16
  s_mov_b32 s41, s17
  s_mov_b32 s42, 4096
  s_mov_b32 s43, 0x20000
  v_lshlrev_b32 v12, 1, v10
  s_lshl_b32 s51, s44, 7
  buffer_load_ushort v16, v12, s[40:43], s51 offen offset:0
  buffer_load_ushort v17, v12, s[40:43], s51 offen offset:32
  buffer_load_ushort v18, v12, s[40:43], s51 offen offset:64
  buffer_load_ushort v19, v12, s[40:43], s51 offen offset:96
  s_lshl_b32 s51, s44, 10
  s_lshl_b32 s52, s46, 7
  s_add_u32 s51, s51, s52
  s_add_u32 s51, s51, 950272
  v_mov_b32 v10, s51
  s_mov_b32 s61, 0
L_poll_106:
  buffer_load_dword v11, v10, s[32:35], 0 offen sc1
L_pchk_108:
  s_waitcnt vmcnt(0)
  v_cmp_ne_u32 vcc, s47, v11
  s_nop 1
  s_cmp_eq_u64 vcc, 0
  s_cbranch_scc1 L_pdone_107
  s_add_u32 s61, s61, 1
  s_cmp_lt_u32 s61, 40000
  s_cbranch_scc1 L_poll_106
L_pdone_107:
  v_lshl_or_b32 v254, v17, 16, v16
  v_lshl_or_b32 v255, v19, 16, v18
  s_mul_i32 s53, s46, 10240
  s_mul_i32 s52, s44, 81920
  s_add_u32 s52, s52, s53
  s_add_u32 s52, s52, 16777216
  s_mov_b32 m0, s53
  s_nop 0
  buffer_load_dwordx4 v2, s[32:35], s52 offen sc1 lds
  buffer_load_dwordx4 v2, s[32:35], s52 offen offset:1024 sc1 lds
  buffer_load_dwordx4 v2, s[32:35], s52 offen offset:2048 sc1 lds
  buffer_load_dwordx4 v2, s[32:35], s52 offen offset:3072 sc1 lds
  s_add_u32 s52, s52, 4096
  s_add_u32 s53, s53, 4096
  s_mov_b32 m0, s53
  s_nop 0
  buffer_load_dwordx4 v2, s[32:35], s52 offen sc1 lds
  buffer_load_dwordx4 v2, s[32:35], s52 offen offset:1024 sc1 lds
  buffer_load_dwordx4 v2, s[32:35], s52 offen offset:2048 sc1 lds
  buffer_load_dwordx4 v2, s[32:35], s52 offen offset:3072 sc1 lds
  s_add_u32 s52, s52, 4096
  s_add_u32 s53, s53, 4096
  s_mov_b32 m0, s53
  s_nop 0
  buffer_load_dwordx4 v2, s[32:35], s52 offen sc1 lds
  buffer_load_dwordx4 v2, s[32:35], s52 offen offset:1024 sc1 lds
  ds_read_b128 v[48:51], v6 offset:0
  ds_read_b128 v[52:55], v6 offset:64
  ds_read_b128 v[56:59], v6 offset:128
  ds_read_b128 v[60:63], v6 offset:192
  s_waitcnt lgkmcnt(3)
  v_mfma_f32_16x16x32_bf16 v[12:15], v[160:163], v[48:51], 0
  s_waitcnt lgkmcnt(2)
  v_mfma_f32_16x16x32_bf16 v[12:15], v[164:167], v[52:55], v[12:15]
  s_waitcnt lgkmcnt(1)
  v_mfma_f32_16x16x32_bf16 v[12:15], v[168:171], v[56:59], v[12:15]
  s_waitcnt lgkmcnt(0)
  v_mfma_f32_16x16x32_bf16 v[12:15], v[172:175], v[60:63], v[12:15]
  ds_read_b128 v[48:51], v6 offset:256
  ds_read_b128 v[52:55], v6 offset:320
  ds_read_b128 v[56:59], v6 offset:384
  ds_read_b128 v[60:63], v6 offset:448
  s_waitcnt lgkmcnt(3)
  v_mfma_f32_16x16x32_bf16 v[12:15], v[176:179], v[48:51], v[12:15]
  s_waitcnt lgkmcnt(2)
  v_mfma_f32_16x16x32_bf16 v[12:15], v[180:183], v[52:55], v[12:15]
  s_waitcnt lgkmcnt(1)
  v_mfma_f32_16x16x32_bf16 v[12:15], v[184:187], v[56:59], v[12:15]
  s_waitcnt lgkmcnt(0)
  v_mfma_f32_16x16x32_bf16 v[12:15], v[188:191], v[60:63], v[12:15]
  ds_read_b128 v[48:51], v6 offset:512
  ds_read_b128 v[52:55], v6 offset:576
  ds_read_b128 v[56:59], v6 offset:640
  ds_read_b128 v[60:63], v6 offset:704
  s_waitcnt lgkmcnt(3)
  v_mfma_f32_16x16x32_bf16 v[12:15], v[192:195], v[48:51], v[12:15]
  s_waitcnt lgkmcnt(2)
  v_mfma_f32_16x16x32_bf16 v[12:15], v[196:199], v[52:55], v[12:15]
  s_waitcnt lgkmcnt(1)
  v_mfma_f32_16x16x32_bf16 v[12:15], v[200:203], v[56:59], v[12:15]
  s_waitcnt lgkmcnt(0)
  v_mfma_f32_16x16x32_bf16 v[12:15], v[204:207], v[60:63], v[12:15]
  ds_read_b128 v[48:51], v6 offset:768
  ds_read_b128 v[52:55], v6 offset:832
  ds_read_b128 v[56:59], v6 offset:896
  ds_read_b128 v[60:63], v6 offset:960
  s_waitcnt lgkmcnt(3)
  v_mfma_f32_16x16x32_bf16 v[12:15], v[208:211], v[48:51], v[12:15]
  s_waitcnt lgkmcnt(2)
  v_mfma_f32_16x16x32_bf16 v[12:15], v[212:215], v[52:55], v[12:15]
  s_waitcnt lgkmcnt(1)
  v_mfma_f32_16x16x32_bf16 v[12:15], v[216:219], v[56:59], v[12:15]
  s_waitcnt lgkmcnt(0)
  v_mfma_f32_16x16x32_bf16 v[12:15], v[220:223], v[60:63], v[12:15]
  ds_read_b128 v[48:51], v6 offset:1024
  ds_read_b128 v[52:55], v6 offset:1088
  ds_read_b128 v[56:59], v6 offset:1152
  ds_read_b128 v[60:63], v6 offset:1216
  s_waitcnt lgkmcnt(3)
  v_mfma_f32_16x16x32_bf16 v[12:15], v[224:227], v[48:51], v[12:15]
  s_waitcnt lgkmcnt(2)
  v_mfma_f32_16x16x32_bf16 v[12:15], v[228:231], v[52:55], v[12:15]
  s_waitcnt lgkmcnt(1)
  v_mfma_f32_16x16x32_bf16 v[12:15], v[232:235], v[56:59], v[12:15]
  s_waitcnt lgkmcnt(0)
  v_mfma_f32_16x16x32_bf16 v[12:15], v[236:239], v[60:63], v[12:15]
  buffer_load_dwordx4 v[96:99], v8, s[32:35], s57 offen sc1
  s_add_u32 s57, s57, 14336
  buffer_load_dwordx4 v[100:103], v8, s[32:35], s57 offen sc1
  s_add_u32 s57, s57, 14336
  buffer_load_dwordx4 v[104:107], v8, s[32:35], s57 offen sc1
  s_add_u32 s57, s57, 14336
  s_waitcnt vmcnt(3)
  s_barrier
  s_cmp_eq_u32 s46, 7
  s_cbranch_scc1 L_svc_109
  v_mov_b32_dpp v246, v12 row_newbcast:0 row_mask:0xf bank_mask:0xf
  v_mov_b32_dpp v250, v12 row_newbcast:1 row_mask:0xf bank_mask:0xf
  v_mov_b32_dpp v247, v13 row_newbcast:0 row_mask:0xf bank_mask:0xf
  v_mov_b32_dpp v251, v13 row_newbcast:1 row_mask:0xf bank_mask:0xf
  v_mov_b32_dpp v248, v14 row_newbcast:0 row_mask:0xf bank_mask:0xf
  v_mov_b32_dpp v252, v14 row_newbcast:1 row_mask:0xf bank_mask:0xf
  v_mov_b32_dpp v249, v15 row_newbcast:0 row_mask:0xf bank_mask:0xf
  v_mov_b32_dpp v253, v15 row_newbcast:1 row_mask:0xf bank_mask:0xf
  ds_read_b128 v[48:51], v4 offset:0
  ds_read_b128 v[52:55], v4 offset:256
  ds_read_b128 v[56:59], v4 offset:512
  ds_read_b128 v[60:63], v4 offset:768
  ds_read_b128 v[64:67], v4 offset:4096
  ds_read_b128 v[68:71], v4 offset:4352
  ds_read_b128 v[72:75], v4 offset:4608
  ds_read_b128 v[76:79], v4 offset:4864
  s_waitcnt lgkmcnt(4)
  v_mfma_f32_16x16x32_bf16 v[16:19], v[160:163], v[48:51], 0
  ds_read_b128 v[80:83], v4 offset:8192
  ds_read_b128 v[84:87], v4 offset:8448
  v_mfma_f32_16x16x32_bf16 v[20:23], v[160:163], v[52:55], 0
  ds_read_b128 v[88:91], v4 offset:8704
  v_mfma_f32_16x16x32_bf16 v[24:27], v[160:163], v[56:59], 0
  ds_read_b128 v[92:95], v4 offset:8960
  v_mfma_f32_16x16x32_bf16 v[28:31], v[160:163], v[60:63], 0
  buffer_load_dwordx4 v[108:111], v8, s[32:35], s57 offen sc1
  s_add_u32 s57, s57, 14336
  s_waitcnt lgkmcnt(4)
  v_mfma_f32_16x16x32_bf16 v[16:19], v[164:167], v[64:67], v[16:19]
  ds_read_b128 v[48:51], v4 offset:12288
  ds_read_b128 v[52:55], v4 offset:12544
  v_mfma_f32_16x16x32_bf16 v[20:23], v[164:167], v[68:71], v[20:23]
  ds_read_b128 v[56:59], v4 offset:12800
  v_mfma_f32_16x16x32_bf16 v[24:27], v[164:167], v[72:75], v[24:27]
  ds_read_b128 v[60:63], v4 offset:13056
  v_mfma_f32_16x16x32_bf16 v[28:31], v[164:167], v[76:79], v[28:31]
  buffer_load_dwordx4 v[112:115], v8, s[32:35], s57 offen sc1
  s_add_u32 s57, s57, 14336
  s_waitcnt lgkmcnt(4)
  v_mfma_f32_16x16x32_bf16 v[16:19], v[168:171], v[80:83], v[16:19]
  ds_read_b128 v[64:67], v4 offset:16384
  ds_read_b128 v[68:71], v4 offset:16640
  v_mfma_f32_16x16x32_bf16 v[20:23], v[168:171], v[84:87], v[20:23]
  ds_read_b128 v[72:75], v4 offset:16896
  v_mfma_f32_16x16x32_bf16 v[24:27], v[168:171], v[88:91], v[24:27]
  ds_read_b128 v[76:79], v4 offset:17152
  v_mfma_f32_16x16x32_bf16 v[28:31], v[168:171], v[92:95], v[28:31]
  buffer_load_dwordx4 v[116:119], v8, s[32:35], s57 offen sc1
  s_add_u32 s57, s57, 14336
  s_waitcnt lgkmcnt(4)
  v_mfma_f32_16x16x32_bf16 v[16:19], v[172:175], v[48:51], v[16:19]
  ds_read_b128 v[80:83], v4 offset:20480
  ds_read_b128 v[84:87], v4 offset:20736
  v_mfma_f32_16x16x32_bf16 v[20:23], v[172:175], v[52:55], v[20:23]
  ds_read_b128 v[88:91], v4 offset:20992
  v_mfma_f32_16x16x32_bf16 v[24:27], v[172:175], v[56:59], v[24:27]
  ds_read_b128 v[92:95], v4 offset:21248
  v_mfma_f32_16x16x32_bf16 v[28:31], v[172:175], v[60:63], v[28:31]
  buffer_load_dwordx4 v[120:123], v8, s[32:35], s57 offen sc1
  s_add_u32 s57, s57, 14336
  s_waitcnt lgkmcnt(4)
  v_mfma_f32_16x16x32_bf16 v[16:19], v[176:179], v[64:67], v[16:19]
  ds_read_b128 v[48:51], v4 offset:24576
  ds_read_b128 v[52:55], v4 offset:24832
  v_mfma_f32_16x16x32_bf16 v[20:23], v[176:179], v[68:71], v[20:23]
  ds_read_b128 v[56:59], v4 offset:25088
  v_mfma_f32_16x16x32_bf16 v[24:27], v[176:179], v[72:75], v[24:27]
  ds_read_b128 v[60:63], v4 offset:25344
  v_mfma_f32_16x16x32_bf16 v[28:31], v[176:179], v[76:79], v[28:31]
  buffer_load_dwordx4 v[124:127], v8, s[32:35], s57 offen sc1
  s_add_u32 s57, s57, 14336
  s_waitcnt lgkmcnt(4)
  v_mfma_f32_16x16x32_bf16 v[16:19], v[180:183], v[80:83], v[16:19]
  ds_read_b128 v[64:67], v4 offset:28672
  ds_read_b128 v[68:71], v4 offset:28928
  v_mfma_f32_16x16x32_bf16 v[20:23], v[180:183], v[84:87], v[20:23]
  ds_read_b128 v[72:75], v4 offset:29184
  v_mfma_f32_16x16x32_bf16 v[24:27], v[180:183], v[88:91], v[24:27]
  ds_read_b128 v[76:79], v4 offset:29440
  v_mfma_f32_16x16x32_bf16 v[28:31], v[180:183], v[92:95], v[28:31]
  buffer_load_dwordx4 v[128:131], v8, s[32:35], s57 offen sc1
  s_add_u32 s57, s57, 14336
  s_waitcnt lgkmcnt(4)
  v_mfma_f32_16x16x32_bf16 v[16:19], v[184:187], v[48:51], v[16:19]
  ds_read_b128 v[80:83], v4 offset:32768
  ds_read_b128 v[84:87], v4 offset:33024
  v_mfma_f32_16x16x32_bf16 v[20:23], v[184:187], v[52:55], v[20:23]
  ds_read_b128 v[88:91], v4 offset:33280
  v_mfma_f32_16x16x32_bf16 v[24:27], v[184:187], v[56:59], v[24:27]
  ds_read_b128 v[92:95], v4 offset:33536
  v_mfma_f32_16x16x32_bf16 v[28:31], v[184:187], v[60:63], v[28:31]
  buffer_load_dwordx4 v[132:135], v8, s[32:35], s57 offen sc1
  s_add_u32 s57, s57, 14336
  s_waitcnt lgkmcnt(4)
  v_mfma_f32_16x16x32_bf16 v[16:19], v[188:191], v[64:67], v[16:19]
  ds_read_b128 v[48:51], v4 offset:36864
  ds_read_b128 v[52:55], v4 offset:37120
  v_mfma_f32_16x16x32_bf16 v[20:23], v[188:191], v[68:71], v[20:23]
  ds_read_b128 v[56:59], v4 offset:37376
  v_mfma_f32_16x16x32_bf16 v[24:27], v[188:191], v[72:75], v[24:27]
  ds_read_b128 v[60:63], v4 offset:37632
  v_mfma_f32_16x16x32_bf16 v[28:31], v[188:191], v[76:79], v[28:31]
  buffer_load_dwordx4 v[136:139], v8, s[32:35], s57 offen sc1
  s_add_u32 s57, s57, 14336
  s_waitcnt lgkmcnt(4)
  v_mfma_f32_16x16x32_bf16 v[16:19], v[192:195], v[80:83], v[16:19]
  ds_read_b128 v[64:67], v4 offset:40960
  ds_read_b128 v[68:71], v4 offset:41216
  v_mfma_f32_16x16x32_bf16 v[20:23], v[192:195], v[84:87], v[20:23]
  ds_read_b128 v[72:75], v4 offset:41472
  v_mfma_f32_16x16x32_bf16 v[24:27], v[192:195], v[88:91], v[24:27]
  ds_read_b128 v[76:79], v4 offset:41728
  v_mfma_f32_16x16x32_bf16 v[28:31], v[192:195], v[92:95], v[28:31]
  buffer_load_dwordx4 v[140:143], v8, s[32:35], s57 offen sc1
  s_add_u32 s57, s57, 14336
  s_waitcnt lgkmcnt(4)
  v_mfma_f32_16x16x32_bf16 v[16:19], v[196:199], v[48:51], v[16:19]
  ds_read_b128 v[80:83], v4 offset:45056
  v_mfma_f32_16x16x32_bf16 v[20:23], v[196:199], v[52:55], v[20:23]
  ds_read_b128 v[84:87], v4 offset:45312
  v_mfma_f32_16x16x32_bf16 v[24:27], v[196:199], v[56:59], v[24:27]
  ds_read_b128 v[88:91], v4 offset:45568
  v_mfma_f32_16x16x32_bf16 v[28:31], v[196:199], v[60:63], v[28:31]
  ds_read_b128 v[92:95], v4 offset:45824
  s_waitcnt lgkmcnt(4)
  v_mfma_f32_16x16x32_bf16 v[16:19], v[200:203], v[64:67], v[16:19]
  ds_read_b128 v[48:51], v4 offset:49152
  ds_read_b128 v[52:55], v4 offset:49408
  v_mfma_f32_16x16x32_bf16 v[20:23], v[200:203], v[68:71], v[20:23]
  ds_read_b128 v[56:59], v4 offset:49664
  v_mfma_f32_16x16x32_bf16 v[24:27], v[200:203], v[72:75], v[24:27]
  ds_read_b128 v[60:63], v4 offset:49920
  v_mfma_f32_16x16x32_bf16 v[28:31], v[200:203], v[76:79], v[28:31]
  buffer_load_dwordx4 v[144:147], v8, s[32:35], s57 offen sc1
  s_add_u32 s57, s57, 14336
  s_waitcnt lgkmcnt(4)
  v_mfma_f32_16x16x32_bf16 v[16:19], v[204:207], v[80:83], v[16:19]
  ds_read_b128 v[64:67], v4 offset:53248
  ds_read_b128 v[68:71], v4 offset:53504
  v_mfma_f32_16x16x32_bf16 v[20:23], v[204:207], v[84:87], v[20:23]
  ds_read_b128 v[72:75], v4 offset:53760
  v_mfma_f32_16x16x32_bf16 v[24:27], v[204:207], v[88:91], v[24:27]
  ds_read_b128 v[76:79], v4 offset:54016
  v_mfma_f32_16x16x32_bf16 v[28:31], v[204:207], v[92:95], v[28:31]
  buffer_load_dwordx4 v[148:151], v8, s[32:35], s57 offen sc1
  s_add_u32 s57, s57, 14336
  s_waitcnt lgkmcnt(4)
  v_mfma_f32_16x16x32_bf16 v[16:19], v[208:211], v[48:51], v[16:19]
  ds_read_b128 v[80:83], v4 offset:57344
  ds_read_b128 v[84:87], v4 offset:57600
  v_mfma_f32_16x16x32_bf16 v[20:23], v[208:211], v[52:55], v[20:23]
  ds_read_b128 v[88:91], v4 offset:57856
  v_mfma_f32_16x16x32_bf16 v[24:27], v[208:211], v[56:59], v[24:27]
  ds_read_b128 v[92:95], v4 offset:58112
  v_mfma_f32_16x16x32_bf16 v[28:31], v[208:211], v[60:63], v[28:31]
  buffer_load_dwordx4 v[152:155], v8, s[32:35], s57 offen sc1
  s_add_u32 s57, s57, 14336
  s_waitcnt lgkmcnt(4)
  v_mfma_f32_16x16x32_bf16 v[16:19], v[212:215], v[64:67], v[16:19]
  ds_read_b128 v[48:51], v4 offset:61440
  ds_read_b128 v[52:55], v4 offset:61696
  v_mfma_f32_16x16x32_bf16 v[20:23], v[212:215], v[68:71], v[20:23]
  ds_read_b128 v[56:59], v4 offset:61952
  v_mfma_f32_16x16x32_bf16 v[24:27], v[212:215], v[72:75], v[24:27]
  ds_read_b128 v[60:63], v4 offset:62208
  v_mfma_f32_16x16x32_bf16 v[28:31], v[212:215], v[76:79], v[28:31]
  buffer_load_dwordx4 v[156:159], v8, s[32:35], s57 offen sc1
  s_add_u32 s57, s57, 14336
  s_waitcnt lgkmcnt(4)
  v_mfma_f32_16x16x32_bf16 v[16:19], v[216:219], v[80:83], v[16:19]
  ds_read_b128 v[64:67], v5 offset:0
  ds_read_b128 v[68:71], v5 offset:256
  v_mfma_f32_16x16x32_bf16 v[20:23], v[216:219], v[84:87], v[20:23]
  ds_read_b128 v[72:75], v5 offset:512
  v_mfma_f32_16x16x32_bf16 v[24:27], v[216:219], v[88:91], v[24:27]
  ds_read_b128 v[76:79], v5 offset:768
  v_mfma_f32_16x16x32_bf16 v[28:31], v[216:219], v[92:95], v[28:31]
  buffer_load_dwordx4 v[160:163], v8, s[32:35], s57 offen sc1
  s_add_u32 s57, s57, 14336
  s_waitcnt lgkmcnt(4)
  v_mfma_f32_16x16x32_bf16 v[16:19], v[220:223], v[48:51], v[16:19]
  ds_read_b128 v[80:83], v5 offset:4096
  ds_read_b128 v[84:87], v5 offset:4352
  v_mfma_f32_16x16x32_bf16 v[20:23], v[220:223], v[52:55], v[20:23]
  ds_read_b128 v[88:91], v5 offset:4608
  v_mfma_f32_16x16x32_bf16 v[24:27], v[220:223], v[56:59], v[24:27]
  ds_read_b128 v[92:95], v5 offset:4864
  v_mfma_f32_16x16x32_bf16 v[28:31], v[220:223], v[60:63], v[28:31]
  buffer_load_dwordx4 v[164:167], v8, s[32:35], s57 offen sc1
  s_add_u32 s57, s57, 14336
  s_waitcnt lgkmcnt(4)
  v_mfma_f32_16x16x32_bf16 v[16:19], v[224:227], v[64:67], v[16:19]
  ds_read_b128 v[48:51], v5 offset:8192
  ds_read_b128 v[52:55], v5 offset:8448
  v_mfma_f32_16x16x32_bf16 v[20:23], v[224:227], v[68:71], v[20:23]
  ds_read_b128 v[56:59], v5 offset:8704
  v_mfma_f32_16x16x32_bf16 v[24:27], v[224:227], v[72:75], v[24:27]
  ds_read_b128 v[60:63], v5 offset:8960
  v_mfma_f32_16x16x32_bf16 v[28:31], v[224:227], v[76:79], v[28:31]
  buffer_load_dwordx4 v[168:171], v8, s[32:35], s57 offen sc1
  s_add_u32 s57, s57, 14336
  s_waitcnt lgkmcnt(4)
  v_mfma_f32_16x16x32_bf16 v[16:19], v[228:231], v[80:83], v[16:19]
  ds_read_b128 v[64:67], v5 offset:12288
  ds_read_b128 v[68:71], v5 offset:12544
  v_mfma_f32_16x16x32_bf16 v[20:23], v[228:231], v[84:87], v[20:23]
  ds_read_b128 v[72:75], v5 offset:12800
  v_mfma_f32_16x16x32_bf16 v[24:27], v[228:231], v[88:91], v[24:27]
  ds_read_b128 v[76:79], v5 offset:13056
  v_mfma_f32_16x16x32_bf16 v[28:31], v[228:231], v[92:95], v[28:31]
  buffer_load_dwordx4 v[172:175], v8, s[32:35], s57 offen sc1
  s_add_u32 s57, s57, 14336
  s_waitcnt lgkmcnt(4)
  v_mfma_f32_16x16x32_bf16 v[16:19], v[232:235], v[48:51], v[16:19]
  v_mfma_f32_16x16x32_bf16 v[20:23], v[232:235], v[52:55], v[20:23]
  v_mfma_f32_16x16x32_bf16 v[24:27], v[232:235], v[56:59], v[24:27]
  v_mfma_f32_16x16x32_bf16 v[28:31], v[232:235], v[60:63], v[28:31]
  s_waitcnt lgkmcnt(0)
  v_mfma_f32_16x16x32_bf16 v[16:19], v[236:239], v[64:67], v[16:19]
  v_mfma_f32_16x16x32_bf16 v[20:23], v[236:239], v[68:71], v[20:23]
  v_mfma_f32_16x16x32_bf16 v[24:27], v[236:239], v[72:75], v[24:27]
  v_mfma_f32_16x16x32_bf16 v[28:31], v[236:239], v[76:79], v[28:31]
  v_mov_b32 v10, 97280
  v_add_u32 v11, 96768, v7
  s_mov_b32 s61, 0
L_lf_111:
  ds_read_b32 v88, v10
  ds_read_b64 v[80:81], v11 offset:0
  ds_read_b64 v[82:83], v11 offset:128
  ds_read_b64 v[84:85], v11 offset:256
  ds_read_b64 v[86:87], v11 offset:384
  s_waitcnt lgkmcnt(0)
  v_readfirstlane_b32 s51, v88
  s_nop 1
  s_cmp_eq_u32 s51, 1
  s_cbranch_scc1 L_lfd_112
  s_add_u32 s61, s61, 1
  s_cmp_lt_u32 s61, 320000
  s_cbranch_scc1 L_lf_111
L_lfd_112:
  s_add_u32 s59, s30, 0
  s_add_u32 m0, s31, 98304
  s_nop 0
  buffer_load_dwordx4 v9, s[36:39], s59 offen lds
  s_add_u32 s59, s30, 128
  s_add_u32 m0, s31, 106496
  s_nop 0
  buffer_load_dwordx4 v9, s[36:39], s59 offen lds
  s_add_u32 s59, s30, 256
  s_add_u32 m0, s31, 114688
  s_nop 0
  buffer_load_dwordx4 v9, s[36:39], s59 offen lds
  s_add_u32 s59, s30, 384
  s_add_u32 m0, s31, 122880
  s_nop 0
  buffer_load_dwordx4 v9, s[36:39], s59 offen lds
  v_fma_f32 v48, -v81, v246, v250
  v_fma_f32 v49, -v81, v247, v251
  v_fma_f32 v50, -v81, v248, v252
  v_fma_f32 v51, -v81, v249, v253
  v_fma_f32 v52, -v83, v246, v250
  v_fma_f32 v53, -v83, v247, v251
  v_fma_f32 v54, -v83, v248, v252
  v_fma_f32 v55, -v83, v249, v253
  v_fma_f32 v56, -v85, v246, v250
  v_fma_f32 v57, -v85, v247, v251
  v_fma_f32 v58, -v85, v248, v252
  v_fma_f32 v59, -v85, v249, v253
  v_fma_f32 v60, -v87, v246, v250
  v_fma_f32 v61, -v87, v247, v251
  v_fma_f32 v62, -v87, v248, v252
  v_fma_f32 v63, -v87, v249, v253
  v_fma_f32 v16, v16, v80, v48
  v_fma_f32 v17, v17, v80, v49
  v_fma_f32 v18, v18, v80, v50
  v_fma_f32 v19, v19, v80, v51
  v_fma_f32 v20, v20, v82, v52
  v_fma_f32 v21, v21, v82, v53
  v_fma_f32 v22, v22, v82, v54
  v_fma_f32 v23, v23, v82, v55
  v_fma_f32 v24, v24, v84, v56
  v_fma_f32 v25, v25, v84, v57
  v_fma_f32 v26, v26, v84, v58
  v_fma_f32 v27, v27, v84, v59
  v_fma_f32 v28, v28, v86, v60
  v_fma_f32 v29, v29, v86, v61
  v_fma_f32 v30, v30, v86, v62
  v_fma_f32 v31, v31, v86, v63
  s_add_u32 s59, s30, 512
  s_add_u32 m0, s31, 131072
  s_nop 0
  buffer_load_dwordx4 v9, s[36:39], s59 offen lds
  s_add_u32 s59, s30, 640
  s_add_u32 m0, s31, 139264
  s_nop 0
  buffer_load_dwordx4 v9, s[36:39], s59 offen lds
  s_add_u32 s59, s30, 768
  s_add_u32 m0, s31, 147456
  s_nop 0
  buffer_load_dwordx4 v9, s[36:39], s59 offen lds
  s_add_u32 s59, s30, 896
  s_add_u32 m0, s31, 155648
  s_nop 0
  buffer_load_dwordx4 v9, s[36:39], s59 offen lds
  v_mov_b32 v64, 0xc0135761
  v_mul_f32 v48, v16, v16
  v_mul_f32 v49, v17, v17
  v_mul_f32 v50, v18, v18
  v_mul_f32 v51, v19, v19
  v_mul_f32 v52, v20, v20
  v_mul_f32 v53, v21, v21
  v_mul_f32 v54, v22, v22
  v_mul_f32 v55, v23, v23
  v_mul_f32 v56, v24, v24
  v_mul_f32 v57, v25, v25
  v_mul_f32 v58, v26, v26
  v_mul_f32 v59, v27, v27
  v_mul_f32 v60, v28, v28
  v_mul_f32 v61, v29, v29
  v_mul_f32 v62, v30, v30
  v_mul_f32 v63, v31, v31
  v_fmamk_f32 v48, v48, 0xbdd2d3e8, v64
  v_fmamk_f32 v49, v49, 0xbdd2d3e8, v64
  v_fmamk_f32 v50, v50, 0xbdd2d3e8, v64
  v_fmamk_f32 v51, v51, 0xbdd2d3e8, v64
  v_fmamk_f32 v52, v52, 0xbdd2d3e8, v64
  v_fmamk_f32 v53, v53, 0xbdd2d3e8, v64
  v_fmamk_f32 v54, v54, 0xbdd2d3e8, v64
  v_fmamk_f32 v55, v55, 0xbdd2d3e8, v64
  v_fmamk_f32 v56, v56, 0xbdd2d3e8, v64
  v_fmamk_f32 v57, v57, 0xbdd2d3e8, v64
  v_fmamk_f32 v58, v58, 0xbdd2d3e8, v64
  v_fmamk_f32 v59, v59, 0xbdd2d3e8, v64
  v_fmamk_f32 v60, v60, 0xbdd2d3e8, v64
  v_fmamk_f32 v61, v61, 0xbdd2d3e8, v64
  v_fmamk_f32 v62, v62, 0xbdd2d3e8, v64
  v_fmamk_f32 v63, v63, 0xbdd2d3e8, v64
  v_mul_f32 v48, v48, v16
  v_mul_f32 v49, v49, v17
  v_mul_f32 v50, v50, v18
  v_mul_f32 v51, v51, v19
  v_mul_f32 v52, v52, v20
  v_mul_f32 v53, v53, v21
  v_mul_f32 v54, v54, v22
  v_mul_f32 v55, v55, v23
  v_mul_f32 v56, v56, v24
  v_mul_f32 v57, v57, v25
  v_mul_f32 v58, v58, v26
  v_mul_f32 v59, v59, v27
  v_mul_f32 v60, v60, v28
  v_mul_f32 v61, v61, v29
  v_mul_f32 v62, v62, v30
  v_mul_f32 v63, v63, v31
  v_exp_f32 v48, v48
  v_exp_f32 v49, v49
  v_exp_f32 v50, v50
  v_exp_f32 v51, v51
  v_exp_f32 v52, v52
  v_exp_f32 v53, v53
  v_exp_f32 v54, v54
  v_exp_f32 v55, v55
  v_exp_f32 v56, v56
  v_exp_f32 v57, v57
  v_exp_f32 v58, v58
  v_exp_f32 v59, v59
  v_exp_f32 v60, v60
  v_exp_f32 v61, v61
  v_exp_f32 v62, v62
  v_exp_f32 v63, v63
  v_add_f32 v48, 1.0, v48
  v_add_f32 v49, 1.0, v49
  v_add_f32 v50, 1.0, v50
  v_add_f32 v51, 1.0, v51
  v_add_f32 v52, 1.0, v52
  v_add_f32 v53, 1.0, v53
  v_add_f32 v54, 1.0, v54
  v_add_f32 v55, 1.0, v55
  v_add_f32 v56, 1.0, v56
  v_add_f32 v57, 1.0, v57
  v_add_f32 v58, 1.0, v58
  v_add_f32 v59, 1.0, v59
  v_add_f32 v60, 1.0, v60
  v_add_f32 v61, 1.0, v61
  v_add_f32 v62, 1.0, v62
  v_add_f32 v63, 1.0, v63
  v_rcp_f32 v48, v48
  v_rcp_f32 v49, v49
  v_rcp_f32 v50, v50
  v_rcp_f32 v51, v51
  v_rcp_f32 v52, v52
  v_rcp_f32 v53, v53
  v_rcp_f32 v54, v54
  v_rcp_f32 v55, v55
  v_rcp_f32 v56, v56
  v_rcp_f32 v57, v57
  v_rcp_f32 v58, v58
  v_rcp_f32 v59, v59
  v_rcp_f32 v60, v60
  v_rcp_f32 v61, v61
  v_rcp_f32 v62, v62
  v_rcp_f32 v63, v63
  v_mul_f32 v16, v16, v48
  v_mul_f32 v17, v17, v49
  v_mul_f32 v18, v18, v50
  v_mul_f32 v19, v19, v51
  v_mul_f32 v20, v20, v52
  v_mul_f32 v21, v21, v53
  v_mul_f32 v22, v22, v54
  v_mul_f32 v23, v23, v55
  v_mul_f32 v24, v24, v56
  v_mul_f32 v25, v25, v57
  v_mul_f32 v26, v26, v58
  v_mul_f32 v27, v27, v59
  v_mul_f32 v28, v28, v60
  v_mul_f32 v29, v29, v61
  v_mul_f32 v30, v30, v62
  v_mul_f32 v31, v31, v63
  v_add_f32 v48, v16, v17
  v_mul_f32 v52, v16, v16
  v_add_f32 v68, v18, v19
  v_fmac_f32 v52, v17, v17
  v_add_f32 v48, v48, v68
  v_fmac_f32 v52, v18, v18
  v_fmac_f32 v52, v19, v19
  v_add_f32 v49, v20, v21
  v_mul_f32 v53, v20, v20
  v_add_f32 v69, v22, v23
  v_fmac_f32 v53, v21, v21
  v_add_f32 v49, v49, v69
  v_fmac_f32 v53, v22, v22
  v_fmac_f32 v53, v23, v23
  v_add_f32 v50, v24, v25
  v_mul_f32 v54, v24, v24
  v_add_f32 v70, v26, v27
  v_fmac_f32 v54, v25, v25
  v_add_f32 v50, v50, v70
  v_fmac_f32 v54, v26, v26
  v_fmac_f32 v54, v27, v27
  v_add_f32 v51, v28, v29
  v_mul_f32 v55, v28, v28
  v_add_f32 v71, v30, v31
  v_fmac_f32 v55, v29, v29
  v_add_f32 v51, v51, v71
  v_fmac_f32 v55, v30, v30
  v_fmac_f32 v55, v31, v31
  v_permlane16_swap_b32 v48, v49
  v_permlane16_swap_b32 v50, v51
  v_permlane16_swap_b32 v52, v53
  v_permlane16_swap_b32 v54, v55
  v_add_f32 v48, v48, v49
  v_add_f32 v50, v50, v51
  v_add_f32 v52, v52, v53
  v_add_f32 v54, v54, v55
  v_permlane32_swap_b32 v48, v50
  s_nop 0
  v_permlane32_swap_b32 v52, v54
  v_add_f32 v56, v48, v50
  v_add_f32 v57, v52, v54
  s_lshl_b32 s51, s46, 9
  s_add_u32 s51, s51, 85504
  v_lshlrev_b32 v58, 3, v1
  v_add_u32 v58, s51, v58
  ds_write_b64 v58, v[56:57]
  s_waitcnt lgkmcnt(0)
  s_barrier
  ds_read_b128 v[48:51], v4 offset:0
  ds_read_b128 v[52:55], v4 offset:256
  ds_read_b128 v[56:59], v4 offset:512
  ds_read_b128 v[60:63], v4 offset:768
  ds_read_b128 v[64:67], v4 offset:4096
  ds_read_b128 v[68:71], v4 offset:4352
  ds_read_b128 v[72:75], v4 offset:4608
  ds_read_b128 v[76:79], v4 offset:4864
  s_waitcnt vmcnt(27) lgkmcnt(4)
  v_mfma_f32_16x16x32_bf16 v[32:35], v[96:99], v[48:51], 0
  ds_read_b128 v[80:83], v4 offset:8192
  ds_read_b128 v[84:87], v4 offset:8448
  v_mfma_f32_16x16x32_bf16 v[36:39], v[96:99], v[52:55], 0
  ds_read_b128 v[88:91], v4 offset:8704
  v_mfma_f32_16x16x32_bf16 v[40:43], v[96:99], v[56:59], 0
  ds_read_b128 v[92:95], v4 offset:8960
  v_mfma_f32_16x16x32_bf16 v[44:47], v[96:99], v[60:63], 0
  s_add_u32 s59, s30, 1024
  buffer_load_dwordx4 v[176:179], v9, s[36:39], s59 offen
  s_waitcnt vmcnt(27) lgkmcnt(4)
  v_mfma_f32_16x16x32_bf16 v[32:35], v[100:103], v[64:67], v[32:35]
  ds_read_b128 v[48:51], v4 offset:12288
  ds_read_b128 v[52:55], v4 offset:12544
  v_mfma_f32_16x16x32_bf16 v[36:39], v[100:103], v[68:71], v[36:39]
  ds_read_b128 v[56:59], v4 offset:12800
  v_mfma_f32_16x16x32_bf16 v[40:43], v[100:103], v[72:75], v[40:43]
  ds_read_b128 v[60:63], v4 offset:13056
  v_mfma_f32_16x16x32_bf16 v[44:47], v[100:103], v[76:79], v[44:47]
  s_add_u32 s59, s30, 1152
  buffer_load_dwordx4 v[180:183], v9, s[36:39], s59 offen
  s_waitcnt vmcnt(27) lgkmcnt(4)
  v_mfma_f32_16x16x32_bf16 v[32:35], v[104:107], v[80:83], v[32:35]
  ds_read_b128 v[64:67], v4 offset:16384
  v_mfma_f32_16x16x32_bf16 v[36:39], v[104:107], v[84:87], v[36:39]
  ds_read_b128 v[68:71], v4 offset:16640
  v_mfma_f32_16x16x32_bf16 v[40:43], v[104:107], v[88:91], v[40:43]
  ds_read_b128 v[72:75], v4 offset:16896
  v_mfma_f32_16x16x32_bf16 v[44:47], v[104:107], v[92:95], v[44:47]
  ds_read_b128 v[76:79], v4 offset:17152
  s_waitcnt vmcnt(26) lgkmcnt(4)
  v_mfma_f32_16x16x32_bf16 v[32:35], v[108:111], v[48:51], v[32:35]
  ds_read_b128 v[80:83], v4 offset:20480
  ds_read_b128 v[84:87], v4 offset:20736
  v_mfma_f32_16x16x32_bf16 v[36:39], v[108:111], v[52:55], v[36:39]
  ds_read_b128 v[88:91], v4 offset:20992
  v_mfma_f32_16x16x32_bf16 v[40:43], v[108:111], v[56:59], v[40:43]
  ds_read_b128 v[92:95], v4 offset:21248
  v_mfma_f32_16x16x32_bf16 v[44:47], v[108:111], v[60:63], v[44:47]
  s_add_u32 s59, s30, 1280
  buffer_load_dwordx4 v[184:187], v9, s[36:39], s59 offen
  s_waitcnt vmcnt(26) lgkmcnt(4)
  v_mfma_f32_16x16x32_bf16 v[32:35], v[112:115], v[64:67], v[32:35]
  ds_read_b128 v[48:51], v4 offset:24576
  v_mfma_f32_16x16x32_bf16 v[36:39], v[112:115], v[68:71], v[36:39]
  ds_read_b128 v[52:55], v4 offset:24832
  v_mfma_f32_16x16x32_bf16 v[40:43], v[112:115], v[72:75], v[40:43]
  ds_read_b128 v[56:59], v4 offset:25088
  v_mfma_f32_16x16x32_bf16 v[44:47], v[112:115], v[76:79], v[44:47]
  ds_read_b128 v[60:63], v4 offset:25344
  s_waitcnt vmcnt(25) lgkmcnt(4)
  v_mfma_f32_16x16x32_bf16 v[32:35], v[116:119], v[80:83], v[32:35]
  ds_read_b128 v[64:67], v4 offset:28672
  ds_read_b128 v[68:71], v4 offset:28928
  v_mfma_f32_16x16x32_bf16 v[36:39], v[116:119], v[84:87], v[36:39]
  ds_read_b128 v[72:75], v4 offset:29184
  v_mfma_f32_16x16x32_bf16 v[40:43], v[116:119], v[88:91], v[40:43]
  ds_read_b128 v[76:79], v4 offset:29440
  v_mfma_f32_16x16x32_bf16 v[44:47], v[116:119], v[92:95], v[44:47]
  s_add_u32 s59, s30, 1408
  buffer_load_dwordx4 v[188:191], v9, s[36:39], s59 offen
  s_waitcnt vmcnt(25) lgkmcnt(4)
  v_mfma_f32_16x16x32_bf16 v[32:35], v[120:123], v[48:51], v[32:35]
  ds_read_b128 v[80:83], v4 offset:32768
  ds_read_b128 v[84:87], v4 offset:33024
  v_mfma_f32_16x16x32_bf16 v[36:39], v[120:123], v[52:55], v[36:39]
  ds_read_b128 v[88:91], v4 offset:33280
  v_mfma_f32_16x16x32_bf16 v[40:43], v[120:123], v[56:59], v[40:43]
  ds_read_b128 v[92:95], v4 offset:33536
  v_mfma_f32_16x16x32_bf16 v[44:47], v[120:123], v[60:63], v[44:47]
  s_add_u32 s59, s30, 1536
  buffer_load_dwordx4 v[192:195], v9, s[36:39], s59 offen
  s_waitcnt vmcnt(25) lgkmcnt(4)
  v_mfma_f32_16x16x32_bf16 v[32:35], v[124:127], v[64:67], v[32:35]
  ds_read_b128 v[48:51], v4 offset:36864
  v_mfma_f32_16x16x32_bf16 v[36:39], v[124:127], v[68:71], v[36:39]
  ds_read_b128 v[52:55], v4 offset:37120
  v_mfma_f32_16x16x32_bf16 v[40:43], v[124:127], v[72:75], v[40:43]
  ds_read_b128 v[56:59], v4 offset:37376
  v_mfma_f32_16x16x32_bf16 v[44:47], v[124:127], v[76:79], v[44:47]
  ds_read_b128 v[60:63], v4 offset:37632
  s_waitcnt vmcnt(24) lgkmcnt(4)
  v_mfma_f32_16x16x32_bf16 v[32:35], v[128:131], v[80:83], v[32:35]
  ds_read_b128 v[64:67], v4 offset:40960
  ds_read_b128 v[68:71], v4 offset:41216
  v_mfma_f32_16x16x32_bf16 v[36:39], v[128:131], v[84:87], v[36:39]
  ds_read_b128 v[72:75], v4 offset:41472
  v_mfma_f32_16x16x32_bf16 v[40:43], v[128:131], v[88:91], v[40:43]
  ds_read_b128 v[76:79], v4 offset:41728
  v_mfma_f32_16x16x32_bf16 v[44:47], v[128:131], v[92:95], v[44:47]
  s_add_u32 s59, s30, 1664
  buffer_load_dwordx4 v[196:199], v9, s[36:39], s59 offen
  s_waitcnt vmcnt(24) lgkmcnt(4)
  v_mfma_f32_16x16x32_bf16 v[32:35], v[132:135], v[48:51], v[32:35]
  ds_read_b128 v[80:83], v4 offset:45056
  v_mfma_f32_16x16x32_bf16 v[36:39], v[132:135], v[52:55], v[36:39]
  ds_read_b128 v[84:87], v4 offset:45312
  v_mfma_f32_16x16x32_bf16 v[40:43], v[132:135], v[56:59], v[40:43]
  ds_read_b128 v[88:91], v4 offset:45568
  v_mfma_f32_16x16x32_bf16 v[44:47], v[132:135], v[60:63], v[44:47]
  ds_read_b128 v[92:95], v4 offset:45824
  s_waitcnt vmcnt(23) lgkmcnt(4)
  v_mfma_f32_16x16x32_bf16 v[32:35], v[136:139], v[64:67], v[32:35]
  ds_read_b128 v[48:51], v4 offset:49152
  ds_read_b128 v[52:55], v4 offset:49408
  v_mfma_f32_16x16x32_bf16 v[36:39], v[136:139], v[68:71], v[36:39]
  ds_read_b128 v[56:59], v4 offset:49664
  v_mfma_f32_16x16x32_bf16 v[40:43], v[136:139], v[72:75], v[40:43]
  ds_read_b128 v[60:63], v4 offset:49920
  v_mfma_f32_16x16x32_bf16 v[44:47], v[136:139], v[76:79], v[44:47]
  s_add_u32 s59, s30, 1792
  buffer_load_dwordx4 v[200:203], v9, s[36:39], s59 offen
  s_waitcnt vmcnt(23) lgkmcnt(4)
  v_mfma_f32_16x16x32_bf16 v[32:35], v[140:143], v[80:83], v[32:35]
  ds_read_b128 v[64:67], v4 offset:53248
  ds_read_b128 v[68:71], v4 offset:53504
  v_mfma_f32_16x16x32_bf16 v[36:39], v[140:143], v[84:87], v[36:39]
  ds_read_b128 v[72:75], v4 offset:53760
  v_mfma_f32_16x16x32_bf16 v[40:43], v[140:143], v[88:91], v[40:43]
  ds_read_b128 v[76:79], v4 offset:54016
  v_mfma_f32_16x16x32_bf16 v[44:47], v[140:143], v[92:95], v[44:47]
  s_add_u32 s59, s30, 1920
  buffer_load_dwordx4 v[204:207], v9, s[36:39], s59 offen
  s_waitcnt vmcnt(23) lgkmcnt(4)
  v_mfma_f32_16x16x32_bf16 v[32:35], v[144:147], v[48:51], v[32:35]
  ds_read_b128 v[80:83], v4 offset:57344
  v_mfma_f32_16x16x32_bf16 v[36:39], v[144:147], v[52:55], v[36:39]
  ds_read_b128 v[84:87], v4 offset:57600
  v_mfma_f32_16x16x32_bf16 v[40:43], v[144:147], v[56:59], v[40:43]
  ds_read_b128 v[88:91], v4 offset:57856
  v_mfma_f32_16x16x32_bf16 v[44:47], v[144:147], v[60:63], v[44:47]
  ds_read_b128 v[92:95], v4 offset:58112
  s_waitcnt vmcnt(22) lgkmcnt(4)
  v_mfma_f32_16x16x32_bf16 v[32:35], v[148:151], v[64:67], v[32:35]
  ds_read_b128 v[48:51], v4 offset:61440
  ds_read_b128 v[52:55], v4 offset:61696
  v_mfma_f32_16x16x32_bf16 v[36:39], v[148:151], v[68:71], v[36:39]
  ds_read_b128 v[56:59], v4 offset:61952
  v_mfma_f32_16x16x32_bf16 v[40:43], v[148:151], v[72:75], v[40:43]
  ds_read_b128 v[60:63], v4 offset:62208
  v_mfma_f32_16x16x32_bf16 v[44:47], v[148:151], v[76:79], v[44:47]
  s_add_u32 s59, s30, 2048
  buffer_load_dwordx4 v[208:211], v9, s[36:39], s59 offen
  s_waitcnt vmcnt(22) lgkmcnt(4)
  v_mfma_f32_16x16x32_bf16 v[32:35], v[152:155], v[80:83], v[32:35]
  ds_read_b128 v[64:67], v5 offset:0
  v_mfma_f32_16x16x32_bf16 v[36:39], v[152:155], v[84:87], v[36:39]
  ds_read_b128 v[68:71], v5 offset:256
  v_mfma_f32_16x16x32_bf16 v[40:43], v[152:155], v[88:91], v[40:43]
  ds_read_b128 v[72:75], v5 offset:512
  v_mfma_f32_16x16x32_bf16 v[44:47], v[152:155], v[92:95], v[44:47]
  ds_read_b128 v[76:79], v5 offset:768
  s_waitcnt vmcnt(21) lgkmcnt(4)
  v_mfma_f32_16x16x32_bf16 v[32:35], v[156:159], v[48:51], v[32:35]
  ds_read_b128 v[80:83], v5 offset:4096
  ds_read_b128 v[84:87], v5 offset:4352
  v_mfma_f32_16x16x32_bf16 v[36:39], v[156:159], v[52:55], v[36:39]
  ds_read_b128 v[88:91], v5 offset:4608
  v_mfma_f32_16x16x32_bf16 v[40:43], v[156:159], v[56:59], v[40:43]
  ds_read_b128 v[92:95], v5 offset:4864
  v_mfma_f32_16x16x32_bf16 v[44:47], v[156:159], v[60:63], v[44:47]
  s_add_u32 s59, s30, 2176
  buffer_load_dwordx4 v[212:215], v9, s[36:39], s59 offen
  s_waitcnt vmcnt(21) lgkmcnt(4)
  v_mfma_f32_16x16x32_bf16 v[32:35], v[160:163], v[64:67], v[32:35]
  ds_read_b128 v[48:51], v5 offset:8192
  ds_read_b128 v[52:55], v5 offset:8448
  v_mfma_f32_16x16x32_bf16 v[36:39], v[160:163], v[68:71], v[36:39]
  ds_read_b128 v[56:59], v5 offset:8704
  v_mfma_f32_16x16x32_bf16 v[40:43], v[160:163], v[72:75], v[40:43]
  ds_read_b128 v[60:63], v5 offset:8960
  v_mfma_f32_16x16x32_bf16 v[44:47], v[160:163], v[76:79], v[44:47]
  s_add_u32 s59, s30, 2304
  buffer_load_dwordx4 v[216:219], v9, s[36:39], s59 offen
  s_waitcnt vmcnt(21) lgkmcnt(4)
  v_mfma_f32_16x16x32_bf16 v[32:35], v[164:167], v[80:83], v[32:35]
  ds_read_b128 v[64:67], v5 offset:12288
  v_mfma_f32_16x16x32_bf16 v[36:39], v[164:167], v[84:87], v[36:39]
  ds_read_b128 v[68:71], v5 offset:12544
  v_mfma_f32_16x16x32_bf16 v[40:43], v[164:167], v[88:91], v[40:43]
  ds_read_b128 v[72:75], v5 offset:12800
  v_mfma_f32_16x16x32_bf16 v[44:47], v[164:167], v[92:95], v[44:47]
  ds_read_b128 v[76:79], v5 offset:13056
  s_waitcnt vmcnt(20) lgkmcnt(4)
  v_mfma_f32_16x16x32_bf16 v[32:35], v[168:171], v[48:51], v[32:35]
  s_add_u32 s59, s30, 2432
  buffer_load_dwordx4 v[220:223], v9, s[36:39], s59 offen
  v_mfma_f32_16x16x32_bf16 v[36:39], v[168:171], v[52:55], v[36:39]
  v_mfma_f32_16x16x32_bf16 v[40:43], v[168:171], v[56:59], v[40:43]
  v_mfma_f32_16x16x32_bf16 v[44:47], v[168:171], v[60:63], v[44:47]
  s_waitcnt vmcnt(20) lgkmcnt(0)
  v_mfma_f32_16x16x32_bf16 v[32:35], v[172:175], v[64:67], v[32:35]
  v_mfma_f32_16x16x32_bf16 v[36:39], v[172:175], v[68:71], v[36:39]
  v_mfma_f32_16x16x32_bf16 v[40:43], v[172:175], v[72:75], v[40:43]
  v_mfma_f32_16x16x32_bf16 v[44:47], v[172:175], v[76:79], v[44:47]
  s_cmp_lt_u32 s46, 0
  s_cbranch_scc0 L_w_113
  v_add_u32 v10, 96768, v7
  ds_read_b64 v[80:81], v10 offset:0
  ds_read_b64 v[82:83], v10 offset:128
  ds_read_b64 v[84:85], v10 offset:256
  ds_read_b64 v[86:87], v10 offset:384
  ds_read_b128 v[48:51], v6 offset:0
  ds_read_b128 v[52:55], v6 offset:64
  ds_read_b128 v[56:59], v6 offset:128
  ds_read_b128 v[60:63], v6 offset:192
  s_waitcnt lgkmcnt(3)
  v_mfma_f32_16x16x32_bf16 v[12:15], v[96:99], v[48:51], 0
  s_waitcnt lgkmcnt(2)
  v_mfma_f32_16x16x32_bf16 v[12:15], v[100:103], v[52:55], v[12:15]
  s_waitcnt lgkmcnt(1)
  v_mfma_f32_16x16x32_bf16 v[12:15], v[104:107], v[56:59], v[12:15]
  s_waitcnt lgkmcnt(0)
  v_mfma_f32_16x16x32_bf16 v[12:15], v[108:111], v[60:63], v[12:15]
  ds_read_b128 v[48:51], v6 offset:256
  ds_read_b128 v[52:55], v6 offset:320
  ds_read_b128 v[56:59], v6 offset:384
  ds_read_b128 v[60:63], v6 offset:448
  s_waitcnt lgkmcnt(3)
  v_mfma_f32_16x16x32_bf16 v[12:15], v[112:115], v[48:51], v[12:15]
  s_waitcnt lgkmcnt(2)
  v_mfma_f32_16x16x32_bf16 v[12:15], v[116:119], v[52:55], v[12:15]
  s_waitcnt lgkmcnt(1)
  v_mfma_f32_16x16x32_bf16 v[12:15], v[120:123], v[56:59], v[12:15]
  s_waitcnt lgkmcnt(0)
  v_mfma_f32_16x16x32_bf16 v[12:15], v[124:127], v[60:63], v[12:15]
  ds_read_b128 v[48:51], v6 offset:512
  ds_read_b128 v[52:55], v6 offset:576
  ds_read_b128 v[56:59], v6 offset:640
  ds_read_b128 v[60:63], v6 offset:704
  s_waitcnt lgkmcnt(3)
  v_mfma_f32_16x16x32_bf16 v[12:15], v[128:131], v[48:51], v[12:15]
  s_waitcnt lgkmcnt(2)
  v_mfma_f32_16x16x32_bf16 v[12:15], v[132:135], v[52:55], v[12:15]
  s_waitcnt lgkmcnt(1)
  v_mfma_f32_16x16x32_bf16 v[12:15], v[136:139], v[56:59], v[12:15]
  s_waitcnt lgkmcnt(0)
  v_mfma_f32_16x16x32_bf16 v[12:15], v[140:143], v[60:63], v[12:15]
  ds_read_b128 v[48:51], v6 offset:768
  ds_read_b128 v[52:55], v6 offset:832
  ds_read_b128 v[56:59], v6 offset:896
  ds_read_b128 v[60:63], v6 offset:960
  s_waitcnt lgkmcnt(3)
  v_mfma_f32_16x16x32_bf16 v[12:15], v[144:147], v[48:51], v[12:15]
  s_waitcnt lgkmcnt(2)
  v_mfma_f32_16x16x32_bf16 v[12:15], v[148:151], v[52:55], v[12:15]
  s_waitcnt lgkmcnt(1)
  v_mfma_f32_16x16x32_bf16 v[12:15], v[152:155], v[56:59], v[12:15]
  s_waitcnt lgkmcnt(0)
  v_mfma_f32_16x16x32_bf16 v[12:15], v[156:159], v[60:63], v[12:15]
  ds_read_b128 v[48:51], v6 offset:1024
  ds_read_b128 v[52:55], v6 offset:1088
  ds_read_b128 v[56:59], v6 offset:1152
  ds_read_b128 v[60:63], v6 offset:1216
  s_waitcnt lgkmcnt(3)
  v_mfma_f32_16x16x32_bf16 v[12:15], v[160:163], v[48:51], v[12:15]
  s_waitcnt lgkmcnt(2)
  v_mfma_f32_16x16x32_bf16 v[12:15], v[164:167], v[52:55], v[12:15]
  s_waitcnt lgkmcnt(1)
  v_mfma_f32_16x16x32_bf16 v[12:15], v[168:171], v[56:59], v[12:15]
  s_waitcnt lgkmcnt(0)
  v_mfma_f32_16x16x32_bf16 v[12:15], v[172:175], v[60:63], v[12:15]
  s_nop 7
  v_mov_b32_dpp v246, v12 row_newbcast:0 row_mask:0xf bank_mask:0xf
  v_mov_b32_dpp v250, v12 row_newbcast:1 row_mask:0xf bank_mask:0xf
  v_mov_b32_dpp v247, v13 row_newbcast:0 row_mask:0xf bank_mask:0xf
  v_mov_b32_dpp v251, v13 row_newbcast:1 row_mask:0xf bank_mask:0xf
  v_mov_b32_dpp v248, v14 row_newbcast:0 row_mask:0xf bank_mask:0xf
  v_mov_b32_dpp v252, v14 row_newbcast:1 row_mask:0xf bank_mask:0xf
  v_mov_b32_dpp v249, v15 row_newbcast:0 row_mask:0xf bank_mask:0xf
  v_mov_b32_dpp v253, v15 row_newbcast:1 row_mask:0xf bank_mask:0xf
  v_fma_f32 v48, -v81, v246, v250
  v_fma_f32 v49, -v81, v247, v251
  v_fma_f32 v50, -v81, v248, v252
  v_fma_f32 v51, -v81, v249, v253
  v_fma_f32 v52, -v83, v246, v250
  v_fma_f32 v53, -v83, v247, v251
  v_fma_f32 v54, -v83, v248, v252
  v_fma_f32 v55, -v83, v249, v253
  v_fma_f32 v56, -v85, v246, v250
  v_fma_f32 v57, -v85, v247, v251
  v_fma_f32 v58, -v85, v248, v252
  v_fma_f32 v59, -v85, v249, v253
  v_fma_f32 v60, -v87, v246, v250
  v_fma_f32 v61, -v87, v247, v251
  v_fma_f32 v62, -v87, v248, v252
  v_fma_f32 v63, -v87, v249, v253
  v_fma_f32 v32, v32, v80, v48
  v_fma_f32 v33, v33, v80, v49
  v_fma_f32 v34, v34, v80, v50
  v_fma_f32 v35, v35, v80, v51
  v_fma_f32 v36, v36, v82, v52
  v_fma_f32 v37, v37, v82, v53
  v_fma_f32 v38, v38, v82, v54
  v_fma_f32 v39, v39, v82, v55
  v_fma_f32 v40, v40, v84, v56
  v_fma_f32 v41, v41, v84, v57
  v_fma_f32 v42, v42, v84, v58
  v_fma_f32 v43, v43, v84, v59
  v_fma_f32 v44, v44, v86, v60
  v_fma_f32 v45, v45, v86, v61
  v_fma_f32 v46, v46, v86, v62
  v_fma_f32 v47, v47, v86, v63
  v_mov_b32 v64, 0xc0135761
  v_mul_f32 v48, v32, v32
  v_mul_f32 v49, v33, v33
  v_mul_f32 v50, v34, v34
  v_mul_f32 v51, v35, v35
  v_mul_f32 v52, v36, v36
  v_mul_f32 v53, v37, v37
  v_mul_f32 v54, v38, v38
  v_mul_f32 v55, v39, v39
  v_mul_f32 v56, v40, v40
  v_mul_f32 v57, v41, v41
  v_mul_f32 v58, v42, v42
  v_mul_f32 v59, v43, v43
  v_mul_f32 v60, v44, v44
  v_mul_f32 v61, v45, v45
  v_mul_f32 v62, v46, v46
  v_mul_f32 v63, v47, v47
  v_fmamk_f32 v48, v48, 0xbdd2d3e8, v64
  v_fmamk_f32 v49, v49, 0xbdd2d3e8, v64
  v_fmamk_f32 v50, v50, 0xbdd2d3e8, v64
  v_fmamk_f32 v51, v51, 0xbdd2d3e8, v64
  v_fmamk_f32 v52, v52, 0xbdd2d3e8, v64
  v_fmamk_f32 v53, v53, 0xbdd2d3e8, v64
  v_fmamk_f32 v54, v54, 0xbdd2d3e8, v64
  v_fmamk_f32 v55, v55, 0xbdd2d3e8, v64
  v_fmamk_f32 v56, v56, 0xbdd2d3e8, v64
  v_fmamk_f32 v57, v57, 0xbdd2d3e8, v64
  v_fmamk_f32 v58, v58, 0xbdd2d3e8, v64
  v_fmamk_f32 v59, v59, 0xbdd2d3e8, v64
  v_fmamk_f32 v60, v60, 0xbdd2d3e8, v64
  v_fmamk_f32 v61, v61, 0xbdd2d3e8, v64
  v_fmamk_f32 v62, v62, 0xbdd2d3e8, v64
  v_fmamk_f32 v63, v63, 0xbdd2d3e8, v64
  v_mul_f32 v48, v48, v32
  v_mul_f32 v49, v49, v33
  v_mul_f32 v50, v50, v34
  v_mul_f32 v51, v51, v35
  v_mul_f32 v52, v52, v36
  v_mul_f32 v53, v53, v37
  v_mul_f32 v54, v54, v38
  v_mul_f32 v55, v55, v39
  v_mul_f32 v56, v56, v40
  v_mul_f32 v57, v57, v41
  v_mul_f32 v58, v58, v42
  v_mul_f32 v59, v59, v43
  v_mul_f32 v60, v60, v44
  v_mul_f32 v61, v61, v45
  v_mul_f32 v62, v62, v46
  v_mul_f32 v63, v63, v47
  v_exp_f32 v48, v48
  v_exp_f32 v49, v49
  v_exp_f32 v50, v50
  v_exp_f32 v51, v51
  v_exp_f32 v52, v52
  v_exp_f32 v53, v53
  v_exp_f32 v54, v54
  v_exp_f32 v55, v55
  v_exp_f32 v56, v56
  v_exp_f32 v57, v57
  v_exp_f32 v58, v58
  v_exp_f32 v59, v59
  v_exp_f32 v60, v60
  v_exp_f32 v61, v61
  v_exp_f32 v62, v62
  v_exp_f32 v63, v63
  v_add_f32 v48, 1.0, v48
  v_add_f32 v49, 1.0, v49
  v_add_f32 v50, 1.0, v50
  v_add_f32 v51, 1.0, v51
  v_add_f32 v52, 1.0, v52
  v_add_f32 v53, 1.0, v53
  v_add_f32 v54, 1.0, v54
  v_add_f32 v55, 1.0, v55
  v_add_f32 v56, 1.0, v56
  v_add_f32 v57, 1.0, v57
  v_add_f32 v58, 1.0, v58
  v_add_f32 v59, 1.0, v59
  v_add_f32 v60, 1.0, v60
  v_add_f32 v61, 1.0, v61
  v_add_f32 v62, 1.0, v62
  v_add_f32 v63, 1.0, v63
  v_rcp_f32 v48, v48
  v_rcp_f32 v49, v49
  v_rcp_f32 v50, v50
  v_rcp_f32 v51, v51
  v_rcp_f32 v52, v52
  v_rcp_f32 v53, v53
  v_rcp_f32 v54, v54
  v_rcp_f32 v55, v55
  v_rcp_f32 v56, v56
  v_rcp_f32 v57, v57
  v_rcp_f32 v58, v58
  v_rcp_f32 v59, v59
  v_rcp_f32 v60, v60
  v_rcp_f32 v61, v61
  v_rcp_f32 v62, v62
  v_rcp_f32 v63, v63
  v_mul_f32 v32, v32, v48
  v_mul_f32 v33, v33, v49
  v_mul_f32 v34, v34, v50
  v_mul_f32 v35, v35, v51
  v_mul_f32 v36, v36, v52
  v_mul_f32 v37, v37, v53
  v_mul_f32 v38, v38, v54
  v_mul_f32 v39, v39, v55
  v_mul_f32 v40, v40, v56
  v_mul_f32 v41, v41, v57
  v_mul_f32 v42, v42, v58
  v_mul_f32 v43, v43, v59
  v_mul_f32 v44, v44, v60
  v_mul_f32 v45, v45, v61
  v_mul_f32 v46, v46, v62
  v_mul_f32 v47, v47, v63
  v_cvt_pk_bf16_f32 v246, v32, v33
  v_cvt_pk_bf16_f32 v247, v34, v35
  v_cvt_pk_bf16_f32 v248, v36, v37
  v_cvt_pk_bf16_f32 v249, v38, v39
  v_cvt_pk_bf16_f32 v250, v40, v41
  v_cvt_pk_bf16_f32 v251, v42, v43
  v_cvt_pk_bf16_f32 v252, v44, v45
  v_cvt_pk_bf16_f32 v253, v46, v47
L_w_113:
  s_barrier
  s_add_u32 s59, s30, 2560
  buffer_load_dwordx4 v[224:227], v9, s[36:39], s59 offen
  s_add_u32 s59, s30, 2688
  buffer_load_dwordx4 v[228:231], v9, s[36:39], s59 offen
  s_add_u32 s59, s30, 2816
  buffer_load_dwordx4 v[232:235], v9, s[36:39], s59 offen
  s_add_u32 s59, s30, 2944
  buffer_load_dwordx4 v[236:239], v9, s[36:39], s59 offen
  v_add_u32 v57, 96256, v7
  ds_read_b64 v[48:49], v57 offset:0
  ds_read_b64 v[50:51], v57 offset:128
  ds_read_b64 v[52:53], v57 offset:256
  ds_read_b64 v[54:55], v57 offset:384
  v_add_u32 v57, 96768, v7
  ds_read_b64 v[80:81], v57 offset:0
  ds_read_b64 v[82:83], v57 offset:128
  ds_read_b64 v[84:85], v57 offset:256
  ds_read_b64 v[86:87], v57 offset:384
  v_lshrrev_b32 v58, 4, v1
  v_lshlrev_b32 v58, 3, v58
  v_lshl_add_u32 v58, v7, 2, v58
  s_lshl_b32 s51, s46, 11
  v_add_u32 v58, s51, v58
  v_lshrrev_b32 v60, 4, v1
  v_bfe_u32 v61, v1, 2, 2
  v_lshl_add_u32 v60, v60, 3, v61
  v_mul_u32_u24 v60, 32, v60
  v_and_b32 v61, 3, v1
  v_lshl_add_u32 v59, v61, 3, v60
  v_add_u32 v59, s51, v59
  s_mul_i32 s52, s45, 64
  s_lshl_b32 s53, s44, 1
  s_add_u32 s52, s52, s53
  s_mul_i32 s52, s52, 7168
  s_add_u32 s52, s52, 19398656
  s_add_u32 s53, s52, 7168
  s_waitcnt lgkmcnt(7)
  v_fma_f32 v16, v16, v48, -v49
  v_fma_f32 v17, v17, v48, -v49
  v_fma_f32 v18, v18, v48, -v49
  v_fma_f32 v19, v19, v48, -v49
  v_cvt_pk_bf16_f32 v16, v16, v17
  v_cvt_pk_bf16_f32 v17, v18, v19
  ds_write_b64 v58, v[16:17] offset:0
  s_waitcnt lgkmcnt(7)
  v_fma_f32 v20, v20, v50, -v51
  v_fma_f32 v21, v21, v50, -v51
  v_fma_f32 v22, v22, v50, -v51
  v_fma_f32 v23, v23, v50, -v51
  v_cvt_pk_bf16_f32 v20, v20, v21
  v_cvt_pk_bf16_f32 v21, v22, v23
  ds_write_b64 v58, v[20:21] offset:512
  s_waitcnt lgkmcnt(7)
  v_fma_f32 v24, v24, v52, -v53
  v_fma_f32 v25, v25, v52, -v53
  v_fma_f32 v26, v26, v52, -v53
  v_fma_f32 v27, v27, v52, -v53
  v_cvt_pk_bf16_f32 v24, v24, v25
  v_cvt_pk_bf16_f32 v25, v26, v27
  ds_write_b64 v58, v[24:25] offset:1024
  s_waitcnt lgkmcnt(7)
  v_fma_f32 v28, v28, v54, -v55
  v_fma_f32 v29, v29, v54, -v55
  v_fma_f32 v30, v30, v54, -v55
  v_fma_f32 v31, v31, v54, -v55
  v_cvt_pk_bf16_f32 v28, v28, v29
  v_cvt_pk_bf16_f32 v29, v30, v31
  ds_write_b64 v58, v[28:29] offset:1536
  s_waitcnt lgkmcnt(0)
  ds_read_b64_tr_b16 v[64:65], v59 offset:0
  ds_read_b64_tr_b16 v[66:67], v59 offset:128
  ds_read_b64_tr_b16 v[68:69], v59 offset:1024
  ds_read_b64_tr_b16 v[70:71], v59 offset:1152
  s_waitcnt lgkmcnt(2)
  buffer_store_dwordx4 v[64:67], v8, s[32:35], s52 offen sc1
  s_waitcnt lgkmcnt(0)
  buffer_store_dwordx4 v[68:71], v8, s[32:35], s53 offen sc1
  s_cmp_ge_u32 s46, 0
  s_cbranch_scc0 L_w_114
  ds_read_b128 v[48:51], v6 offset:0
  ds_read_b128 v[52:55], v6 offset:64
  ds_read_b128 v[56:59], v6 offset:128
  ds_read_b128 v[60:63], v6 offset:192
  s_waitcnt lgkmcnt(3)
  v_mfma_f32_16x16x32_bf16 v[12:15], v[96:99], v[48:51], 0
  s_waitcnt lgkmcnt(2)
  v_mfma_f32_16x16x32_bf16 v[12:15], v[100:103], v[52:55], v[12:15]
  s_waitcnt lgkmcnt(1)
  v_mfma_f32_16x16x32_bf16 v[12:15], v[104:107], v[56:59], v[12:15]
  s_waitcnt lgkmcnt(0)
  v_mfma_f32_16x16x32_bf16 v[12:15], v[108:111], v[60:63], v[12:15]
  ds_read_b128 v[48:51], v6 offset:256
  ds_read_b128 v[52:55], v6 offset:320
  ds_read_b128 v[56:59], v6 offset:384
  ds_read_b128 v[60:63], v6 offset:448
  s_waitcnt lgkmcnt(3)
  v_mfma_f32_16x16x32_bf16 v[12:15], v[112:115], v[48:51], v[12:15]
  s_waitcnt lgkmcnt(2)
  v_mfma_f32_16x16x32_bf16 v[12:15], v[116:119], v[52:55], v[12:15]
  s_waitcnt lgkmcnt(1)
  v_mfma_f32_16x16x32_bf16 v[12:15], v[120:123], v[56:59], v[12:15]
  s_waitcnt lgkmcnt(0)
  v_mfma_f32_16x16x32_bf16 v[12:15], v[124:127], v[60:63], v[12:15]
  ds_read_b128 v[48:51], v6 offset:512
  ds_read_b128 v[52:55], v6 offset:576
  ds_read_b128 v[56:59], v6 offset:640
  ds_read_b128 v[60:63], v6 offset:704
  s_waitcnt lgkmcnt(3)
  v_mfma_f32_16x16x32_bf16 v[12:15], v[128:131], v[48:51], v[12:15]
  s_waitcnt lgkmcnt(2)
  v_mfma_f32_16x16x32_bf16 v[12:15], v[132:135], v[52:55], v[12:15]
  s_waitcnt lgkmcnt(1)
  v_mfma_f32_16x16x32_bf16 v[12:15], v[136:139], v[56:59], v[12:15]
  s_waitcnt lgkmcnt(0)
  v_mfma_f32_16x16x32_bf16 v[12:15], v[140:143], v[60:63], v[12:15]
  ds_read_b128 v[48:51], v6 offset:768
  ds_read_b128 v[52:55], v6 offset:832
  ds_read_b128 v[56:59], v6 offset:896
  ds_read_b128 v[60:63], v6 offset:960
  s_waitcnt lgkmcnt(3)
  v_mfma_f32_16x16x32_bf16 v[12:15], v[144:147], v[48:51], v[12:15]
  s_waitcnt lgkmcnt(2)
  v_mfma_f32_16x16x32_bf16 v[12:15], v[148:151], v[52:55], v[12:15]
  s_waitcnt lgkmcnt(1)
  v_mfma_f32_16x16x32_bf16 v[12:15], v[152:155], v[56:59], v[12:15]
  s_waitcnt lgkmcnt(0)
  v_mfma_f32_16x16x32_bf16 v[12:15], v[156:159], v[60:63], v[12:15]
  ds_read_b128 v[48:51], v6 offset:1024
  ds_read_b128 v[52:55], v6 offset:1088
  ds_read_b128 v[56:59], v6 offset:1152
  ds_read_b128 v[60:63], v6 offset:1216
  s_waitcnt lgkmcnt(3)
  v_mfma_f32_16x16x32_bf16 v[12:15], v[160:163], v[48:51], v[12:15]
  s_waitcnt lgkmcnt(2)
  v_mfma_f32_16x16x32_bf16 v[12:15], v[164:167], v[52:55], v[12:15]
  s_waitcnt lgkmcnt(1)
  v_mfma_f32_16x16x32_bf16 v[12:15], v[168:171], v[56:59], v[12:15]
  s_waitcnt lgkmcnt(0)
  v_mfma_f32_16x16x32_bf16 v[12:15], v[172:175], v[60:63], v[12:15]
L_w_114:
  s_waitcnt vmcnt(0)
  s_barrier
  s_add_u32 s59, s31, 98304
  v_add_u32 v10, s59, v2
  v_xor_b32 v11, 0x10000, v10
  s_add_u32 s59, s30, 3072
  buffer_load_dwordx4 v[124:127], v9, s[36:39], s59 offen
  ds_write_b128 v11, v[176:179] offset:0
  s_add_u32 s59, s30, 3200
  buffer_load_dwordx4 v[128:131], v9, s[36:39], s59 offen
  ds_write_b128 v11, v[180:183] offset:8192
  s_add_u32 s59, s30, 3328
  buffer_load_dwordx4 v[132:135], v9, s[36:39], s59 offen
  ds_write_b128 v11, v[184:187] offset:16384
  s_add_u32 s59, s30, 3456
  buffer_load_dwordx4 v[136:139], v9, s[36:39], s59 offen
  ds_write_b128 v11, v[188:191] offset:24576
  s_add_u32 s59, s30, 3584
  buffer_load_dwordx4 v[140:143], v9, s[36:39], s59 offen
  ds_write_b128 v11, v[192:195] offset:32768
  s_add_u32 s59, s30, 3712
  buffer_load_dwordx4 v[144:147], v9, s[36:39], s59 offen
  ds_write_b128 v11, v[196:199] offset:40960
  s_add_u32 s59, s30, 3840
  buffer_load_dwordx4 v[148:151], v9, s[36:39], s59 offen
  ds_write_b128 v11, v[200:203] offset:49152
  s_add_u32 s59, s30, 3968
  buffer_load_dwordx4 v[152:155], v9, s[36:39], s59 offen
  ds_write_b128 v11, v[204:207] offset:57344
  s_cmp_ge_u32 s46, 0
  s_cbranch_scc0 L_w_115
  v_mov_b32_dpp v246, v12 row_newbcast:0 row_mask:0xf bank_mask:0xf
  v_mov_b32_dpp v250, v12 row_newbcast:1 row_mask:0xf bank_mask:0xf
  v_mov_b32_dpp v247, v13 row_newbcast:0 row_mask:0xf bank_mask:0xf
  v_mov_b32_dpp v251, v13 row_newbcast:1 row_mask:0xf bank_mask:0xf
  v_mov_b32_dpp v248, v14 row_newbcast:0 row_mask:0xf bank_mask:0xf
  v_mov_b32_dpp v252, v14 row_newbcast:1 row_mask:0xf bank_mask:0xf
  v_mov_b32_dpp v249, v15 row_newbcast:0 row_mask:0xf bank_mask:0xf
  v_mov_b32_dpp v253, v15 row_newbcast:1 row_mask:0xf bank_mask:0xf
  v_fma_f32 v48, -v81, v246, v250
  v_fma_f32 v49, -v81, v247, v251
  v_fma_f32 v50, -v81, v248, v252
  v_fma_f32 v51, -v81, v249, v253
  v_fma_f32 v52, -v83, v246, v250
  v_fma_f32 v53, -v83, v247, v251
  v_fma_f32 v54, -v83, v248, v252
  v_fma_f32 v55, -v83, v249, v253
  v_fma_f32 v56, -v85, v246, v250
  v_fma_f32 v57, -v85, v247, v251
  v_fma_f32 v58, -v85, v248, v252
  v_fma_f32 v59, -v85, v249, v253
  v_fma_f32 v60, -v87, v246, v250
  v_fma_f32 v61, -v87, v247, v251
  v_fma_f32 v62, -v87, v248, v252
  v_fma_f32 v63, -v87, v249, v253
  v_fma_f32 v32, v32, v80, v48
  v_fma_f32 v33, v33, v80, v49
  v_fma_f32 v34, v34, v80, v50
  v_fma_f32 v35, v35, v80, v51
  v_fma_f32 v36, v36, v82, v52
  v_fma_f32 v37, v37, v82, v53
  v_fma_f32 v38, v38, v82, v54
  v_fma_f32 v39, v39, v82, v55
  v_fma_f32 v40, v40, v84, v56
  v_fma_f32 v41, v41, v84, v57
  v_fma_f32 v42, v42, v84, v58
  v_fma_f32 v43, v43, v84, v59
  v_fma_f32 v44, v44, v86, v60
  v_fma_f32 v45, v45, v86, v61
  v_fma_f32 v46, v46, v86, v62
  v_fma_f32 v47, v47, v86, v63
  v_mov_b32 v64, 0xc0135761
  v_mul_f32 v48, v32, v32
  v_mul_f32 v49, v33, v33
  v_mul_f32 v50, v34, v34
  v_mul_f32 v51, v35, v35
  v_mul_f32 v52, v36, v36
  v_mul_f32 v53, v37, v37
  v_mul_f32 v54, v38, v38
  v_mul_f32 v55, v39, v39
  v_mul_f32 v56, v40, v40
  v_mul_f32 v57, v41, v41
  v_mul_f32 v58, v42, v42
  v_mul_f32 v59, v43, v43
  v_mul_f32 v60, v44, v44
  v_mul_f32 v61, v45, v45
  v_mul_f32 v62, v46, v46
  v_mul_f32 v63, v47, v47
  v_fmamk_f32 v48, v48, 0xbdd2d3e8, v64
  v_fmamk_f32 v49, v49, 0xbdd2d3e8, v64
  v_fmamk_f32 v50, v50, 0xbdd2d3e8, v64
  v_fmamk_f32 v51, v51, 0xbdd2d3e8, v64
  v_fmamk_f32 v52, v52, 0xbdd2d3e8, v64
  v_fmamk_f32 v53, v53, 0xbdd2d3e8, v64
  v_fmamk_f32 v54, v54, 0xbdd2d3e8, v64
  v_fmamk_f32 v55, v55, 0xbdd2d3e8, v64
  v_fmamk_f32 v56, v56, 0xbdd2d3e8, v64
  v_fmamk_f32 v57, v57, 0xbdd2d3e8, v64
  v_fmamk_f32 v58, v58, 0xbdd2d3e8, v64
  v_fmamk_f32 v59, v59, 0xbdd2d3e8, v64
  v_fmamk_f32 v60, v60, 0xbdd2d3e8, v64
  v_fmamk_f32 v61, v61, 0xbdd2d3e8, v64
  v_fmamk_f32 v62, v62, 0xbdd2d3e8, v64
  v_fmamk_f32 v63, v63, 0xbdd2d3e8, v64
  v_mul_f32 v48, v48, v32
  v_mul_f32 v49, v49, v33
  v_mul_f32 v50, v50, v34
  v_mul_f32 v51, v51, v35
  v_mul_f32 v52, v52, v36
  v_mul_f32 v53, v53, v37
  v_mul_f32 v54, v54, v38
  v_mul_f32 v55, v55, v39
  v_mul_f32 v56, v56, v40
  v_mul_f32 v57, v57, v41
  v_mul_f32 v58, v58, v42
  v_mul_f32 v59, v59, v43
  v_mul_f32 v60, v60, v44
  v_mul_f32 v61, v61, v45
  v_mul_f32 v62, v62, v46
  v_mul_f32 v63, v63, v47
  v_exp_f32 v48, v48
  v_exp_f32 v49, v49
  v_exp_f32 v50, v50
  v_exp_f32 v51, v51
  v_exp_f32 v52, v52
  v_exp_f32 v53, v53
  v_exp_f32 v54, v54
  v_exp_f32 v55, v55
  v_exp_f32 v56, v56
  v_exp_f32 v57, v57
  v_exp_f32 v58, v58
  v_exp_f32 v59, v59
  v_exp_f32 v60, v60
  v_exp_f32 v61, v61
  v_exp_f32 v62, v62
  v_exp_f32 v63, v63
  v_add_f32 v48, 1.0, v48
  v_add_f32 v49, 1.0, v49
  v_add_f32 v50, 1.0, v50
  v_add_f32 v51, 1.0, v51
  v_add_f32 v52, 1.0, v52
  v_add_f32 v53, 1.0, v53
  v_add_f32 v54, 1.0, v54
  v_add_f32 v55, 1.0, v55
  v_add_f32 v56, 1.0, v56
  v_add_f32 v57, 1.0, v57
  v_add_f32 v58, 1.0, v58
  v_add_f32 v59, 1.0, v59
  v_add_f32 v60, 1.0, v60
  v_add_f32 v61, 1.0, v61
  v_add_f32 v62, 1.0, v62
  v_add_f32 v63, 1.0, v63
  v_rcp_f32 v48, v48
  v_rcp_f32 v49, v49
  v_rcp_f32 v50, v50
  v_rcp_f32 v51, v51
  v_rcp_f32 v52, v52
  v_rcp_f32 v53, v53
  v_rcp_f32 v54, v54
  v_rcp_f32 v55, v55
  v_rcp_f32 v56, v56
  v_rcp_f32 v57, v57
  v_rcp_f32 v58, v58
  v_rcp_f32 v59, v59
  v_rcp_f32 v60, v60
  v_rcp_f32 v61, v61
  v_rcp_f32 v62, v62
  v_rcp_f32 v63, v63
  v_mul_f32 v32, v32, v48
  v_mul_f32 v33, v33, v49
  v_mul_f32 v34, v34, v50
  v_mul_f32 v35, v35, v51
  v_mul_f32 v36, v36, v52
  v_mul_f32 v37, v37, v53
  v_mul_f32 v38, v38, v54
  v_mul_f32 v39, v39, v55
  v_mul_f32 v40, v40, v56
  v_mul_f32 v41, v41, v57
  v_mul_f32 v42, v42, v58
  v_mul_f32 v43, v43, v59
  v_mul_f32 v44, v44, v60
  v_mul_f32 v45, v45, v61
  v_mul_f32 v46, v46, v62
  v_mul_f32 v47, v47, v63
  v_cvt_pk_bf16_f32 v246, v32, v33
  v_cvt_pk_bf16_f32 v247, v34, v35
  v_cvt_pk_bf16_f32 v248, v36, v37
  v_cvt_pk_bf16_f32 v249, v38, v39
  v_cvt_pk_bf16_f32 v250, v40, v41
  v_cvt_pk_bf16_f32 v251, v42, v43
  v_cvt_pk_bf16_f32 v252, v44, v45
  v_cvt_pk_bf16_f32 v253, v46, v47
L_w_115:
  s_branch L_join_110
L_svc_109:
  s_lshl_b32 s51, s44, 13
  s_add_u32 s51, s51, 262144
  s_add_u32 s52, s51, 4096
  buffer_load_dwordx4 v[16:19], v2, s[32:35], s51 offen offset:0 sc1
  buffer_load_dwordx4 v[20:23], v2, s[32:35], s51 offen offset:1024 sc1
  buffer_load_dwordx4 v[24:27], v2, s[32:35], s51 offen offset:2048 sc1
  buffer_load_dwordx4 v[28:31], v2, s[32:35], s51 offen offset:3072 sc1
  buffer_load_dwordx4 v[32:35], v2, s[32:35], s52 offen offset:0 sc1
  buffer_load_dwordx4 v[36:39], v2, s[32:35], s52 offen offset:1024 sc1
  buffer_load_dwordx4 v[40:43], v2, s[32:35], s52 offen offset:2048 sc1
  buffer_load_dwordx4 v[44:47], v2, s[32:35], s52 offen offset:3072 sc1
  v_bfe_u32 v52, v1, 3, 2
  v_and_b32 v53, 3, v1
  v_lshlrev_b32 v53, 5, v53
  v_lshl_add_u32 v52, v52, 7, v53
  v_add_u32 v52, 96768, v52
  s_waitcnt vmcnt(0)
  v_add_f32 v16, v16, v20
  v_add_f32 v17, v17, v21
  v_add_f32 v18, v18, v22
  v_add_f32 v19, v19, v23
  v_add_f32 v16, v16, v24
  v_add_f32 v17, v17, v25
  v_add_f32 v18, v18, v26
  v_add_f32 v19, v19, v27
  v_add_f32 v16, v16, v28
  v_add_f32 v17, v17, v29
  v_add_f32 v18, v18, v30
  v_add_f32 v19, v19, v31
  v_add_f32 v16, v16, v32
  v_add_f32 v17, v17, v33
  v_add_f32 v18, v18, v34
  v_add_f32 v19, v19, v35
  v_add_f32 v16, v16, v36
  v_add_f32 v17, v17, v37
  v_add_f32 v18, v18, v38
  v_add_f32 v19, v19, v39
  v_add_f32 v16, v16, v40
  v_add_f32 v17, v17, v41
  v_add_f32 v18, v18, v42
  v_add_f32 v19, v19, v43
  v_add_f32 v16, v16, v44
  v_add_f32 v17, v17, v45
  v_add_f32 v18, v18, v46
  v_add_f32 v19, v19, v47
  v_mov_b32 v20, v16
  v_mov_b32 v21, v17
  v_mov_b32 v22, v18
  v_mov_b32 v23, v19
  v_permlane32_swap_b32 v16, v20
  v_permlane32_swap_b32 v17, v21
  v_permlane32_swap_b32 v18, v22
  v_permlane32_swap_b32 v19, v23
  v_add_f32 v16, v16, v20
  v_add_f32 v17, v17, v21
  v_add_f32 v18, v18, v22
  v_add_f32 v19, v19, v23
  v_mul_f32 v16, 0x3acccccd, v16
  v_mul_f32 v17, 0x3acccccd, v17
  v_mul_f32 v18, 0x3acccccd, v18
  v_mul_f32 v19, 0x3acccccd, v19
  v_mov_b32_dpp v20, v16 row_shl:4 row_mask:0xf bank_mask:0xf
  v_mov_b32_dpp v21, v17 row_shl:4 row_mask:0xf bank_mask:0xf
  v_mov_b32_dpp v22, v18 row_shl:4 row_mask:0xf bank_mask:0xf
  v_mov_b32_dpp v23, v19 row_shl:4 row_mask:0xf bank_mask:0xf
  v_fma_f32 v20, -v16, v16, v20
  v_max_f32 v20, 0, v20
  v_add_f32 v20, 0x3727c5ac, v20
  v_rsq_f32 v24, v20
  v_fma_f32 v21, -v17, v17, v21
  v_max_f32 v21, 0, v21
  v_add_f32 v21, 0x3727c5ac, v21
  v_rsq_f32 v26, v21
  v_fma_f32 v22, -v18, v18, v22
  v_max_f32 v22, 0, v22
  v_add_f32 v22, 0x3727c5ac, v22
  v_rsq_f32 v28, v22
  v_fma_f32 v23, -v19, v19, v23
  v_max_f32 v23, 0, v23
  v_add_f32 v23, 0x3727c5ac, v23
  v_rsq_f32 v30, v23
  v_mul_f32 v25, v16, v24
  v_mul_f32 v27, v17, v26
  v_mul_f32 v29, v18, v28
  v_mul_f32 v31, v19, v30
  s_mov_b32 exec_lo, 0x0f0f0f0f
  s_mov_b32 exec_hi, 0
  ds_write_b128 v52, v[24:27]
  ds_write_b128 v52, v[28:31] offset:16
  s_mov_b64 exec, -1
  v_mov_b32 v16, 1
  v_mov_b32 v17, 97280
  s_waitcnt lgkmcnt(0)
  ds_write_b32 v17, v16
  s_add_u32 s59, s30, 0
  s_add_u32 m0, s31, 98304
  s_nop 0
  buffer_load_dwordx4 v9, s[36:39], s59 offen lds
  s_waitcnt vmcnt(40)
  s_add_u32 s59, s30, 128
  s_add_u32 m0, s31, 106496
  s_nop 0
  buffer_load_dwordx4 v9, s[36:39], s59 offen lds
  s_waitcnt vmcnt(40)
  s_add_u32 s59, s30, 256
  s_add_u32 m0, s31, 114688
  s_nop 0
  buffer_load_dwordx4 v9, s[36:39], s59 offen lds
  s_waitcnt vmcnt(40)
  s_add_u32 s59, s30, 384
  s_add_u32 m0, s31, 122880
  s_nop 0
  buffer_load_dwordx4 v9, s[36:39], s59 offen lds
  s_waitcnt vmcnt(40)
  s_add_u32 s59, s30, 512
  s_add_u32 m0, s31, 131072
  s_nop 0
  buffer_load_dwordx4 v9, s[36:39], s59 offen lds
  s_waitcnt vmcnt(40)
  s_add_u32 s59, s30, 640
  s_add_u32 m0, s31, 139264
  s_nop 0
  buffer_load_dwordx4 v9, s[36:39], s59 offen lds
  s_waitcnt vmcnt(40)
  s_add_u32 s59, s30, 768
  s_add_u32 m0, s31, 147456
  s_nop 0
  buffer_load_dwordx4 v9, s[36:39], s59 offen lds
  s_waitcnt vmcnt(40)
  s_add_u32 s59, s30, 896
  s_add_u32 m0, s31, 155648
  s_nop 0
  buffer_load_dwordx4 v9, s[36:39], s59 offen lds
  s_waitcnt vmcnt(40)
  s_add_u32 s59, s30, 1024
  buffer_load_dwordx4 v[176:179], v9, s[36:39], s59 offen
  s_waitcnt vmcnt(40)
  s_add_u32 s59, s30, 1152
  buffer_load_dwordx4 v[180:183], v9, s[36:39], s59 offen
  s_waitcnt vmcnt(40)
  s_add_u32 s59, s30, 1280
  buffer_load_dwordx4 v[184:187], v9, s[36:39], s59 offen
  s_waitcnt vmcnt(40)
  s_add_u32 s59, s30, 1408
  buffer_load_dwordx4 v[188:191], v9, s[36:39], s59 offen
  s_waitcnt vmcnt(40)
  s_add_u32 s59, s30, 1536
  buffer_load_dwordx4 v[192:195], v9, s[36:39], s59 offen
  s_waitcnt vmcnt(40)
  s_add_u32 s59, s30, 1664
  buffer_load_dwordx4 v[196:199], v9, s[36:39], s59 offen
  s_waitcnt vmcnt(40)
  s_add_u32 s59, s30, 1792
  buffer_load_dwordx4 v[200:203], v9, s[36:39], s59 offen
  s_waitcnt vmcnt(40)
  s_add_u32 s59, s30, 1920
  buffer_load_dwordx4 v[204:207], v9, s[36:39], s59 offen
  s_waitcnt vmcnt(40)
  s_add_u32 s59, s30, 2048
  buffer_load_dwordx4 v[208:211], v9, s[36:39], s59 offen
  s_waitcnt vmcnt(40)
  s_add_u32 s59, s30, 2176
  buffer_load_dwordx4 v[212:215], v9, s[36:39], s59 offen
  s_waitcnt vmcnt(40)
  s_add_u32 s59, s30, 2304
  buffer_load_dwordx4 v[216:219], v9, s[36:39], s59 offen
  s_waitcnt vmcnt(40)
  s_add_u32 s59, s30, 2432
  buffer_load_dwordx4 v[220:223], v9, s[36:39], s59 offen
  s_waitcnt vmcnt(40)
  s_add_u32 s59, s30, 2560
  buffer_load_dwordx4 v[224:227], v9, s[36:39], s59 offen
  s_waitcnt vmcnt(40)
  s_add_u32 s59, s30, 2688
  buffer_load_dwordx4 v[228:231], v9, s[36:39], s59 offen
  s_waitcnt vmcnt(40)
  s_add_u32 s59, s30, 2816
  buffer_load_dwordx4 v[232:235], v9, s[36:39], s59 offen
  s_waitcnt vmcnt(40)
  s_add_u32 s59, s30, 2944
  buffer_load_dwordx4 v[236:239], v9, s[36:39], s59 offen
  s_waitcnt vmcnt(40)
  v_lshlrev_b32 v16, 3, v1
  v_add_u32 v17, 85504, v16
  s_lshl_b32 s56, s44, 13
  s_add_u32 s56, s56, 524288
  s_add_u32 s50, s56, 4096
  s_lshl_b32 s52, s45, 10
  s_add_u32 s57, s52, s56
  s_waitcnt vmcnt(0)
  s_waitcnt lgkmcnt(0)
  s_barrier
  ds_read_b64 v[20:21], v17 offset:0
  ds_read_b64 v[22:23], v17 offset:512
  ds_read_b64 v[24:25], v17 offset:1024
  ds_read_b64 v[26:27], v17 offset:1536
  ds_read_b64 v[28:29], v17 offset:2048
  ds_read_b64 v[30:31], v17 offset:2560
  ds_read_b64 v[32:33], v17 offset:3072
  s_waitcnt lgkmcnt(0)
  v_add_f32 v20, v20, v22
  v_add_f32 v21, v21, v23
  v_add_f32 v20, v20, v24
  v_add_f32 v21, v21, v25
  v_add_f32 v20, v20, v26
  v_add_f32 v21, v21, v27
  v_add_f32 v20, v20, v28
  v_add_f32 v21, v21, v29
  v_add_f32 v20, v20, v30
  v_add_f32 v21, v21, v31
  v_add_f32 v20, v20, v32
  v_add_f32 v21, v21, v33
  v_mov_b32 v22, v20
  v_mov_b32 v23, v21
  v_mov_b32 v24, 0xff
  s_lshr_b32 s60, s47, 0
  v_mov_b32 v25, s60
  v_bfi_b32 v20, v24, v25, v20
  s_lshr_b32 s60, s47, 8
  v_mov_b32 v25, s60
  v_bfi_b32 v21, v24, v25, v21
  s_lshr_b32 s60, s47, 16
  v_mov_b32 v25, s60
  v_bfi_b32 v22, v24, v25, v22
  s_lshr_b32 s60, s47, 24
  v_mov_b32 v25, s60
  v_bfi_b32 v23, v24, v25, v23
  buffer_store_dwordx4 v[20:23], v2, s[32:35], s57 offen sc1
  s_waitcnt vmcnt(0)
  s_mov_b32 s61, 0
  s_mov_b32 s60, 0x0c0c0400
L_tl_116:
  buffer_load_dwordx4 v[20:23], v2, s[32:35], s56 offen offset:0 sc1
  buffer_load_dwordx4 v[24:27], v2, s[32:35], s56 offen offset:1024 sc1
  buffer_load_dwordx4 v[28:31], v2, s[32:35], s56 offen offset:2048 sc1
  buffer_load_dwordx4 v[32:35], v2, s[32:35], s56 offen offset:3072 sc1
  buffer_load_dwordx4 v[36:39], v2, s[32:35], s50 offen offset:0 sc1
  buffer_load_dwordx4 v[40:43], v2, s[32:35], s50 offen offset:1024 sc1
  buffer_load_dwordx4 v[44:47], v2, s[32:35], s50 offen offset:2048 sc1
  buffer_load_dwordx4 v[48:51], v2, s[32:35], s50 offen offset:3072 sc1
  s_waitcnt vmcnt(0)
L_tc_118:
  v_perm_b32 v18, v21, v20, s60
  v_perm_b32 v19, v23, v22, s60
  v_lshl_or_b32 v18, v19, 16, v18
  v_cmp_ne_u32 vcc, s47, v18
  v_perm_b32 v18, v25, v24, s60
  v_perm_b32 v19, v27, v26, s60
  v_lshl_or_b32 v18, v19, 16, v18
  v_cmp_ne_u32 s[58:59], s47, v18
  s_nop 1
  s_or_b64 vcc, vcc, s[58:59]
  v_perm_b32 v18, v29, v28, s60
  v_perm_b32 v19, v31, v30, s60
  v_lshl_or_b32 v18, v19, 16, v18
  v_cmp_ne_u32 s[58:59], s47, v18
  s_nop 1
  s_or_b64 vcc, vcc, s[58:59]
  v_perm_b32 v18, v33, v32, s60
  v_perm_b32 v19, v35, v34, s60
  v_lshl_or_b32 v18, v19, 16, v18
  v_cmp_ne_u32 s[58:59], s47, v18
  s_nop 1
  s_or_b64 vcc, vcc, s[58:59]
  v_perm_b32 v18, v37, v36, s60
  v_perm_b32 v19, v39, v38, s60
  v_lshl_or_b32 v18, v19, 16, v18
  v_cmp_ne_u32 s[58:59], s47, v18
  s_nop 1
  s_or_b64 vcc, vcc, s[58:59]
  v_perm_b32 v18, v41, v40, s60
  v_perm_b32 v19, v43, v42, s60
  v_lshl_or_b32 v18, v19, 16, v18
  v_cmp_ne_u32 s[58:59], s47, v18
  s_nop 1
  s_or_b64 vcc, vcc, s[58:59]
  v_perm_b32 v18, v45, v44, s60
  v_perm_b32 v19, v47, v46, s60
  v_lshl_or_b32 v18, v19, 16, v18
  v_cmp_ne_u32 s[58:59], s47, v18
  s_nop 1
  s_or_b64 vcc, vcc, s[58:59]
  v_perm_b32 v18, v49, v48, s60
  v_perm_b32 v19, v51, v50, s60
  v_lshl_or_b32 v18, v19, 16, v18
  v_cmp_ne_u32 s[58:59], s47, v18
  s_nop 1
  s_or_b64 vcc, vcc, s[58:59]
  s_cmp_eq_u64 vcc, 0
  s_cbranch_scc1 L_td_117
  s_add_u32 s61, s61, 1
  s_cmp_lt_u32 s61, 40000
  s_cbranch_scc1 L_tl_116
L_td_117:
  v_and_b32 v20, 0xffffff00, v20
  v_and_b32 v21, 0xffffff00, v21
  v_and_b32 v22, 0xffffff00, v22
  v_and_b32 v23, 0xffffff00, v23
  v_and_b32 v24, 0xffffff00, v24
  v_and_b32 v25, 0xffffff00, v25
  v_and_b32 v26, 0xffffff00, v26
  v_and_b32 v27, 0xffffff00, v27
  v_and_b32 v28, 0xffffff00, v28
  v_and_b32 v29, 0xffffff00, v29
  v_and_b32 v30, 0xffffff00, v30
  v_and_b32 v31, 0xffffff00, v31
  v_and_b32 v32, 0xffffff00, v32
  v_and_b32 v33, 0xffffff00, v33
  v_and_b32 v34, 0xffffff00, v34
  v_and_b32 v35, 0xffffff00, v35
  v_and_b32 v36, 0xffffff00, v36
  v_and_b32 v37, 0xffffff00, v37
  v_and_b32 v38, 0xffffff00, v38
  v_and_b32 v39, 0xffffff00, v39
  v_and_b32 v40, 0xffffff00, v40
  v_and_b32 v41, 0xffffff00, v41
  v_and_b32 v42, 0xffffff00, v42
  v_and_b32 v43, 0xffffff00, v43
  v_and_b32 v44, 0xffffff00, v44
  v_and_b32 v45, 0xffffff00, v45
  v_and_b32 v46, 0xffffff00, v46
  v_and_b32 v47, 0xffffff00, v47
  v_and_b32 v48, 0xffffff00, v48
  v_and_b32 v49, 0xffffff00, v49
  v_and_b32 v50, 0xffffff00, v50
  v_and_b32 v51, 0xffffff00, v51
  v_add_f32 v20, v20, v24
  v_add_f32 v21, v21, v25
  v_add_f32 v20, v20, v28
  v_add_f32 v21, v21, v29
  v_add_f32 v20, v20, v32
  v_add_f32 v21, v21, v33
  v_add_f32 v20, v20, v36
  v_add_f32 v21, v21, v37
  v_add_f32 v20, v20, v40
  v_add_f32 v21, v21, v41
  v_add_f32 v20, v20, v44
  v_add_f32 v21, v21, v45
  v_add_f32 v20, v20, v48
  v_add_f32 v21, v21, v49
  v_mul_f32 v20, 0x3a97b426, v20
  v_mul_f32 v21, 0x3a97b426, v21
  v_fma_f32 v21, -v20, v20, v21
  v_max_f32 v21, 0, v21
  v_add_f32 v21, 0x3727c5ac, v21
  v_rsq_f32 v22, v21
  s_nop 0
  v_mul_f32 v23, v20, v22
  v_add_u32 v17, 96256, v16
  ds_write_b64 v17, v[22:23]
  s_waitcnt lgkmcnt(0)
  s_add_u32 s59, s30, 3072
  buffer_load_dwordx4 v[124:127], v9, s[36:39], s59 offen
  s_add_u32 s59, s30, 3200
  buffer_load_dwordx4 v[128:131], v9, s[36:39], s59 offen
  s_add_u32 s59, s30, 3328
  buffer_load_dwordx4 v[132:135], v9, s[36:39], s59 offen
  s_add_u32 s59, s30, 3456
  buffer_load_dwordx4 v[136:139], v9, s[36:39], s59 offen
  s_add_u32 s59, s30, 3584
  buffer_load_dwordx4 v[140:143], v9, s[36:39], s59 offen
  s_add_u32 s59, s30, 3712
  buffer_load_dwordx4 v[144:147], v9, s[36:39], s59 offen
  s_add_u32 s59, s30, 3840
  buffer_load_dwordx4 v[148:151], v9, s[36:39], s59 offen
  s_add_u32 s59, s30, 3968
  buffer_load_dwordx4 v[152:155], v9, s[36:39], s59 offen
  s_barrier
  s_lshl_b32 s51, s45, 12
  s_lshl_b32 s52, s44, 7
  s_add_u32 s50, s51, s52
  s_add_u32 s50, s50, 884736
  s_barrier
  s_mov_b64 exec, 1
  buffer_store_dword v3, off, s[32:35], s50 sc1
  s_mov_b64 exec, -1
  s_add_u32 s59, s31, 98304
  v_add_u32 v10, s59, v2
  v_xor_b32 v11, 0x10000, v10
  ds_write_b128 v11, v[176:179] offset:0
  ds_write_b128 v11, v[180:183] offset:8192
  ds_write_b128 v11, v[184:187] offset:16384
  ds_write_b128 v11, v[188:191] offset:24576
  ds_write_b128 v11, v[192:195] offset:32768
  ds_write_b128 v11, v[196:199] offset:40960
  ds_write_b128 v11, v[200:203] offset:49152
  ds_write_b128 v11, v[204:207] offset:57344
L_join_110:
  s_cmp_eq_u32 s46, 7
  s_cbranch_scc1 L_svc_119
  v_and_b32 v36, 15, v1
  v_lshrrev_b32 v37, 4, v1
  v_and_b32 v38, 6, v36
  v_lshrrev_b32 v39, 3, v36
  v_lshlrev_b32 v39, 10, v39
  v_and_b32 v40, 7, v36
  v_lshl_add_u32 v39, v40, 7, v39
  v_add_u32 v39, 98304, v39
  v_add_u32 v40, 0, v37
  v_xor_b32 v40, v40, v38
  v_lshl_add_u32 v4, v40, 4, v39
  v_add_u32 v40, 4, v37
  v_xor_b32 v40, v40, v38
  v_lshl_add_u32 v5, v40, 4, v39
  s_add_u32 s59, s31, 98304
  v_add_u32 v12, s59, v2
  v_xor_b32 v13, 0x10000, v12
  v_xor_b32 v6, 0x10000, v4
  v_xor_b32 v7, 0x10000, v5
  s_mul_i32 s57, s45, 458752
  s_add_u32 s57, s57, 19398656
  s_waitcnt lgkmcnt(0)
  v_lshlrev_b32 v32, 16, v254
  v_and_b32 v33, 0xffff0000, v254
  v_lshlrev_b32 v34, 16, v255
  v_and_b32 v35, 0xffff0000, v255
  s_barrier
  buffer_load_dwordx4 v[92:95], v8, s[32:35], s57 offen sc1
  s_add_u32 s57, s57, 7168
  buffer_load_dwordx4 v[96:99], v8, s[32:35], s57 offen sc1
  s_add_u32 s57, s57, 7168
  buffer_load_dwordx4 v[100:103], v8, s[32:35], s57 offen sc1
  s_add_u32 s57, s57, 7168
  buffer_load_dwordx4 v[104:107], v8, s[32:35], s57 offen sc1
  s_add_u32 s57, s57, 7168
  buffer_load_dwordx4 v[108:111], v8, s[32:35], s57 offen sc1
  s_add_u32 s57, s57, 7168
  buffer_load_dwordx4 v[112:115], v8, s[32:35], s57 offen sc1
  s_add_u32 s57, s57, 7168
  buffer_load_dwordx4 v[116:119], v8, s[32:35], s57 offen sc1
  s_add_u32 s57, s57, 7168
  buffer_load_dwordx4 v[120:123], v8, s[32:35], s57 offen sc1
  s_add_u32 s57, s57, 7168
  ds_read_b128 v[44:47], v4 offset:0
  ds_read_b128 v[48:51], v4 offset:2048
  ds_read_b128 v[52:55], v4 offset:4096
  ds_read_b128 v[56:59], v4 offset:6144
  ds_read_b128 v[60:63], v5 offset:0
  ds_read_b128 v[64:67], v5 offset:2048
  ds_read_b128 v[68:71], v5 offset:4096
  ds_read_b128 v[72:75], v5 offset:6144
  s_waitcnt vmcnt(7) lgkmcnt(4)
  v_mfma_f32_16x16x32_bf16 v[16:19], v[92:95], v[44:47], 0
  ds_read_b128 v[76:79], v4 offset:8192
  v_mfma_f32_16x16x32_bf16 v[20:23], v[92:95], v[48:51], 0
  ds_read_b128 v[80:83], v4 offset:10240
  v_mfma_f32_16x16x32_bf16 v[24:27], v[92:95], v[52:55], 0
  ds_read_b128 v[84:87], v4 offset:12288
  v_mfma_f32_16x16x32_bf16 v[28:31], v[92:95], v[56:59], 0
  ds_read_b128 v[88:91], v4 offset:14336
  buffer_load_dwordx4 v[92:95], v8, s[32:35], s57 offen sc1
  s_add_u32 s57, s57, 7168
  s_waitcnt vmcnt(7) lgkmcnt(4)
  v_mfma_f32_16x16x32_bf16 v[16:19], v[96:99], v[60:63], v[16:19]
  ds_read_b128 v[44:47], v5 offset:8192
  v_mfma_f32_16x16x32_bf16 v[20:23], v[96:99], v[64:67], v[20:23]
  ds_read_b128 v[48:51], v5 offset:10240
  v_mfma_f32_16x16x32_bf16 v[24:27], v[96:99], v[68:71], v[24:27]
  ds_read_b128 v[52:55], v5 offset:12288
  v_mfma_f32_16x16x32_bf16 v[28:31], v[96:99], v[72:75], v[28:31]
  ds_read_b128 v[56:59], v5 offset:14336
  buffer_load_dwordx4 v[96:99], v8, s[32:35], s57 offen sc1
  s_add_u32 s57, s57, 7168
  s_waitcnt vmcnt(7) lgkmcnt(4)
  v_mfma_f32_16x16x32_bf16 v[16:19], v[100:103], v[76:79], v[16:19]
  ds_read_b128 v[60:63], v4 offset:16384
  v_mfma_f32_16x16x32_bf16 v[20:23], v[100:103], v[80:83], v[20:23]
  ds_read_b128 v[64:67], v4 offset:18432
  v_mfma_f32_16x16x32_bf16 v[24:27], v[100:103], v[84:87], v[24:27]
  ds_read_b128 v[68:71], v4 offset:20480
  v_mfma_f32_16x16x32_bf16 v[28:31], v[100:103], v[88:91], v[28:31]
  ds_read_b128 v[72:75], v4 offset:22528
  buffer_load_dwordx4 v[100:103], v8, s[32:35], s57 offen sc1
  s_add_u32 s57, s57, 7168
  s_waitcnt vmcnt(7) lgkmcnt(4)
  v_mfma_f32_16x16x32_bf16 v[16:19], v[104:107], v[44:47], v[16:19]
  ds_read_b128 v[76:79], v5 offset:16384
  v_mfma_f32_16x16x32_bf16 v[20:23], v[104:107], v[48:51], v[20:23]
  ds_read_b128 v[80:83], v5 offset:18432
  v_mfma_f32_16x16x32_bf16 v[24:27], v[104:107], v[52:55], v[24:27]
  ds_read_b128 v[84:87], v5 offset:20480
  v_mfma_f32_16x16x32_bf16 v[28:31], v[104:107], v[56:59], v[28:31]
  ds_read_b128 v[88:91], v5 offset:22528
  buffer_load_dwordx4 v[104:107], v8, s[32:35], s57 offen sc1
  s_add_u32 s57, s57, 7168
  s_waitcnt vmcnt(7) lgkmcnt(4)
  v_mfma_f32_16x16x32_bf16 v[16:19], v[108:111], v[60:63], v[16:19]
  ds_read_b128 v[44:47], v4 offset:24576
  v_mfma_f32_16x16x32_bf16 v[20:23], v[108:111], v[64:67], v[20:23]
  ds_read_b128 v[48:51], v4 offset:26624
  v_mfma_f32_16x16x32_bf16 v[24:27], v[108:111], v[68:71], v[24:27]
  ds_read_b128 v[52:55], v4 offset:28672
  v_mfma_f32_16x16x32_bf16 v[28:31], v[108:111], v[72:75], v[28:31]
  ds_read_b128 v[56:59], v4 offset:30720
  buffer_load_dwordx4 v[108:111], v8, s[32:35], s57 offen sc1
  s_add_u32 s57, s57, 7168
  s_mul_i32 s53, s45, 27
  s_mul_i32 s52, s96, 7
  s_add_u32 s53, s53, s52
  s_mul_i32 s53, s53, 5120
  s_mul_i32 s52, s97, 3072
  s_add_u32 s53, s53, s52
  s_add_u32 s53, s53, 7077888
  s_lshl_b32 s52, s97, 30
  v_add_u32 v10, s52, v2
  buffer_load_dwordx4 v[156:159], v2, s[32:35], s53 offen offset:0 sc1
  s_waitcnt vmcnt(8) lgkmcnt(4)
  v_mfma_f32_16x16x32_bf16 v[16:19], v[112:115], v[76:79], v[16:19]
  ds_read_b128 v[60:63], v5 offset:24576
  v_mfma_f32_16x16x32_bf16 v[20:23], v[112:115], v[80:83], v[20:23]
  ds_read_b128 v[64:67], v5 offset:26624
  v_mfma_f32_16x16x32_bf16 v[24:27], v[112:115], v[84:87], v[24:27]
  ds_read_b128 v[68:71], v5 offset:28672
  v_mfma_f32_16x16x32_bf16 v[28:31], v[112:115], v[88:91], v[28:31]
  ds_read_b128 v[72:75], v5 offset:30720
  buffer_load_dwordx4 v[112:115], v8, s[32:35], s57 offen sc1
  s_add_u32 s57, s57, 7168
  s_waitcnt vmcnt(8) lgkmcnt(4)
  v_mfma_f32_16x16x32_bf16 v[16:19], v[116:119], v[44:47], v[16:19]
  ds_read_b128 v[76:79], v4 offset:32768
  v_mfma_f32_16x16x32_bf16 v[20:23], v[116:119], v[48:51], v[20:23]
  ds_read_b128 v[80:83], v4 offset:34816
  v_mfma_f32_16x16x32_bf16 v[24:27], v[116:119], v[52:55], v[24:27]
  ds_read_b128 v[84:87], v4 offset:36864
  v_mfma_f32_16x16x32_bf16 v[28:31], v[116:119], v[56:59], v[28:31]
  ds_read_b128 v[88:91], v4 offset:38912
  buffer_load_dwordx4 v[116:119], v8, s[32:35], s57 offen sc1
  s_add_u32 s57, s57, 7168
  s_waitcnt vmcnt(8) lgkmcnt(4)
  v_mfma_f32_16x16x32_bf16 v[16:19], v[120:123], v[60:63], v[16:19]
  ds_read_b128 v[44:47], v5 offset:32768
  v_mfma_f32_16x16x32_bf16 v[20:23], v[120:123], v[64:67], v[20:23]
  ds_read_b128 v[48:51], v5 offset:34816
  v_mfma_f32_16x16x32_bf16 v[24:27], v[120:123], v[68:71], v[24:27]
  ds_read_b128 v[52:55], v5 offset:36864
  v_mfma_f32_16x16x32_bf16 v[28:31], v[120:123], v[72:75], v[28:31]
  ds_read_b128 v[56:59], v5 offset:38912
  buffer_load_dwordx4 v[120:123], v8, s[32:35], s57 offen sc1
  s_add_u32 s57, s57, 7168
  s_waitcnt vmcnt(8) lgkmcnt(4)
  v_mfma_f32_16x16x32_bf16 v[16:19], v[92:95], v[76:79], v[16:19]
  ds_read_b128 v[60:63], v4 offset:40960
  v_mfma_f32_16x16x32_bf16 v[20:23], v[92:95], v[80:83], v[20:23]
  ds_read_b128 v[64:67], v4 offset:43008
  v_mfma_f32_16x16x32_bf16 v[24:27], v[92:95], v[84:87], v[24:27]
  ds_read_b128 v[68:71], v4 offset:45056
  v_mfma_f32_16x16x32_bf16 v[28:31], v[92:95], v[88:91], v[28:31]
  ds_read_b128 v[72:75], v4 offset:47104
  buffer_load_dwordx4 v[92:95], v8, s[32:35], s57 offen sc1
  s_add_u32 s57, s57, 7168
  buffer_load_dwordx4 v[160:163], v2, s[32:35], s53 offen offset:1024 sc1
  s_waitcnt vmcnt(9) lgkmcnt(4)
  v_mfma_f32_16x16x32_bf16 v[16:19], v[96:99], v[44:47], v[16:19]
  ds_read_b128 v[76:79], v5 offset:40960
  v_mfma_f32_16x16x32_bf16 v[20:23], v[96:99], v[48:51], v[20:23]
  ds_read_b128 v[80:83], v5 offset:43008
  v_mfma_f32_16x16x32_bf16 v[24:27], v[96:99], v[52:55], v[24:27]
  ds_read_b128 v[84:87], v5 offset:45056
  v_mfma_f32_16x16x32_bf16 v[28:31], v[96:99], v[56:59], v[28:31]
  ds_read_b128 v[88:91], v5 offset:47104
  buffer_load_dwordx4 v[96:99], v8, s[32:35], s57 offen sc1
  s_add_u32 s57, s57, 7168
  s_waitcnt vmcnt(9) lgkmcnt(4)
  v_mfma_f32_16x16x32_bf16 v[16:19], v[100:103], v[60:63], v[16:19]
  ds_read_b128 v[44:47], v4 offset:49152
  v_mfma_f32_16x16x32_bf16 v[20:23], v[100:103], v[64:67], v[20:23]
  ds_read_b128 v[48:51], v4 offset:51200
  v_mfma_f32_16x16x32_bf16 v[24:27], v[100:103], v[68:71], v[24:27]
  ds_read_b128 v[52:55], v4 offset:53248
  v_mfma_f32_16x16x32_bf16 v[28:31], v[100:103], v[72:75], v[28:31]
  ds_read_b128 v[56:59], v4 offset:55296
  buffer_load_dwordx4 v[100:103], v8, s[32:35], s57 offen sc1
  s_add_u32 s57, s57, 7168
  s_waitcnt vmcnt(9) lgkmcnt(4)
  v_mfma_f32_16x16x32_bf16 v[16:19], v[104:107], v[76:79], v[16:19]
  ds_read_b128 v[60:63], v5 offset:49152
  v_mfma_f32_16x16x32_bf16 v[20:23], v[104:107], v[80:83], v[20:23]
  ds_read_b128 v[64:67], v5 offset:51200
  v_mfma_f32_16x16x32_bf16 v[24:27], v[104:107], v[84:87], v[24:27]
  ds_read_b128 v[68:71], v5 offset:53248
  v_mfma_f32_16x16x32_bf16 v[28:31], v[104:107], v[88:91], v[28:31]
  ds_read_b128 v[72:75], v5 offset:55296
  buffer_load_dwordx4 v[104:107], v8, s[32:35], s57 offen sc1
  s_add_u32 s57, s57, 7168
  s_waitcnt vmcnt(9) lgkmcnt(4)
  v_mfma_f32_16x16x32_bf16 v[16:19], v[108:111], v[44:47], v[16:19]
  ds_read_b128 v[76:79], v4 offset:57344
  v_mfma_f32_16x16x32_bf16 v[20:23], v[108:111], v[48:51], v[20:23]
  ds_read_b128 v[80:83], v4 offset:59392
  v_mfma_f32_16x16x32_bf16 v[24:27], v[108:111], v[52:55], v[24:27]
  ds_read_b128 v[84:87], v4 offset:61440
  v_mfma_f32_16x16x32_bf16 v[28:31], v[108:111], v[56:59], v[28:31]
  ds_read_b128 v[88:91], v4 offset:63488
  buffer_load_dwordx4 v[108:111], v8, s[32:35], s57 offen sc1
  s_add_u32 s57, s57, 7168
  s_waitcnt vmcnt(8) lgkmcnt(4)
  v_mfma_f32_16x16x32_bf16 v[16:19], v[112:115], v[60:63], v[16:19]
  ds_read_b128 v[44:47], v5 offset:57344
  v_mfma_f32_16x16x32_bf16 v[20:23], v[112:115], v[64:67], v[20:23]
  ds_read_b128 v[48:51], v5 offset:59392
  v_mfma_f32_16x16x32_bf16 v[24:27], v[112:115], v[68:71], v[24:27]
  ds_read_b128 v[52:55], v5 offset:61440
  v_mfma_f32_16x16x32_bf16 v[28:31], v[112:115], v[72:75], v[28:31]
  ds_read_b128 v[56:59], v5 offset:63488
  buffer_load_dwordx4 v[112:115], v8, s[32:35], s57 offen sc1
  s_add_u32 s57, s57, 7168
  buffer_load_dwordx4 v[164:167], v10, s[32:35], s53 offen offset:2048 sc1
  s_waitcnt vmcnt(9) lgkmcnt(4)
  v_mfma_f32_16x16x32_bf16 v[16:19], v[116:119], v[76:79], v[16:19]
  ds_read_b128 v[60:63], v6 offset:0
  v_mfma_f32_16x16x32_bf16 v[20:23], v[116:119], v[80:83], v[20:23]
  ds_read_b128 v[64:67], v6 offset:2048
  v_mfma_f32_16x16x32_bf16 v[24:27], v[116:119], v[84:87], v[24:27]
  ds_read_b128 v[68:71], v6 offset:4096
  v_mfma_f32_16x16x32_bf16 v[28:31], v[116:119], v[88:91], v[28:31]
  ds_read_b128 v[72:75], v6 offset:6144
  buffer_load_dwordx4 v[116:119], v8, s[32:35], s57 offen sc1
  s_add_u32 s57, s57, 7168
  s_waitcnt vmcnt(9) lgkmcnt(4)
  v_mfma_f32_16x16x32_bf16 v[16:19], v[120:123], v[44:47], v[16:19]
  ds_read_b128 v[76:79], v7 offset:0
  v_mfma_f32_16x16x32_bf16 v[20:23], v[120:123], v[48:51], v[20:23]
  ds_read_b128 v[80:83], v7 offset:2048
  v_mfma_f32_16x16x32_bf16 v[24:27], v[120:123], v[52:55], v[24:27]
  ds_read_b128 v[84:87], v7 offset:4096
  v_mfma_f32_16x16x32_bf16 v[28:31], v[120:123], v[56:59], v[28:31]
  ds_read_b128 v[88:91], v7 offset:6144
  buffer_load_dwordx4 v[120:123], v8, s[32:35], s57 offen sc1
  s_add_u32 s57, s57, 7168
  s_waitcnt vmcnt(9) lgkmcnt(4)
  s_barrier
  v_mfma_f32_16x16x32_bf16 v[16:19], v[92:95], v[60:63], v[16:19]
  ds_read_b128 v[44:47], v6 offset:8192
  v_mfma_f32_16x16x32_bf16 v[20:23], v[92:95], v[64:67], v[20:23]
  ds_read_b128 v[48:51], v6 offset:10240
  v_mfma_f32_16x16x32_bf16 v[24:27], v[92:95], v[68:71], v[24:27]
  ds_read_b128 v[52:55], v6 offset:12288
  v_mfma_f32_16x16x32_bf16 v[28:31], v[92:95], v[72:75], v[28:31]
  ds_read_b128 v[56:59], v6 offset:14336
  buffer_load_dwordx4 v[92:95], v8, s[32:35], s57 offen sc1
  s_add_u32 s57, s57, 7168
  s_waitcnt vmcnt(8) lgkmcnt(4)
  v_mfma_f32_16x16x32_bf16 v[16:19], v[96:99], v[76:79], v[16:19]
  ds_read_b128 v[60:63], v7 offset:8192
  ds_read_b128 v[64:67], v7 offset:10240
  v_mfma_f32_16x16x32_bf16 v[20:23], v[96:99], v[80:83], v[20:23]
  ds_read_b128 v[68:71], v7 offset:12288
  v_mfma_f32_16x16x32_bf16 v[24:27], v[96:99], v[84:87], v[24:27]
  ds_read_b128 v[72:75], v7 offset:14336
  v_mfma_f32_16x16x32_bf16 v[28:31], v[96:99], v[88:91], v[28:31]
  ds_write_b128 v12, v[208:211] offset:0
  buffer_load_dwordx4 v[96:99], v8, s[32:35], s57 offen sc1
  s_add_u32 s57, s57, 7168
  s_waitcnt vmcnt(8) lgkmcnt(5)
  v_mfma_f32_16x16x32_bf16 v[16:19], v[100:103], v[44:47], v[16:19]
  ds_read_b128 v[76:79], v6 offset:16384
  ds_read_b128 v[80:83], v6 offset:18432
  v_mfma_f32_16x16x32_bf16 v[20:23], v[100:103], v[48:51], v[20:23]
  ds_read_b128 v[84:87], v6 offset:20480
  v_mfma_f32_16x16x32_bf16 v[24:27], v[100:103], v[52:55], v[24:27]
  ds_read_b128 v[88:91], v6 offset:22528
  v_mfma_f32_16x16x32_bf16 v[28:31], v[100:103], v[56:59], v[28:31]
  ds_write_b128 v12, v[212:215] offset:8192
  buffer_load_dwordx4 v[100:103], v8, s[32:35], s57 offen sc1
  s_add_u32 s57, s57, 7168
  s_add_u32 s53, s53, 5120
  buffer_load_dwordx4 v[168:171], v2, s[32:35], s53 offen offset:0 sc1
  s_waitcnt vmcnt(9) lgkmcnt(6)
  v_mfma_f32_16x16x32_bf16 v[16:19], v[104:107], v[60:63], v[16:19]
  ds_read_b128 v[44:47], v7 offset:16384
  ds_read_b128 v[48:51], v7 offset:18432
  v_mfma_f32_16x16x32_bf16 v[20:23], v[104:107], v[64:67], v[20:23]
  ds_read_b128 v[52:55], v7 offset:20480
  v_mfma_f32_16x16x32_bf16 v[24:27], v[104:107], v[68:71], v[24:27]
  ds_read_b128 v[56:59], v7 offset:22528
  v_mfma_f32_16x16x32_bf16 v[28:31], v[104:107], v[72:75], v[28:31]
  ds_write_b128 v12, v[216:219] offset:16384
  buffer_load_dwordx4 v[104:107], v8, s[32:35], s57 offen sc1
  s_add_u32 s57, s57, 7168
  s_waitcnt vmcnt(9) lgkmcnt(6)
  v_mfma_f32_16x16x32_bf16 v[16:19], v[108:111], v[76:79], v[16:19]
  ds_read_b128 v[60:63], v6 offset:24576
  ds_read_b128 v[64:67], v6 offset:26624
  v_mfma_f32_16x16x32_bf16 v[20:23], v[108:111], v[80:83], v[20:23]
  ds_read_b128 v[68:71], v6 offset:28672
  v_mfma_f32_16x16x32_bf16 v[24:27], v[108:111], v[84:87], v[24:27]
  ds_read_b128 v[72:75], v6 offset:30720
  v_mfma_f32_16x16x32_bf16 v[28:31], v[108:111], v[88:91], v[28:31]
  ds_write_b128 v12, v[220:223] offset:24576
  buffer_load_dwordx4 v[108:111], v8, s[32:35], s57 offen sc1
  s_add_u32 s57, s57, 7168
  s_waitcnt vmcnt(9) lgkmcnt(6)
  v_mfma_f32_16x16x32_bf16 v[16:19], v[112:115], v[44:47], v[16:19]
  ds_read_b128 v[76:79], v7 offset:24576
  ds_read_b128 v[80:83], v7 offset:26624
  v_mfma_f32_16x16x32_bf16 v[20:23], v[112:115], v[48:51], v[20:23]
  ds_read_b128 v[84:87], v7 offset:28672
  v_mfma_f32_16x16x32_bf16 v[24:27], v[112:115], v[52:55], v[24:27]
  ds_read_b128 v[88:91], v7 offset:30720
  v_mfma_f32_16x16x32_bf16 v[28:31], v[112:115], v[56:59], v[28:31]
  ds_write_b128 v12, v[224:227] offset:32768
  buffer_load_dwordx4 v[112:115], v8, s[32:35], s57 offen sc1
  s_add_u32 s57, s57, 7168
  s_waitcnt vmcnt(8) lgkmcnt(6)
  v_mfma_f32_16x16x32_bf16 v[16:19], v[116:119], v[60:63], v[16:19]
  ds_read_b128 v[44:47], v6 offset:32768
  ds_read_b128 v[48:51], v6 offset:34816
  v_mfma_f32_16x16x32_bf16 v[20:23], v[116:119], v[64:67], v[20:23]
  ds_read_b128 v[52:55], v6 offset:36864
  v_mfma_f32_16x16x32_bf16 v[24:27], v[116:119], v[68:71], v[24:27]
  ds_read_b128 v[56:59], v6 offset:38912
  v_mfma_f32_16x16x32_bf16 v[28:31], v[116:119], v[72:75], v[28:31]
  ds_write_b128 v12, v[228:231] offset:40960
  buffer_load_dwordx4 v[116:119], v8, s[32:35], s57 offen sc1
  s_add_u32 s57, s57, 7168
  s_waitcnt vmcnt(8) lgkmcnt(6)
  v_mfma_f32_16x16x32_bf16 v[16:19], v[120:123], v[76:79], v[16:19]
  ds_read_b128 v[60:63], v7 offset:32768
  ds_read_b128 v[64:67], v7 offset:34816
  v_mfma_f32_16x16x32_bf16 v[20:23], v[120:123], v[80:83], v[20:23]
  ds_read_b128 v[68:71], v7 offset:36864
  v_mfma_f32_16x16x32_bf16 v[24:27], v[120:123], v[84:87], v[24:27]
  ds_read_b128 v[72:75], v7 offset:38912
  v_mfma_f32_16x16x32_bf16 v[28:31], v[120:123], v[88:91], v[28:31]
  ds_write_b128 v12, v[232:235] offset:49152
  buffer_load_dwordx4 v[120:123], v8, s[32:35], s57 offen sc1
  s_add_u32 s57, s57, 7168
  buffer_load_dwordx4 v[172:175], v2, s[32:35], s53 offen offset:1024 sc1
  s_waitcnt vmcnt(9) lgkmcnt(6)
  v_mfma_f32_16x16x32_bf16 v[16:19], v[92:95], v[44:47], v[16:19]
  ds_read_b128 v[76:79], v6 offset:40960
  ds_read_b128 v[80:83], v6 offset:43008
  v_mfma_f32_16x16x32_bf16 v[20:23], v[92:95], v[48:51], v[20:23]
  ds_read_b128 v[84:87], v6 offset:45056
  v_mfma_f32_16x16x32_bf16 v[24:27], v[92:95], v[52:55], v[24:27]
  ds_read_b128 v[88:91], v6 offset:47104
  v_mfma_f32_16x16x32_bf16 v[28:31], v[92:95], v[56:59], v[28:31]
  ds_write_b128 v12, v[236:239] offset:57344
  buffer_load_dwordx4 v[92:95], v8, s[32:35], s57 offen sc1
  s_add_u32 s57, s57, 7168
  s_waitcnt vmcnt(9) lgkmcnt(6)
  v_mfma_f32_16x16x32_bf16 v[16:19], v[96:99], v[60:63], v[16:19]
  ds_read_b128 v[44:47], v7 offset:40960
  v_mfma_f32_16x16x32_bf16 v[20:23], v[96:99], v[64:67], v[20:23]
  ds_read_b128 v[48:51], v7 offset:43008
  v_mfma_f32_16x16x32_bf16 v[24:27], v[96:99], v[68:71], v[24:27]
  ds_read_b128 v[52:55], v7 offset:45056
  v_mfma_f32_16x16x32_bf16 v[28:31], v[96:99], v[72:75], v[28:31]
  ds_read_b128 v[56:59], v7 offset:47104
  buffer_load_dwordx4 v[96:99], v8, s[32:35], s57 offen sc1
  s_add_u32 s57, s57, 7168
  s_waitcnt vmcnt(9) lgkmcnt(5)
  v_mfma_f32_16x16x32_bf16 v[16:19], v[100:103], v[76:79], v[16:19]
  ds_read_b128 v[60:63], v6 offset:49152
  v_mfma_f32_16x16x32_bf16 v[20:23], v[100:103], v[80:83], v[20:23]
  ds_read_b128 v[64:67], v6 offset:51200
  v_mfma_f32_16x16x32_bf16 v[24:27], v[100:103], v[84:87], v[24:27]
  ds_read_b128 v[68:71], v6 offset:53248
  v_mfma_f32_16x16x32_bf16 v[28:31], v[100:103], v[88:91], v[28:31]
  ds_read_b128 v[72:75], v6 offset:55296
  buffer_load_dwordx4 v[100:103], v8, s[32:35], s57 offen sc1
  s_add_u32 s57, s57, 7168
  s_waitcnt vmcnt(8) lgkmcnt(4)
  v_mfma_f32_16x16x32_bf16 v[16:19], v[104:107], v[44:47], v[16:19]
  ds_read_b128 v[76:79], v7 offset:49152
  v_mfma_f32_16x16x32_bf16 v[20:23], v[104:107], v[48:51], v[20:23]
  ds_read_b128 v[80:83], v7 offset:51200
  v_mfma_f32_16x16x32_bf16 v[24:27], v[104:107], v[52:55], v[24:27]
  ds_read_b128 v[84:87], v7 offset:53248
  v_mfma_f32_16x16x32_bf16 v[28:31], v[104:107], v[56:59], v[28:31]
  ds_read_b128 v[88:91], v7 offset:55296
  buffer_load_dwordx4 v[104:107], v8, s[32:35], s57 offen sc1
  s_add_u32 s57, s57, 7168
  s_waitcnt vmcnt(8) lgkmcnt(4)
  v_mfma_f32_16x16x32_bf16 v[16:19], v[108:111], v[60:63], v[16:19]
  ds_read_b128 v[44:47], v6 offset:57344
  v_mfma_f32_16x16x32_bf16 v[20:23], v[108:111], v[64:67], v[20:23]
  ds_read_b128 v[48:51], v6 offset:59392
  v_mfma_f32_16x16x32_bf16 v[24:27], v[108:111], v[68:71], v[24:27]
  ds_read_b128 v[52:55], v6 offset:61440
  v_mfma_f32_16x16x32_bf16 v[28:31], v[108:111], v[72:75], v[28:31]
  ds_read_b128 v[56:59], v6 offset:63488
  buffer_load_dwordx4 v[108:111], v8, s[32:35], s57 offen sc1
  s_add_u32 s57, s57, 7168
  buffer_load_dwordx4 v[176:179], v10, s[32:35], s53 offen offset:2048 sc1
  s_waitcnt vmcnt(9) lgkmcnt(4)
  s_waitcnt lgkmcnt(15)
  s_barrier
  v_mfma_f32_16x16x32_bf16 v[16:19], v[112:115], v[76:79], v[16:19]
  ds_read_b128 v[60:63], v7 offset:57344
  v_mfma_f32_16x16x32_bf16 v[20:23], v[112:115], v[80:83], v[20:23]
  ds_read_b128 v[64:67], v7 offset:59392
  v_mfma_f32_16x16x32_bf16 v[24:27], v[112:115], v[84:87], v[24:27]
  ds_read_b128 v[68:71], v7 offset:61440
  v_mfma_f32_16x16x32_bf16 v[28:31], v[112:115], v[88:91], v[28:31]
  ds_read_b128 v[72:75], v7 offset:63488
  buffer_load_dwordx4 v[112:115], v8, s[32:35], s57 offen sc1
  s_add_u32 s57, s57, 7168
  s_waitcnt vmcnt(9) lgkmcnt(4)
  v_mfma_f32_16x16x32_bf16 v[16:19], v[116:119], v[44:47], v[16:19]
  ds_read_b128 v[76:79], v4 offset:0
  v_mfma_f32_16x16x32_bf16 v[20:23], v[116:119], v[48:51], v[20:23]
  ds_read_b128 v[80:83], v4 offset:2048
  v_mfma_f32_16x16x32_bf16 v[24:27], v[116:119], v[52:55], v[24:27]
  ds_read_b128 v[84:87], v4 offset:4096
  v_mfma_f32_16x16x32_bf16 v[28:31], v[116:119], v[56:59], v[28:31]
  ds_read_b128 v[88:91], v4 offset:6144
  buffer_load_dwordx4 v[116:119], v8, s[32:35], s57 offen sc1
  s_add_u32 s57, s57, 7168
  s_waitcnt vmcnt(9) lgkmcnt(4)
  v_mfma_f32_16x16x32_bf16 v[16:19], v[120:123], v[60:63], v[16:19]
  ds_read_b128 v[44:47], v5 offset:0
  v_mfma_f32_16x16x32_bf16 v[20:23], v[120:123], v[64:67], v[20:23]
  ds_read_b128 v[48:51], v5 offset:2048
  v_mfma_f32_16x16x32_bf16 v[24:27], v[120:123], v[68:71], v[24:27]
  ds_read_b128 v[52:55], v5 offset:4096
  v_mfma_f32_16x16x32_bf16 v[28:31], v[120:123], v[72:75], v[28:31]
  ds_read_b128 v[56:59], v5 offset:6144
  buffer_load_dwordx4 v[120:123], v8, s[32:35], s57 offen sc1
  s_add_u32 s57, s57, 7168
  s_waitcnt vmcnt(8) lgkmcnt(4)
  s_barrier
  v_mfma_f32_16x16x32_bf16 v[16:19], v[92:95], v[76:79], v[16:19]
  ds_read_b128 v[60:63], v4 offset:8192
  v_mfma_f32_16x16x32_bf16 v[20:23], v[92:95], v[80:83], v[20:23]
  ds_read_b128 v[64:67], v4 offset:10240
  v_mfma_f32_16x16x32_bf16 v[24:27], v[92:95], v[84:87], v[24:27]
  ds_read_b128 v[68:71], v4 offset:12288
  v_mfma_f32_16x16x32_bf16 v[28:31], v[92:95], v[88:91], v[28:31]
  ds_read_b128 v[72:75], v4 offset:14336
  buffer_load_dwordx4 v[92:95], v8, s[32:35], s57 offen sc1
  s_add_u32 s57, s57, 7168
  s_add_u32 s53, s53, 5120
  buffer_load_dwordx4 v[180:183], v2, s[32:35], s53 offen offset:0 sc1
  s_waitcnt vmcnt(9) lgkmcnt(4)
  v_mfma_f32_16x16x32_bf16 v[16:19], v[96:99], v[44:47], v[16:19]
  ds_read_b128 v[76:79], v5 offset:8192
  ds_read_b128 v[80:83], v5 offset:10240
  v_mfma_f32_16x16x32_bf16 v[20:23], v[96:99], v[48:51], v[20:23]
  ds_read_b128 v[84:87], v5 offset:12288
  v_mfma_f32_16x16x32_bf16 v[24:27], v[96:99], v[52:55], v[24:27]
  ds_read_b128 v[88:91], v5 offset:14336
  v_mfma_f32_16x16x32_bf16 v[28:31], v[96:99], v[56:59], v[28:31]
  ds_write_b128 v13, v[124:127] offset:0
  buffer_load_dwordx4 v[96:99], v8, s[32:35], s57 offen sc1
  s_add_u32 s57, s57, 7168
  s_waitcnt vmcnt(9) lgkmcnt(5)
  v_mfma_f32_16x16x32_bf16 v[16:19], v[100:103], v[60:63], v[16:19]
  ds_read_b128 v[44:47], v4 offset:16384
  ds_read_b128 v[48:51], v4 offset:18432
  v_mfma_f32_16x16x32_bf16 v[20:23], v[100:103], v[64:67], v[20:23]
  ds_read_b128 v[52:55], v4 offset:20480
  v_mfma_f32_16x16x32_bf16 v[24:27], v[100:103], v[68:71], v[24:27]
  ds_read_b128 v[56:59], v4 offset:22528
  v_mfma_f32_16x16x32_bf16 v[28:31], v[100:103], v[72:75], v[28:31]
  ds_write_b128 v13, v[128:131] offset:8192
  buffer_load_dwordx4 v[100:103], v8, s[32:35], s57 offen sc1
  s_add_u32 s57, s57, 7168
  s_waitcnt vmcnt(9) lgkmcnt(6)
  v_mfma_f32_16x16x32_bf16 v[16:19], v[104:107], v[76:79], v[16:19]
  ds_read_b128 v[60:63], v5 offset:16384
  ds_read_b128 v[64:67], v5 offset:18432
  v_mfma_f32_16x16x32_bf16 v[20:23], v[104:107], v[80:83], v[20:23]
  ds_read_b128 v[68:71], v5 offset:20480
  v_mfma_f32_16x16x32_bf16 v[24:27], v[104:107], v[84:87], v[24:27]
  ds_read_b128 v[72:75], v5 offset:22528
  v_mfma_f32_16x16x32_bf16 v[28:31], v[104:107], v[88:91], v[28:31]
  ds_write_b128 v13, v[132:135] offset:16384
  buffer_load_dwordx4 v[104:107], v8, s[32:35], s57 offen sc1
  s_add_u32 s57, s57, 7168
  s_waitcnt vmcnt(9) lgkmcnt(6)
  v_mfma_f32_16x16x32_bf16 v[16:19], v[108:111], v[44:47], v[16:19]
  ds_read_b128 v[76:79], v4 offset:24576
  ds_read_b128 v[80:83], v4 offset:26624
  v_mfma_f32_16x16x32_bf16 v[20:23], v[108:111], v[48:51], v[20:23]
  ds_read_b128 v[84:87], v4 offset:28672
  v_mfma_f32_16x16x32_bf16 v[24:27], v[108:111], v[52:55], v[24:27]
  ds_read_b128 v[88:91], v4 offset:30720
  v_mfma_f32_16x16x32_bf16 v[28:31], v[108:111], v[56:59], v[28:31]
  ds_write_b128 v13, v[136:139] offset:24576
  buffer_load_dwordx4 v[108:111], v8, s[32:35], s57 offen sc1
  s_add_u32 s57, s57, 7168
  s_waitcnt vmcnt(8) lgkmcnt(6)
  v_mfma_f32_16x16x32_bf16 v[16:19], v[112:115], v[60:63], v[16:19]
  ds_read_b128 v[44:47], v5 offset:24576
  ds_read_b128 v[48:51], v5 offset:26624
  v_mfma_f32_16x16x32_bf16 v[20:23], v[112:115], v[64:67], v[20:23]
  ds_read_b128 v[52:55], v5 offset:28672
  v_mfma_f32_16x16x32_bf16 v[24:27], v[112:115], v[68:71], v[24:27]
  ds_read_b128 v[56:59], v5 offset:30720
  v_mfma_f32_16x16x32_bf16 v[28:31], v[112:115], v[72:75], v[28:31]
  ds_write_b128 v13, v[140:143] offset:32768
  buffer_load_dwordx4 v[112:115], v8, s[32:35], s57 offen sc1
  s_add_u32 s57, s57, 7168
  buffer_load_dwordx4 v[184:187], v2, s[32:35], s53 offen offset:1024 sc1
  s_waitcnt vmcnt(9) lgkmcnt(6)
  v_mfma_f32_16x16x32_bf16 v[16:19], v[116:119], v[76:79], v[16:19]
  ds_read_b128 v[60:63], v4 offset:32768
  ds_read_b128 v[64:67], v4 offset:34816
  v_mfma_f32_16x16x32_bf16 v[20:23], v[116:119], v[80:83], v[20:23]
  ds_read_b128 v[68:71], v4 offset:36864
  v_mfma_f32_16x16x32_bf16 v[24:27], v[116:119], v[84:87], v[24:27]
  ds_read_b128 v[72:75], v4 offset:38912
  v_mfma_f32_16x16x32_bf16 v[28:31], v[116:119], v[88:91], v[28:31]
  ds_write_b128 v13, v[144:147] offset:40960
  buffer_load_dwordx4 v[116:119], v8, s[32:35], s57 offen sc1
  s_add_u32 s57, s57, 7168
  s_waitcnt vmcnt(9) lgkmcnt(6)
  v_mfma_f32_16x16x32_bf16 v[16:19], v[120:123], v[44:47], v[16:19]
  ds_read_b128 v[76:79], v5 offset:32768
  ds_read_b128 v[80:83], v5 offset:34816
  v_mfma_f32_16x16x32_bf16 v[20:23], v[120:123], v[48:51], v[20:23]
  ds_read_b128 v[84:87], v5 offset:36864
  v_mfma_f32_16x16x32_bf16 v[24:27], v[120:123], v[52:55], v[24:27]
  ds_read_b128 v[88:91], v5 offset:38912
  v_mfma_f32_16x16x32_bf16 v[28:31], v[120:123], v[56:59], v[28:31]
  ds_write_b128 v13, v[148:151] offset:49152
  buffer_load_dwordx4 v[120:123], v8, s[32:35], s57 offen sc1
  s_add_u32 s57, s57, 7168
  s_waitcnt vmcnt(9) lgkmcnt(6)
  v_mfma_f32_16x16x32_bf16 v[16:19], v[92:95], v[60:63], v[16:19]
  ds_read_b128 v[44:47], v4 offset:40960
  ds_read_b128 v[48:51], v4 offset:43008
  v_mfma_f32_16x16x32_bf16 v[20:23], v[92:95], v[64:67], v[20:23]
  ds_read_b128 v[52:55], v4 offset:45056
  v_mfma_f32_16x16x32_bf16 v[24:27], v[92:95], v[68:71], v[24:27]
  ds_read_b128 v[56:59], v4 offset:47104
  v_mfma_f32_16x16x32_bf16 v[28:31], v[92:95], v[72:75], v[28:31]
  ds_write_b128 v13, v[152:155] offset:57344
  buffer_load_dwordx4 v[92:95], v8, s[32:35], s57 offen sc1
  s_add_u32 s57, s57, 7168
  s_waitcnt vmcnt(8) lgkmcnt(6)
  v_mfma_f32_16x16x32_bf16 v[16:19], v[96:99], v[76:79], v[16:19]
  ds_read_b128 v[60:63], v5 offset:40960
  v_mfma_f32_16x16x32_bf16 v[20:23], v[96:99], v[80:83], v[20:23]
  ds_read_b128 v[64:67], v5 offset:43008
  v_mfma_f32_16x16x32_bf16 v[24:27], v[96:99], v[84:87], v[24:27]
  ds_read_b128 v[68:71], v5 offset:45056
  v_mfma_f32_16x16x32_bf16 v[28:31], v[96:99], v[88:91], v[28:31]
  ds_read_b128 v[72:75], v5 offset:47104
  buffer_load_dwordx4 v[96:99], v8, s[32:35], s57 offen sc1
  s_add_u32 s57, s57, 7168
  s_waitcnt vmcnt(8) lgkmcnt(5)
  v_mfma_f32_16x16x32_bf16 v[16:19], v[100:103], v[44:47], v[16:19]
  ds_read_b128 v[76:79], v4 offset:49152
  v_mfma_f32_16x16x32_bf16 v[20:23], v[100:103], v[48:51], v[20:23]
  ds_read_b128 v[80:83], v4 offset:51200
  v_mfma_f32_16x16x32_bf16 v[24:27], v[100:103], v[52:55], v[24:27]
  ds_read_b128 v[84:87], v4 offset:53248
  v_mfma_f32_16x16x32_bf16 v[28:31], v[100:103], v[56:59], v[28:31]
  ds_read_b128 v[88:91], v4 offset:55296
  buffer_load_dwordx4 v[100:103], v8, s[32:35], s57 offen sc1
  s_add_u32 s57, s57, 7168
  buffer_load_dwordx4 v[188:191], v10, s[32:35], s53 offen offset:2048 sc1
  s_waitcnt vmcnt(9) lgkmcnt(4)
  v_mfma_f32_16x16x32_bf16 v[16:19], v[104:107], v[60:63], v[16:19]
  ds_read_b128 v[44:47], v5 offset:49152
  v_mfma_f32_16x16x32_bf16 v[20:23], v[104:107], v[64:67], v[20:23]
  ds_read_b128 v[48:51], v5 offset:51200
  v_mfma_f32_16x16x32_bf16 v[24:27], v[104:107], v[68:71], v[24:27]
  ds_read_b128 v[52:55], v5 offset:53248
  v_mfma_f32_16x16x32_bf16 v[28:31], v[104:107], v[72:75], v[28:31]
  ds_read_b128 v[56:59], v5 offset:55296
  buffer_load_dwordx4 v[104:107], v8, s[32:35], s57 offen sc1
  s_add_u32 s57, s57, 7168
  s_waitcnt vmcnt(9) lgkmcnt(4)
  v_mfma_f32_16x16x32_bf16 v[16:19], v[108:111], v[76:79], v[16:19]
  ds_read_b128 v[60:63], v4 offset:57344
  v_mfma_f32_16x16x32_bf16 v[20:23], v[108:111], v[80:83], v[20:23]
  ds_read_b128 v[64:67], v4 offset:59392
  v_mfma_f32_16x16x32_bf16 v[24:27], v[108:111], v[84:87], v[24:27]
  ds_read_b128 v[68:71], v4 offset:61440
  v_mfma_f32_16x16x32_bf16 v[28:31], v[108:111], v[88:91], v[28:31]
  ds_read_b128 v[72:75], v4 offset:63488
  buffer_load_dwordx4 v[108:111], v8, s[32:35], s57 offen sc1
  s_add_u32 s57, s57, 7168
  s_waitcnt vmcnt(9) lgkmcnt(4)
  s_waitcnt lgkmcnt(15)
  s_barrier
  v_mfma_f32_16x16x32_bf16 v[16:19], v[112:115], v[44:47], v[16:19]
  ds_read_b128 v[76:79], v5 offset:57344
  v_mfma_f32_16x16x32_bf16 v[20:23], v[112:115], v[48:51], v[20:23]
  ds_read_b128 v[80:83], v5 offset:59392
  v_mfma_f32_16x16x32_bf16 v[24:27], v[112:115], v[52:55], v[24:27]
  ds_read_b128 v[84:87], v5 offset:61440
  v_mfma_f32_16x16x32_bf16 v[28:31], v[112:115], v[56:59], v[28:31]
  ds_read_b128 v[88:91], v5 offset:63488
  buffer_load_dwordx4 v[112:115], v8, s[32:35], s57 offen sc1
  s_add_u32 s57, s57, 7168
  s_waitcnt vmcnt(8) lgkmcnt(4)
  v_mfma_f32_16x16x32_bf16 v[16:19], v[116:119], v[60:63], v[16:19]
  ds_read_b128 v[44:47], v6 offset:0
  v_mfma_f32_16x16x32_bf16 v[20:23], v[116:119], v[64:67], v[20:23]
  ds_read_b128 v[48:51], v6 offset:2048
  v_mfma_f32_16x16x32_bf16 v[24:27], v[116:119], v[68:71], v[24:27]
  ds_read_b128 v[52:55], v6 offset:4096
  v_mfma_f32_16x16x32_bf16 v[28:31], v[116:119], v[72:75], v[28:31]
  ds_read_b128 v[56:59], v6 offset:6144
  buffer_load_dwordx4 v[116:119], v8, s[32:35], s57 offen sc1
  s_add_u32 s57, s57, 7168
  s_waitcnt vmcnt(8) lgkmcnt(4)
  v_mfma_f32_16x16x32_bf16 v[16:19], v[120:123], v[76:79], v[16:19]
  ds_read_b128 v[60:63], v7 offset:0
  v_mfma_f32_16x16x32_bf16 v[20:23], v[120:123], v[80:83], v[20:23]
  ds_read_b128 v[64:67], v7 offset:2048
  v_mfma_f32_16x16x32_bf16 v[24:27], v[120:123], v[84:87], v[24:27]
  ds_read_b128 v[68:71], v7 offset:4096
  v_mfma_f32_16x16x32_bf16 v[28:31], v[120:123], v[88:91], v[28:31]
  ds_read_b128 v[72:75], v7 offset:6144
  buffer_load_dwordx4 v[120:123], v8, s[32:35], s57 offen sc1
  s_add_u32 s57, s57, 7168
  s_add_u32 s53, s53, 5120
  buffer_load_dwordx4 v[192:195], v2, s[32:35], s53 offen offset:0 sc1
  s_waitcnt vmcnt(9) lgkmcnt(4)
  v_mfma_f32_16x16x32_bf16 v[16:19], v[92:95], v[44:47], v[16:19]
  ds_read_b128 v[76:79], v6 offset:8192
  v_mfma_f32_16x16x32_bf16 v[20:23], v[92:95], v[48:51], v[20:23]
  ds_read_b128 v[80:83], v6 offset:10240
  v_mfma_f32_16x16x32_bf16 v[24:27], v[92:95], v[52:55], v[24:27]
  ds_read_b128 v[84:87], v6 offset:12288
  v_mfma_f32_16x16x32_bf16 v[28:31], v[92:95], v[56:59], v[28:31]
  ds_read_b128 v[88:91], v6 offset:14336
  buffer_load_dwordx4 v[92:95], v8, s[32:35], s57 offen sc1
  s_add_u32 s57, s57, 7168
  s_waitcnt vmcnt(9) lgkmcnt(4)
  v_mfma_f32_16x16x32_bf16 v[16:19], v[96:99], v[60:63], v[16:19]
  ds_read_b128 v[44:47], v7 offset:8192
  v_mfma_f32_16x16x32_bf16 v[20:23], v[96:99], v[64:67], v[20:23]
  ds_read_b128 v[48:51], v7 offset:10240
  v_mfma_f32_16x16x32_bf16 v[24:27], v[96:99], v[68:71], v[24:27]
  ds_read_b128 v[52:55], v7 offset:12288
  v_mfma_f32_16x16x32_bf16 v[28:31], v[96:99], v[72:75], v[28:31]
  ds_read_b128 v[56:59], v7 offset:14336
  buffer_load_dwordx4 v[96:99], v8, s[32:35], s57 offen sc1
  s_add_u32 s57, s57, 7168
  s_waitcnt vmcnt(9) lgkmcnt(4)
  v_mfma_f32_16x16x32_bf16 v[16:19], v[100:103], v[76:79], v[16:19]
  ds_read_b128 v[60:63], v6 offset:16384
  v_mfma_f32_16x16x32_bf16 v[20:23], v[100:103], v[80:83], v[20:23]
  ds_read_b128 v[64:67], v6 offset:18432
  v_mfma_f32_16x16x32_bf16 v[24:27], v[100:103], v[84:87], v[24:27]
  ds_read_b128 v[68:71], v6 offset:20480
  v_mfma_f32_16x16x32_bf16 v[28:31], v[100:103], v[88:91], v[28:31]
  ds_read_b128 v[72:75], v6 offset:22528
  buffer_load_dwordx4 v[100:103], v8, s[32:35], s57 offen sc1
  s_add_u32 s57, s57, 7168
  s_waitcnt vmcnt(8) lgkmcnt(4)
  v_mfma_f32_16x16x32_bf16 v[16:19], v[104:107], v[44:47], v[16:19]
  ds_read_b128 v[76:79], v7 offset:16384
  v_mfma_f32_16x16x32_bf16 v[20:23], v[104:107], v[48:51], v[20:23]
  ds_read_b128 v[80:83], v7 offset:18432
  v_mfma_f32_16x16x32_bf16 v[24:27], v[104:107], v[52:55], v[24:27]
  ds_read_b128 v[84:87], v7 offset:20480
  v_mfma_f32_16x16x32_bf16 v[28:31], v[104:107], v[56:59], v[28:31]
  ds_read_b128 v[88:91], v7 offset:22528
  buffer_load_dwordx4 v[104:107], v8, s[32:35], s57 offen sc1
  s_add_u32 s57, s57, 7168
  s_waitcnt vmcnt(8) lgkmcnt(4)
  v_mfma_f32_16x16x32_bf16 v[16:19], v[108:111], v[60:63], v[16:19]
  ds_read_b128 v[44:47], v6 offset:24576
  v_mfma_f32_16x16x32_bf16 v[20:23], v[108:111], v[64:67], v[20:23]
  ds_read_b128 v[48:51], v6 offset:26624
  v_mfma_f32_16x16x32_bf16 v[24:27], v[108:111], v[68:71], v[24:27]
  ds_read_b128 v[52:55], v6 offset:28672
  v_mfma_f32_16x16x32_bf16 v[28:31], v[108:111], v[72:75], v[28:31]
  ds_read_b128 v[56:59], v6 offset:30720
  buffer_load_dwordx4 v[108:111], v8, s[32:35], s57 offen sc1
  s_add_u32 s57, s57, 7168
  s_waitcnt vmcnt(8) lgkmcnt(4)
  v_mfma_f32_16x16x32_bf16 v[16:19], v[112:115], v[76:79], v[16:19]
  ds_read_b128 v[60:63], v7 offset:24576
  v_mfma_f32_16x16x32_bf16 v[20:23], v[112:115], v[80:83], v[20:23]
  ds_read_b128 v[64:67], v7 offset:26624
  v_mfma_f32_16x16x32_bf16 v[24:27], v[112:115], v[84:87], v[24:27]
  ds_read_b128 v[68:71], v7 offset:28672
  v_mfma_f32_16x16x32_bf16 v[28:31], v[112:115], v[88:91], v[28:31]
  ds_read_b128 v[72:75], v7 offset:30720
  buffer_load_dwordx4 v[112:115], v8, s[32:35], s57 offen sc1
  s_add_u32 s57, s57, 7168
  s_waitcnt vmcnt(8) lgkmcnt(4)
  v_mfma_f32_16x16x32_bf16 v[16:19], v[116:119], v[44:47], v[16:19]
  ds_read_b128 v[76:79], v6 offset:32768
  v_mfma_f32_16x16x32_bf16 v[20:23], v[116:119], v[48:51], v[20:23]
  ds_read_b128 v[80:83], v6 offset:34816
  v_mfma_f32_16x16x32_bf16 v[24:27], v[116:119], v[52:55], v[24:27]
  ds_read_b128 v[84:87], v6 offset:36864
  v_mfma_f32_16x16x32_bf16 v[28:31], v[116:119], v[56:59], v[28:31]
  ds_read_b128 v[88:91], v6 offset:38912
  buffer_load_dwordx4 v[116:119], v8, s[32:35], s57 offen sc1
  s_add_u32 s57, s57, 7168
  s_waitcnt vmcnt(8) lgkmcnt(4)
  v_mfma_f32_16x16x32_bf16 v[16:19], v[120:123], v[60:63], v[16:19]
  ds_read_b128 v[44:47], v7 offset:32768
  v_mfma_f32_16x16x32_bf16 v[20:23], v[120:123], v[64:67], v[20:23]
  ds_read_b128 v[48:51], v7 offset:34816
  v_mfma_f32_16x16x32_bf16 v[24:27], v[120:123], v[68:71], v[24:27]
  ds_read_b128 v[52:55], v7 offset:36864
  v_mfma_f32_16x16x32_bf16 v[28:31], v[120:123], v[72:75], v[28:31]
  ds_read_b128 v[56:59], v7 offset:38912
  buffer_load_dwordx4 v[120:123], v8, s[32:35], s57 offen sc1
  s_add_u32 s57, s57, 7168
  s_waitcnt vmcnt(7) lgkmcnt(4)
  v_mfma_f32_16x16x32_bf16 v[16:19], v[92:95], v[76:79], v[16:19]
  ds_read_b128 v[60:63], v6 offset:40960
  v_mfma_f32_16x16x32_bf16 v[20:23], v[92:95], v[80:83], v[20:23]
  ds_read_b128 v[64:67], v6 offset:43008
  v_mfma_f32_16x16x32_bf16 v[24:27], v[92:95], v[84:87], v[24:27]
  ds_read_b128 v[68:71], v6 offset:45056
  v_mfma_f32_16x16x32_bf16 v[28:31], v[92:95], v[88:91], v[28:31]
  ds_read_b128 v[72:75], v6 offset:47104
  buffer_load_dwordx4 v[196:199], v2, s[32:35], s53 offen offset:1024 sc1
  s_waitcnt vmcnt(7) lgkmcnt(4)
  v_mfma_f32_16x16x32_bf16 v[16:19], v[96:99], v[44:47], v[16:19]
  ds_read_b128 v[76:79], v7 offset:40960
  v_mfma_f32_16x16x32_bf16 v[20:23], v[96:99], v[48:51], v[20:23]
  ds_read_b128 v[80:83], v7 offset:43008
  v_mfma_f32_16x16x32_bf16 v[24:27], v[96:99], v[52:55], v[24:27]
  ds_read_b128 v[84:87], v7 offset:45056
  v_mfma_f32_16x16x32_bf16 v[28:31], v[96:99], v[56:59], v[28:31]
  ds_read_b128 v[88:91], v7 offset:47104
  buffer_load_dwordx4 v[200:203], v10, s[32:35], s53 offen offset:2048 sc1
  s_waitcnt vmcnt(7) lgkmcnt(4)
  v_mfma_f32_16x16x32_bf16 v[16:19], v[100:103], v[60:63], v[16:19]
  ds_read_b128 v[44:47], v6 offset:49152
  v_mfma_f32_16x16x32_bf16 v[20:23], v[100:103], v[64:67], v[20:23]
  ds_read_b128 v[48:51], v6 offset:51200
  v_mfma_f32_16x16x32_bf16 v[24:27], v[100:103], v[68:71], v[24:27]
  ds_read_b128 v[52:55], v6 offset:53248
  v_mfma_f32_16x16x32_bf16 v[28:31], v[100:103], v[72:75], v[28:31]
  ds_read_b128 v[56:59], v6 offset:55296
  s_add_u32 s53, s53, 5120
  buffer_load_dwordx4 v[204:207], v2, s[32:35], s53 offen offset:0 sc1
  s_waitcnt vmcnt(7) lgkmcnt(4)
  v_mfma_f32_16x16x32_bf16 v[16:19], v[104:107], v[76:79], v[16:19]
  ds_read_b128 v[60:63], v7 offset:49152
  v_mfma_f32_16x16x32_bf16 v[20:23], v[104:107], v[80:83], v[20:23]
  ds_read_b128 v[64:67], v7 offset:51200
  v_mfma_f32_16x16x32_bf16 v[24:27], v[104:107], v[84:87], v[24:27]
  ds_read_b128 v[68:71], v7 offset:53248
  v_mfma_f32_16x16x32_bf16 v[28:31], v[104:107], v[88:91], v[28:31]
  ds_read_b128 v[72:75], v7 offset:55296
  buffer_load_dwordx4 v[208:211], v2, s[32:35], s53 offen offset:1024 sc1
  s_waitcnt vmcnt(7) lgkmcnt(4)
  v_mfma_f32_16x16x32_bf16 v[16:19], v[108:111], v[44:47], v[16:19]
  ds_read_b128 v[76:79], v6 offset:57344
  v_mfma_f32_16x16x32_bf16 v[20:23], v[108:111], v[48:51], v[20:23]
  ds_read_b128 v[80:83], v6 offset:59392
  v_mfma_f32_16x16x32_bf16 v[24:27], v[108:111], v[52:55], v[24:27]
  ds_read_b128 v[84:87], v6 offset:61440
  v_mfma_f32_16x16x32_bf16 v[28:31], v[108:111], v[56:59], v[28:31]
  ds_read_b128 v[88:91], v6 offset:63488
  buffer_load_dwordx4 v[212:215], v10, s[32:35], s53 offen offset:2048 sc1
  s_waitcnt vmcnt(7) lgkmcnt(4)
  v_mfma_f32_16x16x32_bf16 v[16:19], v[112:115], v[60:63], v[16:19]
  ds_read_b128 v[44:47], v7 offset:57344
  v_mfma_f32_16x16x32_bf16 v[20:23], v[112:115], v[64:67], v[20:23]
  ds_read_b128 v[48:51], v7 offset:59392
  v_mfma_f32_16x16x32_bf16 v[24:27], v[112:115], v[68:71], v[24:27]
  ds_read_b128 v[52:55], v7 offset:61440
  v_mfma_f32_16x16x32_bf16 v[28:31], v[112:115], v[72:75], v[28:31]
  ds_read_b128 v[56:59], v7 offset:63488
  s_add_u32 s53, s53, 5120
  buffer_load_dwordx4 v[216:219], v2, s[32:35], s53 offen offset:0 sc1
  s_waitcnt vmcnt(7) lgkmcnt(4)
  v_mfma_f32_16x16x32_bf16 v[16:19], v[116:119], v[76:79], v[16:19]
  v_mfma_f32_16x16x32_bf16 v[20:23], v[116:119], v[80:83], v[20:23]
  v_mfma_f32_16x16x32_bf16 v[24:27], v[116:119], v[84:87], v[24:27]
  v_mfma_f32_16x16x32_bf16 v[28:31], v[116:119], v[88:91], v[28:31]
  buffer_load_dwordx4 v[220:223], v2, s[32:35], s53 offen offset:1024 sc1
  s_waitcnt vmcnt(7) lgkmcnt(0)
  v_mfma_f32_16x16x32_bf16 v[16:19], v[120:123], v[44:47], v[16:19]
  v_mfma_f32_16x16x32_bf16 v[20:23], v[120:123], v[48:51], v[20:23]
  v_mfma_f32_16x16x32_bf16 v[24:27], v[120:123], v[52:55], v[24:27]
  v_mfma_f32_16x16x32_bf16 v[28:31], v[120:123], v[56:59], v[28:31]
  buffer_load_dwordx4 v[224:227], v10, s[32:35], s53 offen offset:2048 sc1
  v_lshrrev_b32 v40, 4, v1
  v_lshlrev_b32 v40, 4, v40
  s_mul_i32 s51, s97, 192
  s_add_u32 s51, s51, 16384
  v_add_u32 v40, s51, v40
  ds_read_b128 v[136:139], v40 offset:0
  ds_read_b128 v[140:143], v40 offset:64
  ds_read_b128 v[144:147], v40 offset:128
  v_lshlrev_b32 v36, 16, v246
  v_and_b32 v37, 0xffff0000, v246
  v_lshlrev_b32 v38, 16, v247
  v_and_b32 v39, 0xffff0000, v247
  v_add_f32 v16, v16, v32
  v_add_f32 v17, v17, v32
  v_add_f32 v18, v18, v32
  v_add_f32 v19, v19, v32
  v_mul_f32 v16, v16, v36
  v_mul_f32 v17, v17, v37
  v_mul_f32 v18, v18, v38
  v_mul_f32 v19, v19, v39
  v_cvt_pk_bf16_f32 v44, v16, v17
  v_cvt_pk_bf16_f32 v45, v18, v19
  v_lshlrev_b32 v36, 16, v248
  v_and_b32 v37, 0xffff0000, v248
  v_lshlrev_b32 v38, 16, v249
  v_and_b32 v39, 0xffff0000, v249
  v_add_f32 v20, v20, v33
  v_add_f32 v21, v21, v33
  v_add_f32 v22, v22, v33
  v_add_f32 v23, v23, v33
  v_mul_f32 v20, v20, v36
  v_mul_f32 v21, v21, v37
  v_mul_f32 v22, v22, v38
  v_mul_f32 v23, v23, v39
  v_cvt_pk_bf16_f32 v46, v20, v21
  v_cvt_pk_bf16_f32 v47, v22, v23
  v_lshlrev_b32 v36, 16, v250
  v_and_b32 v37, 0xffff0000, v250
  v_lshlrev_b32 v38, 16, v251
  v_and_b32 v39, 0xffff0000, v251
  v_add_f32 v24, v24, v34
  v_add_f32 v25, v25, v34
  v_add_f32 v26, v26, v34
  v_add_f32 v27, v27, v34
  v_mul_f32 v24, v24, v36
  v_mul_f32 v25, v25, v37
  v_mul_f32 v26, v26, v38
  v_mul_f32 v27, v27, v39
  v_cvt_pk_bf16_f32 v48, v24, v25
  v_cvt_pk_bf16_f32 v49, v26, v27
  v_lshlrev_b32 v36, 16, v252
  v_and_b32 v37, 0xffff0000, v252
  v_lshlrev_b32 v38, 16, v253
  v_and_b32 v39, 0xffff0000, v253
  v_add_f32 v28, v28, v35
  v_add_f32 v29, v29, v35
  v_add_f32 v30, v30, v35
  v_add_f32 v31, v31, v35
  v_mul_f32 v28, v28, v36
  v_mul_f32 v29, v29, v37
  v_mul_f32 v30, v30, v38
  v_mul_f32 v31, v31, v39
  v_cvt_pk_bf16_f32 v50, v28, v29
  v_cvt_pk_bf16_f32 v51, v30, v31
  v_and_b32 v36, 31, v1
  v_lshlrev_b32 v36, 4, v36
  v_lshrrev_b32 v37, 5, v1
  v_lshl_add_u32 v36, v37, 10, v36
  s_cmp_lt_u32 s46, s55
  s_cselect_b32 s51, 0, 0x40000000
  v_add_u32 v36, s51, v36
  s_mul_i32 s51, s45, 14
  s_cmp_eq_u32 s45, 7
  s_cselect_b32 s51, 96, s51
  s_lshl_b32 s52, s46, 1
  s_add_u32 s51, s51, s52
  s_lshl_b32 s51, s51, 10
  s_mul_i32 s52, s44, 110592
  s_add_u32 s51, s51, s52
  s_add_u32 s51, s51, 23068672
  v_permlane16_swap_b32 v44, v46
  v_permlane16_swap_b32 v45, v47
  v_permlane16_swap_b32 v48, v50
  v_permlane16_swap_b32 v49, v51
  buffer_store_dwordx4 v[44:47], v36, s[32:35], s51 offen offset:0 sc1
  buffer_store_dwordx4 v[48:51], v36, s[32:35], s51 offen offset:512 sc1
  s_add_u32 s53, s53, 5120
  s_cmp_eq_u32 s96, 3
  s_cselect_b32 s52, 0x40000000, 0
  v_or_b32 v10, s52, v10
  v_or_b32 v11, s52, v2
  buffer_load_dwordx4 v[228:231], v11, s[32:35], s53 offen offset:0 sc1
  buffer_load_dwordx4 v[232:235], v11, s[32:35], s53 offen offset:1024 sc1
  buffer_load_dwordx4 v[236:239], v10, s[32:35], s53 offen offset:2048 sc1
  s_waitcnt vmcnt(3) lgkmcnt(0)
  s_barrier
  s_branch L_join_120
L_svc_119:
  v_and_b32 v16, 31, v1
  v_lshlrev_b32 v16, 7, v16
  s_lshl_b32 s51, s45, 12
  s_add_u32 s51, s51, 884736
  v_add_u32 v16, s51, v16
  s_add_u32 s59, s31, 98304
  v_add_u32 v12, s59, v2
  v_xor_b32 v13, 0x10000, v12
  s_mov_b32 s61, 0
L_poll_121:
  buffer_load_dword v17, v16, s[32:35], 0 offen sc1
L_pchk_123:
  s_waitcnt vmcnt(0)
  v_cmp_ne_u32 vcc, s47, v17
  s_nop 1
  s_cmp_eq_u64 vcc, 0
  s_cbranch_scc1 L_pdone_122
  s_add_u32 s61, s61, 1
  s_cmp_lt_u32 s61, 40000
  s_cbranch_scc1 L_poll_121
L_pdone_122:
  s_waitcnt lgkmcnt(0)
  s_barrier
  s_mul_i32 s51, s45, 458752
  s_and_b32 s52, s44, 7
  s_lshl_b32 s52, s52, 13
  s_add_u32 s51, s51, s52
  s_add_u32 s51, s51, 19398656
  v_lshlrev_b32 v16, 7, v1
  s_barrier
  ds_write_b128 v12, v[208:211] offset:0
  ds_write_b128 v12, v[212:215] offset:8192
  ds_write_b128 v12, v[216:219] offset:16384
  ds_write_b128 v12, v[220:223] offset:24576
  ds_write_b128 v12, v[224:227] offset:32768
  ds_write_b128 v12, v[228:231] offset:40960
  ds_write_b128 v12, v[232:235] offset:49152
  ds_write_b128 v12, v[236:239] offset:57344
  v_min_u32 v40, 19, v1
  v_lshlrev_b32 v40, 4, v40
  s_mul_i32 s54, s45, 320
  s_add_u32 s54, s54, 73216
  s_add_u32 s55, s54, 10240
  s_mov_b32 s61, 0
  s_mov_b32 s60, 0x0c0c0400
L_tl_124:
  buffer_load_dwordx4 v[44:47], v40, s[32:35], s54 offen sc1
  buffer_load_dwordx4 v[48:51], v40, s[32:35], s55 offen sc1
  s_waitcnt vmcnt(0)
L_tc_126:
  v_perm_b32 v42, v45, v44, s60
  v_perm_b32 v43, v47, v46, s60
  v_lshl_or_b32 v42, v43, 16, v42
  v_cmp_ne_u32 vcc, s47, v42
  v_perm_b32 v42, v49, v48, s60
  v_perm_b32 v43, v51, v50, s60
  v_lshl_or_b32 v42, v43, 16, v42
  v_cmp_ne_u32 s[58:59], s47, v42
  s_nop 1
  s_or_b64 vcc, vcc, s[58:59]
  s_cmp_eq_u64 vcc, 0
  s_cbranch_scc1 L_td_125
  s_add_u32 s61, s61, 1
  s_cmp_lt_u32 s61, 40000
  s_cbranch_scc1 L_tl_124
L_td_125:
  v_and_b32 v44, 0xffffff00, v44
  v_and_b32 v45, 0xffffff00, v45
  v_and_b32 v46, 0xffffff00, v46
  v_and_b32 v47, 0xffffff00, v47
  v_and_b32 v48, 0xffffff00, v48
  v_and_b32 v49, 0xffffff00, v49
  v_and_b32 v50, 0xffffff00, v50
  v_and_b32 v51, 0xffffff00, v51
  v_add_f32 v44, v44, v48
  v_add_f32 v45, v45, v49
  v_add_f32 v46, v46, v50
  v_add_f32 v47, v47, v51
  v_cvt_pk_bf16_f32 v48, v44, v45
  v_cvt_pk_bf16_f32 v49, v46, v47
  v_lshlrev_b32 v44, 16, v48
  v_and_b32 v45, 0xffff0000, v48
  v_lshlrev_b32 v46, 16, v49
  v_and_b32 v47, 0xffff0000, v49
  v_add_u32 v40, 16384, v40
  ds_write_b128 v40, v[44:47]
  s_waitcnt lgkmcnt(0)
  s_barrier
  s_barrier
  ds_write_b128 v13, v[124:127] offset:0
  ds_write_b128 v13, v[128:131] offset:8192
  ds_write_b128 v13, v[132:135] offset:16384
  ds_write_b128 v13, v[136:139] offset:24576
  ds_write_b128 v13, v[140:143] offset:32768
  ds_write_b128 v13, v[144:147] offset:40960
  ds_write_b128 v13, v[148:151] offset:49152
  ds_write_b128 v13, v[152:155] offset:57344
  s_waitcnt lgkmcnt(0)
  s_barrier
  v_lshrrev_b32 v16, 4, v1
  v_lshlrev_b32 v16, 4, v16
  s_mul_i32 s51, s97, 192
  s_add_u32 s51, s51, 16384
  v_add_u32 v16, s51, v16
  ds_read_b128 v[136:139], v16 offset:0
  ds_read_b128 v[140:143], v16 offset:64
  ds_read_b128 v[144:147], v16 offset:128
  s_mul_i32 s53, s45, 27
  s_mul_i32 s52, s96, 7
  s_add_u32 s53, s53, s52
  s_mul_i32 s53, s53, 5120
  s_mul_i32 s52, s97, 3072
  s_add_u32 s53, s53, s52
  s_add_u32 s53, s53, 7077888
  s_lshl_b32 s52, s97, 30
  v_add_u32 v10, s52, v2
  buffer_load_dwordx4 v[156:159], v2, s[32:35], s53 offen offset:0 sc1
  buffer_load_dwordx4 v[160:163], v2, s[32:35], s53 offen offset:1024 sc1
  buffer_load_dwordx4 v[164:167], v10, s[32:35], s53 offen offset:2048 sc1
  s_add_u32 s53, s53, 5120
  buffer_load_dwordx4 v[168:171], v2, s[32:35], s53 offen offset:0 sc1
  buffer_load_dwordx4 v[172:175], v2, s[32:35], s53 offen offset:1024 sc1
  buffer_load_dwordx4 v[176:179], v10, s[32:35], s53 offen offset:2048 sc1
  s_add_u32 s53, s53, 5120
  buffer_load_dwordx4 v[180:183], v2, s[32:35], s53 offen offset:0 sc1
  buffer_load_dwordx4 v[184:187], v2, s[32:35], s53 offen offset:1024 sc1
  buffer_load_dwordx4 v[188:191], v10, s[32:35], s53 offen offset:2048 sc1
  s_add_u32 s53, s53, 5120
  buffer_load_dwordx4 v[192:195], v2, s[32:35], s53 offen offset:0 sc1
  buffer_load_dwordx4 v[196:199], v2, s[32:35], s53 offen offset:1024 sc1
  buffer_load_dwordx4 v[200:203], v10, s[32:35], s53 offen offset:2048 sc1
  s_add_u32 s53, s53, 5120
  buffer_load_dwordx4 v[204:207], v2, s[32:35], s53 offen offset:0 sc1
  buffer_load_dwordx4 v[208:211], v2, s[32:35], s53 offen offset:1024 sc1
  buffer_load_dwordx4 v[212:215], v10, s[32:35], s53 offen offset:2048 sc1
  s_add_u32 s53, s53, 5120
  buffer_load_dwordx4 v[216:219], v2, s[32:35], s53 offen offset:0 sc1
  buffer_load_dwordx4 v[220:223], v2, s[32:35], s53 offen offset:1024 sc1
  buffer_load_dwordx4 v[224:227], v10, s[32:35], s53 offen offset:2048 sc1
  s_add_u32 s53, s53, 5120
  s_cmp_eq_u32 s96, 3
  s_cselect_b32 s52, 0x40000000, 0
  v_or_b32 v10, s52, v10
  v_or_b32 v11, s52, v2
  buffer_load_dwordx4 v[228:231], v11, s[32:35], s53 offen offset:0 sc1
  buffer_load_dwordx4 v[232:235], v11, s[32:35], s53 offen offset:1024 sc1
  buffer_load_dwordx4 v[236:239], v10, s[32:35], s53 offen offset:2048 sc1
  s_add_u32 s53, s53, 5120
  s_lshl_b32 s54, s44, 10
  s_lshl_b32 s52, s45, 7
  s_add_u32 s54, s54, s52
  s_add_u32 s54, s54, 983040
  s_waitcnt lgkmcnt(0)
  s_barrier
  s_mov_b64 exec, 1
  buffer_store_dword v3, off, s[32:35], s54 sc1
  s_mov_b64 exec, -1
L_join_120:
  s_add_u32 s52, s96, 0
  s_and_b32 s64, s52, 3
  s_lshl_b32 s52, s96, 2
  s_add_u32 s52, s52, s64
  s_mul_i32 s68, s52, 7168
  v_add_u32 v96, s68, v2
  s_add_u32 s52, s96, 1
  s_and_b32 s65, s52, 3
  s_lshl_b32 s52, s96, 2
  s_add_u32 s52, s52, s65
  s_mul_i32 s69, s52, 7168
  v_add_u32 v97, s69, v2
  s_add_u32 s52, s96, 2
  s_and_b32 s66, s52, 3
  s_lshl_b32 s52, s96, 2
  s_add_u32 s52, s52, s66
  s_mul_i32 s70, s52, 7168
  v_add_u32 v98, s70, v2
  s_add_u32 s52, s96, 3
  s_and_b32 s67, s52, 3
  s_lshl_b32 s52, s96, 2
  s_add_u32 s52, s52, s67
  s_mul_i32 s71, s52, 7168
  v_add_u32 v99, s71, v2
  s_mul_i32 s52, s97, 3072
  s_add_u32 s51, s96, 0
  s_and_b32 s51, s51, 3
  s_mul_i32 s51, s51, 10240
  s_add_u32 s51, s51, s52
  s_add_u32 s51, s51, 114688
  v_add_u32 v4, s51, v2
  s_add_u32 s51, s96, 1
  s_and_b32 s51, s51, 3
  s_mul_i32 s51, s51, 10240
  s_add_u32 s51, s51, s52
  s_add_u32 s51, s51, 114688
  v_add_u32 v5, s51, v2
  s_add_u32 s51, s96, 2
  s_and_b32 s51, s51, 3
  s_mul_i32 s51, s51, 10240
  s_add_u32 s51, s51, s52
  s_add_u32 s51, s51, 119808
  v_add_u32 v6, s51, v2
  s_add_u32 s51, s96, 3
  s_and_b32 s51, s51, 3
  s_mul_i32 s51, s51, 5120
  s_add_u32 s51, s51, s52
  s_add_u32 s51, s51, 0
  v_add_u32 v7, s51, v2
  s_add_u32 s51, s96, 0
  s_and_b32 s51, s51, 3
  s_mul_i32 s51, s51, 5120
  s_add_u32 s51, s51, s52
  s_add_u32 s51, s51, 0
  v_add_u32 v11, s51, v2
  v_and_b32 v8, 1, v1
  v_lshlrev_b32 v8, 7, v8
  s_lshl_b32 s51, s44, 10
  s_lshl_b32 s52, s96, 8
  s_add_u32 s51, s51, s52
  s_add_u32 s51, s51, 983040
  v_add_u32 v8, s51, v8
  v_and_b32 v12, 15, v1
  v_lshlrev_b32 v12, 4, v12
  v_lshrrev_b32 v13, 4, v1
  v_lshl_add_u32 v12, v13, 10, v12
  s_cmp_eq_u32 s96, 3
  s_cselect_b32 s51, 0x40000000, 0
  v_or_b32 v13, s51, v12
  s_mul_i32 s54, s44, 110592
  s_mul_i32 s52, s96, 28672
  s_add_u32 s54, s54, s52
  s_add_u32 s54, s54, 23068672
  s_mov_b32 s61, 0
L_poll_127:
  buffer_load_dword v9, v8, s[32:35], 0 offen sc1
L_pchk_129:
  s_waitcnt vmcnt(0)
  v_cmp_ne_u32 vcc, s47, v9
  s_nop 1
  s_cmp_eq_u64 vcc, 0
  s_cbranch_scc1 L_pdone_128
  s_add_u32 s61, s61, 1
  s_cmp_lt_u32 s61, 40000
  s_cbranch_scc1 L_poll_127
L_pdone_128:
  s_cmp_eq_u32 s97, 0
  s_cbranch_scc0 L_g2_130
  s_lshl_b32 s52, s65, 8
  s_add_u32 s52, s52, s54
  s_add_u32 s53, s52, 0
  s_add_u32 m0, s69, 0
  s_nop 0
  buffer_load_dwordx4 v12, s[32:35], s53 offen sc1 lds
  s_add_u32 s53, s52, 4096
  s_add_u32 m0, s69, 1024
  s_nop 0
  buffer_load_dwordx4 v12, s[32:35], s53 offen sc1 lds
  s_add_u32 s53, s52, 8192
  s_add_u32 m0, s69, 2048
  s_nop 0
  buffer_load_dwordx4 v12, s[32:35], s53 offen sc1 lds
  s_add_u32 s53, s52, 12288
  s_add_u32 m0, s69, 3072
  s_nop 0
  buffer_load_dwordx4 v12, s[32:35], s53 offen sc1 lds
  s_lshl_b32 s52, s66, 8
  s_add_u32 s52, s52, s54
  s_add_u32 s53, s52, 0
  s_add_u32 m0, s70, 0
  s_nop 0
  buffer_load_dwordx4 v12, s[32:35], s53 offen sc1 lds
  s_add_u32 s53, s52, 4096
  s_add_u32 m0, s70, 1024
  s_nop 0
  buffer_load_dwordx4 v12, s[32:35], s53 offen sc1 lds
  s_add_u32 s53, s52, 8192
  s_add_u32 m0, s70, 2048
  s_nop 0
  buffer_load_dwordx4 v12, s[32:35], s53 offen sc1 lds
  s_add_u32 s53, s52, 12288
  s_add_u32 m0, s70, 3072
  s_nop 0
  buffer_load_dwordx4 v12, s[32:35], s53 offen sc1 lds
  s_waitcnt vmcnt(4)
  s_barrier
  ds_read_b128 v[16:19], v97 offset:0
  ds_read_b128 v[20:23], v97 offset:1024
  ds_read_b128 v[24:27], v97 offset:2048
  ds_read_b128 v[28:31], v97 offset:3072
  s_waitcnt lgkmcnt(3)
  v_mfma_f32_16x16x32_bf16 v[60:63], v[156:159], v[16:19], 0
  ds_read_b128 v[32:35], v97 offset:4096
  v_mfma_f32_16x16x32_bf16 v[64:67], v[160:163], v[16:19], 0
  v_mfma_f32_16x16x32_bf16 v[68:71], v[164:167], v[16:19], 0
  s_lshl_b32 s52, s67, 8
  s_add_u32 s52, s52, s54
  s_add_u32 s53, s52, 0
  s_add_u32 m0, s71, 0
  s_nop 0
  buffer_load_dwordx4 v12, s[32:35], s53 offen sc1 lds
  s_waitcnt lgkmcnt(3)
  v_mfma_f32_16x16x32_bf16 v[60:63], v[168:171], v[20:23], v[60:63]
  ds_read_b128 v[36:39], v97 offset:5120
  v_mfma_f32_16x16x32_bf16 v[64:67], v[172:175], v[20:23], v[64:67]
  v_mfma_f32_16x16x32_bf16 v[68:71], v[176:179], v[20:23], v[68:71]
  s_add_u32 s53, s52, 4096
  s_add_u32 m0, s71, 1024
  s_nop 0
  buffer_load_dwordx4 v12, s[32:35], s53 offen sc1 lds
  s_waitcnt lgkmcnt(3)
  v_mfma_f32_16x16x32_bf16 v[60:63], v[180:183], v[24:27], v[60:63]
  ds_read_b128 v[40:43], v97 offset:6144
  v_mfma_f32_16x16x32_bf16 v[64:67], v[184:187], v[24:27], v[64:67]
  v_mfma_f32_16x16x32_bf16 v[68:71], v[188:191], v[24:27], v[68:71]
  s_add_u32 s53, s52, 8192
  s_add_u32 m0, s71, 2048
  s_nop 0
  buffer_load_dwordx4 v12, s[32:35], s53 offen sc1 lds
  s_waitcnt vmcnt(3)
  s_barrier
  s_waitcnt lgkmcnt(3)
  v_mfma_f32_16x16x32_bf16 v[60:63], v[192:195], v[28:31], v[60:63]
  ds_read_b128 v[44:47], v98 offset:0
  v_mfma_f32_16x16x32_bf16 v[64:67], v[196:199], v[28:31], v[64:67]
  v_mfma_f32_16x16x32_bf16 v[68:71], v[200:203], v[28:31], v[68:71]
  s_add_u32 s53, s52, 12288
  s_add_u32 m0, s71, 3072
  s_nop 0
  buffer_load_dwordx4 v12, s[32:35], s53 offen sc1 lds
  s_waitcnt lgkmcnt(3)
  v_mfma_f32_16x16x32_bf16 v[60:63], v[204:207], v[32:35], v[60:63]
  ds_read_b128 v[16:19], v98 offset:1024
  v_mfma_f32_16x16x32_bf16 v[64:67], v[208:211], v[32:35], v[64:67]
  v_mfma_f32_16x16x32_bf16 v[68:71], v[212:215], v[32:35], v[68:71]
  s_lshl_b32 s52, s64, 8
  s_add_u32 s52, s52, s54
  s_add_u32 s53, s52, 0
  s_add_u32 m0, s68, 0
  s_nop 0
  buffer_load_dwordx4 v12, s[32:35], s53 offen sc1 lds
  s_waitcnt lgkmcnt(3)
  v_mfma_f32_16x16x32_bf16 v[60:63], v[216:219], v[36:39], v[60:63]
  ds_read_b128 v[20:23], v98 offset:2048
  v_mfma_f32_16x16x32_bf16 v[64:67], v[220:223], v[36:39], v[64:67]
  v_mfma_f32_16x16x32_bf16 v[68:71], v[224:227], v[36:39], v[68:71]
  s_add_u32 s53, s52, 4096
  s_add_u32 m0, s68, 1024
  s_nop 0
  buffer_load_dwordx4 v12, s[32:35], s53 offen sc1 lds
  s_waitcnt lgkmcnt(3)
  v_mfma_f32_16x16x32_bf16 v[60:63], v[228:231], v[40:43], v[60:63]
  ds_read_b128 v[24:27], v98 offset:3072
  v_mfma_f32_16x16x32_bf16 v[64:67], v[232:235], v[40:43], v[64:67]
  v_mfma_f32_16x16x32_bf16 v[68:71], v[236:239], v[40:43], v[68:71]
  s_add_u32 s53, s52, 8192
  s_add_u32 m0, s68, 2048
  s_nop 0
  buffer_load_dwordx4 v12, s[32:35], s53 offen sc1 lds
  s_waitcnt lgkmcnt(3)
  v_mfma_f32_16x16x32_bf16 v[72:75], v[156:159], v[44:47], 0
  ds_read_b128 v[28:31], v98 offset:4096
  v_mfma_f32_16x16x32_bf16 v[76:79], v[160:163], v[44:47], 0
  v_mfma_f32_16x16x32_bf16 v[80:83], v[164:167], v[44:47], 0
  s_add_u32 s53, s52, 12288
  s_add_u32 m0, s68, 3072
  s_nop 0
  buffer_load_dwordx4 v12, s[32:35], s53 offen sc1 lds
  s_waitcnt lgkmcnt(3)
  v_mfma_f32_16x16x32_bf16 v[72:75], v[168:171], v[16:19], v[72:75]
  ds_read_b128 v[32:35], v98 offset:5120
  v_mfma_f32_16x16x32_bf16 v[76:79], v[172:175], v[16:19], v[76:79]
  ds_write_b128 v5, v[60:63] offset:0
  v_mfma_f32_16x16x32_bf16 v[80:83], v[176:179], v[16:19], v[80:83]
  s_waitcnt lgkmcnt(4)
  v_mfma_f32_16x16x32_bf16 v[72:75], v[180:183], v[20:23], v[72:75]
  ds_read_b128 v[36:39], v98 offset:6144
  v_mfma_f32_16x16x32_bf16 v[76:79], v[184:187], v[20:23], v[76:79]
  ds_write_b128 v5, v[64:67] offset:1024
  v_mfma_f32_16x16x32_bf16 v[80:83], v[188:191], v[20:23], v[80:83]
  s_waitcnt vmcnt(4)
  s_barrier
  s_waitcnt lgkmcnt(5)
  v_mfma_f32_16x16x32_bf16 v[72:75], v[192:195], v[24:27], v[72:75]
  ds_read_b128 v[40:43], v99 offset:0
  v_mfma_f32_16x16x32_bf16 v[76:79], v[196:199], v[24:27], v[76:79]
  ds_write_b128 v5, v[68:71] offset:2048
  v_mfma_f32_16x16x32_bf16 v[80:83], v[200:203], v[24:27], v[80:83]
  s_waitcnt lgkmcnt(6)
  v_mfma_f32_16x16x32_bf16 v[72:75], v[204:207], v[28:31], v[72:75]
  ds_read_b128 v[44:47], v99 offset:1024
  v_mfma_f32_16x16x32_bf16 v[76:79], v[208:211], v[28:31], v[76:79]
  v_mfma_f32_16x16x32_bf16 v[80:83], v[212:215], v[28:31], v[80:83]
  s_waitcnt lgkmcnt(6)
  v_mfma_f32_16x16x32_bf16 v[72:75], v[216:219], v[32:35], v[72:75]
  ds_read_b128 v[16:19], v99 offset:2048
  v_mfma_f32_16x16x32_bf16 v[76:79], v[220:223], v[32:35], v[76:79]
  v_mfma_f32_16x16x32_bf16 v[80:83], v[224:227], v[32:35], v[80:83]
  s_waitcnt lgkmcnt(5)
  v_mfma_f32_16x16x32_bf16 v[72:75], v[228:231], v[36:39], v[72:75]
  ds_read_b128 v[20:23], v99 offset:3072
  v_mfma_f32_16x16x32_bf16 v[76:79], v[232:235], v[36:39], v[76:79]
  v_mfma_f32_16x16x32_bf16 v[80:83], v[236:239], v[36:39], v[80:83]
  s_waitcnt lgkmcnt(4)
  v_mfma_f32_16x16x32_bf16 v[84:87], v[156:159], v[40:43], 0
  ds_read_b128 v[24:27], v99 offset:4096
  v_mfma_f32_16x16x32_bf16 v[88:91], v[160:163], v[40:43], 0
  v_mfma_f32_16x16x32_bf16 v[92:95], v[164:167], v[40:43], 0
  s_waitcnt lgkmcnt(3)
  v_mfma_f32_16x16x32_bf16 v[84:87], v[168:171], v[44:47], v[84:87]
  ds_read_b128 v[28:31], v99 offset:5120
  v_mfma_f32_16x16x32_bf16 v[88:91], v[172:175], v[44:47], v[88:91]
  ds_write_b128 v6, v[72:75] offset:0
  v_mfma_f32_16x16x32_bf16 v[92:95], v[176:179], v[44:47], v[92:95]
  s_waitcnt lgkmcnt(4)
  v_mfma_f32_16x16x32_bf16 v[84:87], v[180:183], v[16:19], v[84:87]
  ds_read_b128 v[32:35], v99 offset:6144
  v_mfma_f32_16x16x32_bf16 v[88:91], v[184:187], v[16:19], v[88:91]
  ds_write_b128 v6, v[76:79] offset:1024
  v_mfma_f32_16x16x32_bf16 v[92:95], v[188:191], v[16:19], v[92:95]
  s_waitcnt vmcnt(0)
  s_barrier
  s_waitcnt lgkmcnt(5)
  v_mfma_f32_16x16x32_bf16 v[84:87], v[192:195], v[20:23], v[84:87]
  ds_read_b128 v[36:39], v96 offset:0
  v_mfma_f32_16x16x32_bf16 v[88:91], v[196:199], v[20:23], v[88:91]
  ds_write_b128 v6, v[80:83] offset:2048
  v_mfma_f32_16x16x32_bf16 v[92:95], v[200:203], v[20:23], v[92:95]
  s_waitcnt lgkmcnt(6)
  v_mfma_f32_16x16x32_bf16 v[84:87], v[204:207], v[24:27], v[84:87]
  ds_read_b128 v[40:43], v96 offset:1024
  v_mfma_f32_16x16x32_bf16 v[88:91], v[208:211], v[24:27], v[88:91]
  v_mfma_f32_16x16x32_bf16 v[92:95], v[212:215], v[24:27], v[92:95]
  s_waitcnt lgkmcnt(6)
  v_mfma_f32_16x16x32_bf16 v[84:87], v[216:219], v[28:31], v[84:87]
  ds_read_b128 v[44:47], v96 offset:2048
  v_mfma_f32_16x16x32_bf16 v[88:91], v[220:223], v[28:31], v[88:91]
  v_mfma_f32_16x16x32_bf16 v[92:95], v[224:227], v[28:31], v[92:95]
  s_waitcnt lgkmcnt(5)
  v_mfma_f32_16x16x32_bf16 v[84:87], v[228:231], v[32:35], v[84:87]
  ds_read_b128 v[16:19], v96 offset:3072
  v_mfma_f32_16x16x32_bf16 v[88:91], v[232:235], v[32:35], v[88:91]
  v_mfma_f32_16x16x32_bf16 v[92:95], v[236:239], v[32:35], v[92:95]
  s_waitcnt lgkmcnt(4)
  v_mfma_f32_16x16x32_bf16 v[48:51], v[156:159], v[36:39], 0
  ds_read_b128 v[20:23], v96 offset:4096
  v_mfma_f32_16x16x32_bf16 v[52:55], v[160:163], v[36:39], 0
  v_mfma_f32_16x16x32_bf16 v[56:59], v[164:167], v[36:39], 0
  s_waitcnt lgkmcnt(3)
  v_mfma_f32_16x16x32_bf16 v[48:51], v[168:171], v[40:43], v[48:51]
  ds_read_b128 v[24:27], v96 offset:5120
  v_mfma_f32_16x16x32_bf16 v[52:55], v[172:175], v[40:43], v[52:55]
  v_mfma_f32_16x16x32_bf16 v[56:59], v[176:179], v[40:43], v[56:59]
  s_waitcnt lgkmcnt(3)
  v_mfma_f32_16x16x32_bf16 v[48:51], v[180:183], v[44:47], v[48:51]
  ds_read_b128 v[28:31], v96 offset:6144
  v_mfma_f32_16x16x32_bf16 v[52:55], v[184:187], v[44:47], v[52:55]
  v_mfma_f32_16x16x32_bf16 v[56:59], v[188:191], v[44:47], v[56:59]
  s_waitcnt lgkmcnt(3)
  v_mfma_f32_16x16x32_bf16 v[48:51], v[192:195], v[16:19], v[48:51]
  v_mfma_f32_16x16x32_bf16 v[52:55], v[196:199], v[16:19], v[52:55]
  v_mfma_f32_16x16x32_bf16 v[56:59], v[200:203], v[16:19], v[56:59]
  s_waitcnt lgkmcnt(2)
  v_mfma_f32_16x16x32_bf16 v[48:51], v[204:207], v[20:23], v[48:51]
  v_mfma_f32_16x16x32_bf16 v[52:55], v[208:211], v[20:23], v[52:55]
  v_mfma_f32_16x16x32_bf16 v[56:59], v[212:215], v[20:23], v[56:59]
  s_waitcnt lgkmcnt(1)
  v_mfma_f32_16x16x32_bf16 v[48:51], v[216:219], v[24:27], v[48:51]
  v_mfma_f32_16x16x32_bf16 v[52:55], v[220:223], v[24:27], v[52:55]
  v_mfma_f32_16x16x32_bf16 v[56:59], v[224:227], v[24:27], v[56:59]
  s_waitcnt lgkmcnt(0)
  v_mfma_f32_16x16x32_bf16 v[48:51], v[228:231], v[28:31], v[48:51]
  v_mfma_f32_16x16x32_bf16 v[52:55], v[232:235], v[28:31], v[52:55]
  v_mfma_f32_16x16x32_bf16 v[56:59], v[236:239], v[28:31], v[56:59]
  s_barrier
  ds_write_b128 v7, v[84:87] offset:0
  ds_write_b128 v7, v[88:91] offset:1024
  ds_write_b128 v7, v[92:95] offset:2048
  s_branch L_ge_131
L_g2_130:
  s_lshl_b32 s52, s65, 8
  s_add_u32 s52, s52, s54
  s_add_u32 s53, s52, 16384
  s_add_u32 m0, s69, 4096
  s_nop 0
  buffer_load_dwordx4 v12, s[32:35], s53 offen sc1 lds
  s_add_u32 s53, s52, 20480
  s_add_u32 m0, s69, 5120
  s_nop 0
  buffer_load_dwordx4 v12, s[32:35], s53 offen sc1 lds
  s_add_u32 s53, s52, 24576
  s_add_u32 m0, s69, 6144
  s_nop 0
  buffer_load_dwordx4 v13, s[32:35], s53 offen sc1 lds
  s_lshl_b32 s52, s66, 8
  s_add_u32 s52, s52, s54
  s_add_u32 s53, s52, 16384
  s_add_u32 m0, s70, 4096
  s_nop 0
  buffer_load_dwordx4 v12, s[32:35], s53 offen sc1 lds
  s_add_u32 s53, s52, 20480
  s_add_u32 m0, s70, 5120
  s_nop 0
  buffer_load_dwordx4 v12, s[32:35], s53 offen sc1 lds
  s_add_u32 s53, s52, 24576
  s_add_u32 m0, s70, 6144
  s_nop 0
  buffer_load_dwordx4 v13, s[32:35], s53 offen sc1 lds
  s_waitcnt vmcnt(3)
  s_barrier
  ds_read_b128 v[16:19], v97 offset:0
  ds_read_b128 v[20:23], v97 offset:1024
  ds_read_b128 v[24:27], v97 offset:2048
  ds_read_b128 v[28:31], v97 offset:3072
  s_waitcnt lgkmcnt(3)
  v_mfma_f32_16x16x32_bf16 v[60:63], v[156:159], v[16:19], 0
  ds_read_b128 v[32:35], v97 offset:4096
  v_mfma_f32_16x16x32_bf16 v[64:67], v[160:163], v[16:19], 0
  s_lshl_b32 s52, s67, 8
  s_add_u32 s52, s52, s54
  s_add_u32 s53, s52, 16384
  s_add_u32 m0, s71, 4096
  s_nop 0
  buffer_load_dwordx4 v12, s[32:35], s53 offen sc1 lds
  s_waitcnt lgkmcnt(3)
  v_mfma_f32_16x16x32_bf16 v[60:63], v[168:171], v[20:23], v[60:63]
  ds_read_b128 v[36:39], v97 offset:5120
  v_mfma_f32_16x16x32_bf16 v[64:67], v[172:175], v[20:23], v[64:67]
  s_add_u32 s53, s52, 20480
  s_add_u32 m0, s71, 5120
  s_nop 0
  buffer_load_dwordx4 v12, s[32:35], s53 offen sc1 lds
  s_waitcnt lgkmcnt(3)
  v_mfma_f32_16x16x32_bf16 v[60:63], v[180:183], v[24:27], v[60:63]
  ds_read_b128 v[40:43], v97 offset:6144
  v_mfma_f32_16x16x32_bf16 v[64:67], v[184:187], v[24:27], v[64:67]
  s_add_u32 s53, s52, 24576
  s_add_u32 m0, s71, 6144
  s_nop 0
  buffer_load_dwordx4 v13, s[32:35], s53 offen sc1 lds
  s_waitcnt vmcnt(3)
  s_barrier
  s_waitcnt lgkmcnt(3)
  v_mfma_f32_16x16x32_bf16 v[60:63], v[192:195], v[28:31], v[60:63]
  ds_read_b128 v[44:47], v98 offset:0
  v_mfma_f32_16x16x32_bf16 v[64:67], v[196:199], v[28:31], v[64:67]
  s_lshl_b32 s52, s64, 8
  s_add_u32 s52, s52, s54
  s_add_u32 s53, s52, 16384
  s_add_u32 m0, s68, 4096
  s_nop 0
  buffer_load_dwordx4 v12, s[32:35], s53 offen sc1 lds
  s_waitcnt lgkmcnt(3)
  v_mfma_f32_16x16x32_bf16 v[60:63], v[204:207], v[32:35], v[60:63]
  ds_read_b128 v[16:19], v98 offset:1024
  v_mfma_f32_16x16x32_bf16 v[64:67], v[208:211], v[32:35], v[64:67]
  s_add_u32 s53, s52, 20480
  s_add_u32 m0, s68, 5120
  s_nop 0
  buffer_load_dwordx4 v12, s[32:35], s53 offen sc1 lds
  s_waitcnt lgkmcnt(3)
  v_mfma_f32_16x16x32_bf16 v[60:63], v[216:219], v[36:39], v[60:63]
  ds_read_b128 v[20:23], v98 offset:2048
  v_mfma_f32_16x16x32_bf16 v[64:67], v[220:223], v[36:39], v[64:67]
  s_add_u32 s53, s52, 24576
  s_add_u32 m0, s68, 6144
  s_nop 0
  buffer_load_dwordx4 v13, s[32:35], s53 offen sc1 lds
  s_waitcnt lgkmcnt(3)
  v_mfma_f32_16x16x32_bf16 v[60:63], v[228:231], v[40:43], v[60:63]
  ds_read_b128 v[24:27], v98 offset:3072
  v_mfma_f32_16x16x32_bf16 v[64:67], v[232:235], v[40:43], v[64:67]
  s_waitcnt lgkmcnt(3)
  v_mfma_f32_16x16x32_bf16 v[72:75], v[156:159], v[44:47], 0
  ds_read_b128 v[28:31], v98 offset:4096
  v_mfma_f32_16x16x32_bf16 v[76:79], v[160:163], v[44:47], 0
  s_waitcnt lgkmcnt(3)
  v_mfma_f32_16x16x32_bf16 v[72:75], v[168:171], v[16:19], v[72:75]
  ds_read_b128 v[32:35], v98 offset:5120
  v_mfma_f32_16x16x32_bf16 v[76:79], v[172:175], v[16:19], v[76:79]
  ds_write_b128 v5, v[60:63] offset:0
  s_waitcnt lgkmcnt(4)
  v_mfma_f32_16x16x32_bf16 v[72:75], v[180:183], v[20:23], v[72:75]
  ds_read_b128 v[36:39], v98 offset:6144
  v_mfma_f32_16x16x32_bf16 v[76:79], v[184:187], v[20:23], v[76:79]
  ds_write_b128 v5, v[64:67] offset:1024
  s_waitcnt vmcnt(3)
  s_barrier
  s_waitcnt lgkmcnt(5)
  v_mfma_f32_16x16x32_bf16 v[72:75], v[192:195], v[24:27], v[72:75]
  ds_read_b128 v[40:43], v99 offset:0
  v_mfma_f32_16x16x32_bf16 v[76:79], v[196:199], v[24:27], v[76:79]
  s_waitcnt lgkmcnt(5)
  v_mfma_f32_16x16x32_bf16 v[72:75], v[204:207], v[28:31], v[72:75]
  ds_read_b128 v[44:47], v99 offset:1024
  v_mfma_f32_16x16x32_bf16 v[76:79], v[208:211], v[28:31], v[76:79]
  s_waitcnt lgkmcnt(5)
  v_mfma_f32_16x16x32_bf16 v[72:75], v[216:219], v[32:35], v[72:75]
  ds_read_b128 v[16:19], v99 offset:2048
  v_mfma_f32_16x16x32_bf16 v[76:79], v[220:223], v[32:35], v[76:79]
  s_waitcnt lgkmcnt(4)
  v_mfma_f32_16x16x32_bf16 v[72:75], v[228:231], v[36:39], v[72:75]
  ds_read_b128 v[20:23], v99 offset:3072
  v_mfma_f32_16x16x32_bf16 v[76:79], v[232:235], v[36:39], v[76:79]
  s_waitcnt lgkmcnt(3)
  v_mfma_f32_16x16x32_bf16 v[84:87], v[156:159], v[40:43], 0
  ds_read_b128 v[24:27], v99 offset:4096
  v_mfma_f32_16x16x32_bf16 v[88:91], v[160:163], v[40:43], 0
  s_waitcnt lgkmcnt(3)
  v_mfma_f32_16x16x32_bf16 v[84:87], v[168:171], v[44:47], v[84:87]
  ds_read_b128 v[28:31], v99 offset:5120
  v_mfma_f32_16x16x32_bf16 v[88:91], v[172:175], v[44:47], v[88:91]
  ds_write_b128 v6, v[72:75] offset:0
  s_waitcnt lgkmcnt(4)
  v_mfma_f32_16x16x32_bf16 v[84:87], v[180:183], v[16:19], v[84:87]
  ds_read_b128 v[32:35], v99 offset:6144
  v_mfma_f32_16x16x32_bf16 v[88:91], v[184:187], v[16:19], v[88:91]
  ds_write_b128 v6, v[76:79] offset:1024
  s_waitcnt vmcnt(0)
  s_barrier
  s_waitcnt lgkmcnt(5)
  v_mfma_f32_16x16x32_bf16 v[84:87], v[192:195], v[20:23], v[84:87]
  ds_read_b128 v[36:39], v96 offset:0
  v_mfma_f32_16x16x32_bf16 v[88:91], v[196:199], v[20:23], v[88:91]
  s_waitcnt lgkmcnt(5)
  v_mfma_f32_16x16x32_bf16 v[84:87], v[204:207], v[24:27], v[84:87]
  ds_read_b128 v[40:43], v96 offset:1024
  v_mfma_f32_16x16x32_bf16 v[88:91], v[208:211], v[24:27], v[88:91]
  s_waitcnt lgkmcnt(5)
  v_mfma_f32_16x16x32_bf16 v[84:87], v[216:219], v[28:31], v[84:87]
  ds_read_b128 v[44:47], v96 offset:2048
  v_mfma_f32_16x16x32_bf16 v[88:91], v[220:223], v[28:31], v[88:91]
  s_waitcnt lgkmcnt(4)
  v_mfma_f32_16x16x32_bf16 v[84:87], v[228:231], v[32:35], v[84:87]
  ds_read_b128 v[16:19], v96 offset:3072
  v_mfma_f32_16x16x32_bf16 v[88:91], v[232:235], v[32:35], v[88:91]
  s_waitcnt lgkmcnt(3)
  v_mfma_f32_16x16x32_bf16 v[48:51], v[156:159], v[36:39], 0
  ds_read_b128 v[20:23], v96 offset:4096
  v_mfma_f32_16x16x32_bf16 v[52:55], v[160:163], v[36:39], 0
  s_waitcnt lgkmcnt(3)
  v_mfma_f32_16x16x32_bf16 v[48:51], v[168:171], v[40:43], v[48:51]
  ds_read_b128 v[24:27], v96 offset:5120
  v_mfma_f32_16x16x32_bf16 v[52:55], v[172:175], v[40:43], v[52:55]
  s_waitcnt lgkmcnt(3)
  v_mfma_f32_16x16x32_bf16 v[48:51], v[180:183], v[44:47], v[48:51]
  ds_read_b128 v[28:31], v96 offset:6144
  v_mfma_f32_16x16x32_bf16 v[52:55], v[184:187], v[44:47], v[52:55]
  s_waitcnt lgkmcnt(3)
  v_mfma_f32_16x16x32_bf16 v[48:51], v[192:195], v[16:19], v[48:51]
  v_mfma_f32_16x16x32_bf16 v[52:55], v[196:199], v[16:19], v[52:55]
  s_waitcnt lgkmcnt(2)
  v_mfma_f32_16x16x32_bf16 v[48:51], v[204:207], v[20:23], v[48:51]
  v_mfma_f32_16x16x32_bf16 v[52:55], v[208:211], v[20:23], v[52:55]
  s_waitcnt lgkmcnt(1)
  v_mfma_f32_16x16x32_bf16 v[48:51], v[216:219], v[24:27], v[48:51]
  v_mfma_f32_16x16x32_bf16 v[52:55], v[220:223], v[24:27], v[52:55]
  s_waitcnt lgkmcnt(0)
  v_mfma_f32_16x16x32_bf16 v[48:51], v[228:231], v[28:31], v[48:51]
  v_mfma_f32_16x16x32_bf16 v[52:55], v[232:235], v[28:31], v[52:55]
  s_barrier
  ds_write_b128 v7, v[84:87] offset:0
  ds_write_b128 v7, v[88:91] offset:1024
L_ge_131:
  s_waitcnt lgkmcnt(0)
  s_barrier
  ds_read_b128 v[100:103], v4 offset:0
  ds_read_b128 v[104:107], v4 offset:5120
  ds_read_b128 v[108:111], v11 offset:0
  ds_read_b128 v[112:115], v4 offset:1024
  ds_read_b128 v[116:119], v4 offset:6144
  ds_read_b128 v[120:123], v11 offset:1024
  ds_read_b128 v[124:127], v4 offset:2048
  ds_read_b128 v[128:131], v4 offset:7168
  ds_read_b128 v[132:135], v11 offset:2048
  s_waitcnt lgkmcnt(6)
  v_add_f32 v100, v100, v104
  v_add_f32 v48, v48, v108
  v_add_f32 v101, v101, v105
  v_add_f32 v49, v49, v109
  v_add_f32 v102, v102, v106
  v_add_f32 v50, v50, v110
  v_add_f32 v103, v103, v107
  v_add_f32 v51, v51, v111
  v_add_f32 v48, v48, v100
  v_add_f32 v49, v49, v101
  v_add_f32 v50, v50, v102
  v_add_f32 v51, v51, v103
  s_waitcnt lgkmcnt(3)
  v_add_f32 v112, v112, v116
  v_add_f32 v52, v52, v120
  v_add_f32 v113, v113, v117
  v_add_f32 v53, v53, v121
  v_add_f32 v114, v114, v118
  v_add_f32 v54, v54, v122
  v_add_f32 v115, v115, v119
  v_add_f32 v55, v55, v123
  v_add_f32 v52, v52, v112
  v_add_f32 v53, v53, v113
  v_add_f32 v54, v54, v114
  v_add_f32 v55, v55, v115
  s_waitcnt lgkmcnt(0)
  v_add_f32 v124, v124, v128
  v_add_f32 v56, v56, v132
  v_add_f32 v125, v125, v129
  v_add_f32 v57, v57, v133
  v_add_f32 v126, v126, v130
  v_add_f32 v58, v58, v134
  v_add_f32 v127, v127, v131
  v_add_f32 v59, v59, v135
  v_add_f32 v56, v56, v124
  v_add_f32 v57, v57, v125
  v_add_f32 v58, v58, v126
  v_add_f32 v59, v59, v127
  v_lshlrev_b32 v8, 16, v240
  v_and_b32 v9, 0xffff0000, v240
  v_lshlrev_b32 v10, 16, v241
  v_and_b32 v11, 0xffff0000, v241
  v_fmac_f32 v8, v136, v48
  v_fmac_f32 v9, v137, v49
  v_fmac_f32 v10, v138, v50
  v_fmac_f32 v11, v139, v51
  v_cvt_pk_bf16_f32 v16, v8, v9
  v_cvt_pk_bf16_f32 v17, v10, v11
  v_lshlrev_b32 v8, 16, v242
  v_and_b32 v9, 0xffff0000, v242
  v_lshlrev_b32 v10, 16, v243
  v_and_b32 v11, 0xffff0000, v243
  v_fmac_f32 v8, v140, v52
  v_fmac_f32 v9, v141, v53
  v_fmac_f32 v10, v142, v54
  v_fmac_f32 v11, v143, v55
  v_cvt_pk_bf16_f32 v18, v8, v9
  v_cvt_pk_bf16_f32 v19, v10, v11
  v_lshlrev_b32 v8, 16, v244
  v_and_b32 v9, 0xffff0000, v244
  v_lshlrev_b32 v10, 16, v245
  v_and_b32 v11, 0xffff0000, v245
  v_fmac_f32 v8, v144, v56
  v_fmac_f32 v9, v145, v57
  v_fmac_f32 v10, v146, v58
  v_fmac_f32 v11, v147, v59
  v_cvt_pk_bf16_f32 v20, v8, v9
  v_cvt_pk_bf16_f32 v21, v10, v11
  v_and_b32 v8, 15, v1
  s_lshl_b32 s51, s96, 4
  v_add_u32 v8, s51, v8
  v_mul_u32_u24 v8, 160, v8
  v_lshrrev_b32 v9, 4, v1
  v_lshl_add_u32 v8, v9, 3, v8
  s_mul_i32 s51, s97, 96
  s_add_u32 s51, s51, 61440
  v_add_u32 v8, s51, v8
  ds_write_b64 v8, v[16:17]
  ds_write_b64 v8, v[18:19] offset:32
  s_cmp_eq_u32 s97, 0
  s_cbranch_scc0 L_sr_133
  ds_write_b64 v8, v[20:21] offset:64
L_sr_133:
  s_waitcnt lgkmcnt(0)
  s_barrier
  s_mov_b32 s36, s24
  s_mov_b32 s37, s25
  s_mov_b32 s38, 2621440
  s_mov_b32 s39, 0x20000
  s_mul_i32 s51, s44, 81920
  s_mul_i32 s52, s45, 160
  s_add_u32 s51, s51, s52
  v_add_u32 v8, 0, v0
  v_lshlrev_b32 v9, 4, v8
  v_add_u32 v9, 61440, v9
  ds_read_b128 v[16:19], v9
  v_mul_u32_u24 v10, 6554, v8
  v_lshrrev_b32 v10, 16, v10
  v_mul_u32_u24 v10, 1120, v10
  v_lshl_add_u32 v10, v8, 4, v10
  s_waitcnt lgkmcnt(0)
  buffer_store_dwordx4 v[16:19], v10, s[36:39], s51 offen
  s_cmp_lt_u32 s46, 2
  s_cbranch_scc0 L_w_134
  v_add_u32 v8, 512, v0
  v_lshlrev_b32 v9, 4, v8
  v_add_u32 v9, 61440, v9
  ds_read_b128 v[16:19], v9
  v_mul_u32_u24 v10, 6554, v8
  v_lshrrev_b32 v10, 16, v10
  v_mul_u32_u24 v10, 1120, v10
  v_lshl_add_u32 v10, v8, 4, v10
  s_waitcnt lgkmcnt(0)
  buffer_store_dwordx4 v[16:19], v10, s[36:39], s51 offen
L_w_134:
  s_cmp_eq_u32 s2, 0
  s_cbranch_scc0 L_fin_135
  s_cmp_eq_u32 s46, 0
  s_cbranch_scc0 L_fin_135
  s_add_u32 s50, s49, 1
  v_mov_b32 v5, s50
  s_mov_b64 exec, 1
  buffer_store_dword v5, off, s[32:35], 0 sc1
  s_mov_b64 exec, -1
L_fin_135:
  s_waitcnt vmcnt(0)
L_end:
  s_endpgm
L_inv_36:
  s_nop 4
  v_mov_b32 v40, 0xf149f2ca
  v_mov_b32 v41, 0xf149f2ca
  v_mov_b32 v42, 0xf149f2ca
  v_mov_b32 v43, 0xf149f2ca
  v_mov_b32 v44, 0xf149f2ca
  v_mov_b32 v45, 0xf149f2ca
  v_mov_b32 v46, 0xf149f2ca
  v_mov_b32 v47, 0xf149f2ca
  v_mov_b32 v48, 0xf149f2ca
  v_mov_b32 v49, 0xf149f2ca
  v_mov_b32 v50, 0xf149f2ca
  v_mov_b32 v51, 0xf149f2ca
  v_mov_b32 v52, 0xf149f2ca
  v_mov_b32 v53, 0xf149f2ca
  v_mov_b32 v54, 0xf149f2ca
  v_mov_b32 v55, 0xf149f2ca
  s_branch L_invb_37
L_inv_38:
  v_mov_b32 v72, 0xf149f2ca
  v_mov_b32 v73, 0xf149f2ca
  v_mov_b32 v74, 0xf149f2ca
  v_mov_b32 v75, 0xf149f2ca
  v_mov_b32 v76, 0xf149f2ca
  v_mov_b32 v77, 0xf149f2ca
  v_mov_b32 v78, 0xf149f2ca
  v_mov_b32 v79, 0xf149f2ca
  v_mov_b32 v80, 0xf149f2ca
  v_mov_b32 v81, 0xf149f2ca
  v_mov_b32 v82, 0xf149f2ca
  v_mov_b32 v83, 0xf149f2ca
  v_mov_b32 v84, 0xf149f2ca
  v_mov_b32 v85, 0xf149f2ca
  v_mov_b32 v86, 0xf149f2ca
  v_mov_b32 v87, 0xf149f2ca
  s_branch L_invb_39
L_inv_40:
  v_mov_b32 v40, 0xf149f2ca
  v_mov_b32 v41, 0xf149f2ca
  v_mov_b32 v42, 0xf149f2ca
  v_mov_b32 v43, 0xf149f2ca
  v_mov_b32 v44, 0xf149f2ca
  v_mov_b32 v45, 0xf149f2ca
  v_mov_b32 v46, 0xf149f2ca
  v_mov_b32 v47, 0xf149f2ca
  v_mov_b32 v48, 0xf149f2ca
  v_mov_b32 v49, 0xf149f2ca
  v_mov_b32 v50, 0xf149f2ca
  v_mov_b32 v51, 0xf149f2ca
  v_mov_b32 v52, 0xf149f2ca
  v_mov_b32 v53, 0xf149f2ca
  v_mov_b32 v54, 0xf149f2ca
  v_mov_b32 v55, 0xf149f2ca
  s_branch L_invb_41
L_inv_42:
  v_mov_b32 v56, 0xf149f2ca
  v_mov_b32 v57, 0xf149f2ca
  v_mov_b32 v58, 0xf149f2ca
  v_mov_b32 v59, 0xf149f2ca
  v_mov_b32 v60, 0xf149f2ca
  v_mov_b32 v61, 0xf149f2ca
  v_mov_b32 v62, 0xf149f2ca
  v_mov_b32 v63, 0xf149f2ca
  v_mov_b32 v64, 0xf149f2ca
  v_mov_b32 v65, 0xf149f2ca
  v_mov_b32 v66, 0xf149f2ca
  v_mov_b32 v67, 0xf149f2ca
  v_mov_b32 v68, 0xf149f2ca
  v_mov_b32 v69, 0xf149f2ca
  v_mov_b32 v70, 0xf149f2ca
  v_mov_b32 v71, 0xf149f2ca
  s_branch L_invb_43
L_inv_44:
  v_mov_b32 v72, 0xf149f2ca
  v_mov_b32 v73, 0xf149f2ca
  v_mov_b32 v74, 0xf149f2ca
  v_mov_b32 v75, 0xf149f2ca
  v_mov_b32 v76, 0xf149f2ca
  v_mov_b32 v77, 0xf149f2ca
  v_mov_b32 v78, 0xf149f2ca
  v_mov_b32 v79, 0xf149f2ca
  v_mov_b32 v80, 0xf149f2ca
  v_mov_b32 v81, 0xf149f2ca
  v_mov_b32 v82, 0xf149f2ca
  v_mov_b32 v83, 0xf149f2ca
  v_mov_b32 v84, 0xf149f2ca
  v_mov_b32 v85, 0xf149f2ca
  v_mov_b32 v86, 0xf149f2ca
  v_mov_b32 v87, 0xf149f2ca
  s_branch L_invb_45
L_inv_46:
  v_mov_b32 v40, 0xf149f2ca
  v_mov_b32 v41, 0xf149f2ca
  v_mov_b32 v42, 0xf149f2ca
  v_mov_b32 v43, 0xf149f2ca
  v_mov_b32 v44, 0xf149f2ca
  v_mov_b32 v45, 0xf149f2ca
  v_mov_b32 v46, 0xf149f2ca
  v_mov_b32 v47, 0xf149f2ca
  v_mov_b32 v48, 0xf149f2ca
  v_mov_b32 v49, 0xf149f2ca
  v_mov_b32 v50, 0xf149f2ca
  v_mov_b32 v51, 0xf149f2ca
  v_mov_b32 v52, 0xf149f2ca
  v_mov_b32 v53, 0xf149f2ca
  v_mov_b32 v54, 0xf149f2ca
  v_mov_b32 v55, 0xf149f2ca
  s_branch L_invb_47
L_inv_48:
  v_mov_b32 v56, 0xf149f2ca
  v_mov_b32 v57, 0xf149f2ca
  v_mov_b32 v58, 0xf149f2ca
  v_mov_b32 v59, 0xf149f2ca
  v_mov_b32 v60, 0xf149f2ca
  v_mov_b32 v61, 0xf149f2ca
  v_mov_b32 v62, 0xf149f2ca
  v_mov_b32 v63, 0xf149f2ca
  v_mov_b32 v64, 0xf149f2ca
  v_mov_b32 v65, 0xf149f2ca
  v_mov_b32 v66, 0xf149f2ca
  v_mov_b32 v67, 0xf149f2ca
  v_mov_b32 v68, 0xf149f2ca
  v_mov_b32 v69, 0xf149f2ca
  v_mov_b32 v70, 0xf149f2ca
  v_mov_b32 v71, 0xf149f2ca
  s_branch L_invb_49
L_inv_50:
  v_mov_b32 v72, 0xf149f2ca
  v_mov_b32 v73, 0xf149f2ca
  v_mov_b32 v74, 0xf149f2ca
  v_mov_b32 v75, 0xf149f2ca
  v_mov_b32 v76, 0xf149f2ca
  v_mov_b32 v77, 0xf149f2ca
  v_mov_b32 v78, 0xf149f2ca
  v_mov_b32 v79, 0xf149f2ca
  v_mov_b32 v80, 0xf149f2ca
  v_mov_b32 v81, 0xf149f2ca
  v_mov_b32 v82, 0xf149f2ca
  v_mov_b32 v83, 0xf149f2ca
  v_mov_b32 v84, 0xf149f2ca
  v_mov_b32 v85, 0xf149f2ca
  v_mov_b32 v86, 0xf149f2ca
  v_mov_b32 v87, 0xf149f2ca
  s_branch L_invb_51
L_inv_54:
  v_mov_b32 v40, 0xf149f2ca
  v_mov_b32 v41, 0xf149f2ca
  v_mov_b32 v42, 0xf149f2ca
  v_mov_b32 v43, 0xf149f2ca
  v_mov_b32 v44, 0xf149f2ca
  v_mov_b32 v45, 0xf149f2ca
  v_mov_b32 v46, 0xf149f2ca
  v_mov_b32 v47, 0xf149f2ca
  v_mov_b32 v48, 0xf149f2ca
  v_mov_b32 v49, 0xf149f2ca
  v_mov_b32 v50, 0xf149f2ca
  v_mov_b32 v51, 0xf149f2ca
  v_mov_b32 v52, 0xf149f2ca
  v_mov_b32 v53, 0xf149f2ca
  v_mov_b32 v54, 0xf149f2ca
  v_mov_b32 v55, 0xf149f2ca
  s_branch L_invb_55
L_inv_56:
  v_mov_b32 v72, 0xf149f2ca
  v_mov_b32 v73, 0xf149f2ca
  v_mov_b32 v74, 0xf149f2ca
  v_mov_b32 v75, 0xf149f2ca
  v_mov_b32 v76, 0xf149f2ca
  v_mov_b32 v77, 0xf149f2ca
  v_mov_b32 v78, 0xf149f2ca
  v_mov_b32 v79, 0xf149f2ca
  v_mov_b32 v80, 0xf149f2ca
  v_mov_b32 v81, 0xf149f2ca
  v_mov_b32 v82, 0xf149f2ca
  v_mov_b32 v83, 0xf149f2ca
  v_mov_b32 v84, 0xf149f2ca
  v_mov_b32 v85, 0xf149f2ca
  v_mov_b32 v86, 0xf149f2ca
  v_mov_b32 v87, 0xf149f2ca
  s_branch L_invb_57
L_inv_58:
  v_mov_b32 v40, 0xf149f2ca
  v_mov_b32 v41, 0xf149f2ca
  v_mov_b32 v42, 0xf149f2ca
  v_mov_b32 v43, 0xf149f2ca
  v_mov_b32 v44, 0xf149f2ca
  v_mov_b32 v45, 0xf149f2ca
  v_mov_b32 v46, 0xf149f2ca
  v_mov_b32 v47, 0xf149f2ca
  v_mov_b32 v48, 0xf149f2ca
  v_mov_b32 v49, 0xf149f2ca
  v_mov_b32 v50, 0xf149f2ca
  v_mov_b32 v51, 0xf149f2ca
  v_mov_b32 v52, 0xf149f2ca
  v_mov_b32 v53, 0xf149f2ca
  v_mov_b32 v54, 0xf149f2ca
  v_mov_b32 v55, 0xf149f2ca
  s_branch L_invb_59
L_inv_62:
  v_mov_b32 v56, 0xf149f2ca
  v_mov_b32 v57, 0xf149f2ca
  v_mov_b32 v58, 0xf149f2ca
  v_mov_b32 v59, 0xf149f2ca
  v_mov_b32 v60, 0xf149f2ca
  v_mov_b32 v61, 0xf149f2ca
  v_mov_b32 v62, 0xf149f2ca
  v_mov_b32 v63, 0xf149f2ca
  v_mov_b32 v64, 0xf149f2ca
  v_mov_b32 v65, 0xf149f2ca
  v_mov_b32 v66, 0xf149f2ca
  v_mov_b32 v67, 0xf149f2ca
  v_mov_b32 v68, 0xf149f2ca
  v_mov_b32 v69, 0xf149f2ca
  v_mov_b32 v70, 0xf149f2ca
  v_mov_b32 v71, 0xf149f2ca
  s_branch L_invb_63
L_inv_64:
  v_mov_b32 v72, 0xf149f2ca
  v_mov_b32 v73, 0xf149f2ca
  v_mov_b32 v74, 0xf149f2ca
  v_mov_b32 v75, 0xf149f2ca
  v_mov_b32 v76, 0xf149f2ca
  v_mov_b32 v77, 0xf149f2ca
  v_mov_b32 v78, 0xf149f2ca
  v_mov_b32 v79, 0xf149f2ca
  v_mov_b32 v80, 0xf149f2ca
  v_mov_b32 v81, 0xf149f2ca
  v_mov_b32 v82, 0xf149f2ca
  v_mov_b32 v83, 0xf149f2ca
  v_mov_b32 v84, 0xf149f2ca
  v_mov_b32 v85, 0xf149f2ca
  v_mov_b32 v86, 0xf149f2ca
  v_mov_b32 v87, 0xf149f2ca
  s_branch L_invb_65
L_inv_67:
  v_mov_b32 v40, 0xf149f2ca
  v_mov_b32 v41, 0xf149f2ca
  v_mov_b32 v42, 0xf149f2ca
  v_mov_b32 v43, 0xf149f2ca
  v_mov_b32 v44, 0xf149f2ca
  v_mov_b32 v45, 0xf149f2ca
  v_mov_b32 v46, 0xf149f2ca
  v_mov_b32 v47, 0xf149f2ca
  v_mov_b32 v48, 0xf149f2ca
  v_mov_b32 v49, 0xf149f2ca
  v_mov_b32 v50, 0xf149f2ca
  v_mov_b32 v51, 0xf149f2ca
  v_mov_b32 v52, 0xf149f2ca
  v_mov_b32 v53, 0xf149f2ca
  v_mov_b32 v54, 0xf149f2ca
  v_mov_b32 v55, 0xf149f2ca
  s_branch L_invb_68
L_inv_69:
  v_mov_b32 v56, 0xf149f2ca
  v_mov_b32 v57, 0xf149f2ca
  v_mov_b32 v58, 0xf149f2ca
  v_mov_b32 v59, 0xf149f2ca
  v_mov_b32 v60, 0xf149f2ca
  v_mov_b32 v61, 0xf149f2ca
  v_mov_b32 v62, 0xf149f2ca
  v_mov_b32 v63, 0xf149f2ca
  v_mov_b32 v64, 0xf149f2ca
  v_mov_b32 v65, 0xf149f2ca
  v_mov_b32 v66, 0xf149f2ca
  v_mov_b32 v67, 0xf149f2ca
  v_mov_b32 v68, 0xf149f2ca
  v_mov_b32 v69, 0xf149f2ca
  v_mov_b32 v70, 0xf149f2ca
  v_mov_b32 v71, 0xf149f2ca
  s_branch L_invb_70
L_inv_71:
  v_mov_b32 v72, 0xf149f2ca
  v_mov_b32 v73, 0xf149f2ca
  v_mov_b32 v74, 0xf149f2ca
  v_mov_b32 v75, 0xf149f2ca
  v_mov_b32 v76, 0xf149f2ca
  v_mov_b32 v77, 0xf149f2ca
  v_mov_b32 v78, 0xf149f2ca
  v_mov_b32 v79, 0xf149f2ca
  v_mov_b32 v80, 0xf149f2ca
  v_mov_b32 v81, 0xf149f2ca
  v_mov_b32 v82, 0xf149f2ca
  v_mov_b32 v83, 0xf149f2ca
  v_mov_b32 v84, 0xf149f2ca
  v_mov_b32 v85, 0xf149f2ca
  v_mov_b32 v86, 0xf149f2ca
  v_mov_b32 v87, 0xf149f2ca
  s_branch L_invb_72
.section .rodata,"a"
.p2align 6
.amdhsa_kernel adaLN_cond__sliding_block__mixer_gmlp__prompt_kernel
  .amdhsa_next_free_vgpr 256
  .amdhsa_next_free_sgpr 102
  .amdhsa_accum_offset 256
  .amdhsa_group_segment_fixed_size 0
  .amdhsa_kernarg_size 104
  .amdhsa_user_sgpr_count 2
  .amdhsa_user_sgpr_kernarg_segment_ptr 1
  .amdhsa_system_sgpr_workgroup_id_x 1
.end_amdhsa_kernel
```
